```python
import torch

def _softmax(x, axis=-1):
    return torch.softmax(x, dim=axis)
def _gelu(x):
    return torch.nn.functional.gelu(x, approximate="tanh")
def _silu(x):
    return torch.nn.functional.silu(x)
def _sigmoid(x):
    return torch.sigmoid(x)
def _layernorm(x, axis=-1, eps=1e-5):
    m = x.mean(dim=axis, keepdim=True)
    v = x.var(dim=axis, keepdim=True, unbiased=False)
    return (x - m) / torch.sqrt(v + eps)
def _scatter_add(tgt, idx, src, axis=0):
    return tgt.clone().index_add_(axis, idx, src)
def _segment_sum(src, seg, n):
    out = torch.zeros((n,) + src.shape[1:], dtype=src.dtype)
    return out.index_add_(0, seg, src)
def _pad(x, pw):
    flat = tuple(v for pair in reversed(pw) for v in pair)
    return torch.nn.functional.pad(x, flat)

kernel_name = 'recurrent_scan__grouped_kv_mqa__glu_gated_swiglu__prompt'

def setup_inputs():

    _w = (lambda a: (lambda t: t.to(torch.bfloat16) if t.is_floating_point() else t)(torch.as_tensor(a)))
    def _A_setup():
        B, S, D, H = 1, 2048, 576, 32
        Dh = D // H
        return {
            "x": _w((lambda *s: torch.randn(*s, dtype=torch.bfloat16) * 0.05)(B, S, D)),
            "wq": _w((lambda *s: torch.randn(*s, dtype=torch.bfloat16) * 0.2)(D, H * Dh)),
            "wk": _w((lambda *s: torch.randn(*s, dtype=torch.bfloat16) * 0.2)(D, Dh)),
            "wv": _w((lambda *s: torch.randn(*s, dtype=torch.bfloat16) * 0.2)(D, Dh)),
            "wo": _w((lambda *s: torch.randn(*s, dtype=torch.bfloat16) * 0.2)(H * Dh, D)),
        }
    _A_in = _A_setup()

    def _B_setup():
        B, S, D, F = 1, 2048, 576, 4608
        return {
            "x": _w((lambda *s: torch.randn(*s, dtype=torch.bfloat16) * 0.05)(B, S, D)),
            "w1": _w((lambda *s: torch.randn(*s, dtype=torch.bfloat16) * 0.1)(D, F) * (2.0 / D) ** 0.5),
            "w3": _w((lambda *s: torch.randn(*s, dtype=torch.bfloat16) * 0.1)(D, F) * (2.0 / D) ** 0.5),
            "w2": _w((lambda *s: torch.randn(*s, dtype=torch.bfloat16) * 0.1)(F, D) * (2.0 / F) ** 0.5),
        }
    _B_in = _B_setup()

    return {
        "A_x": _A_in["x"],
        "A_wq": _A_in["wq"],
        "A_wk": _A_in["wk"],
        "A_wv": _A_in["wv"],
        "A_wo": _A_in["wo"],
        "B_x": _B_in["x"],
        "B_w1": _B_in["w1"],
        "B_w3": _B_in["w3"],
        "B_w2": _B_in["w2"],
    }

def reference(A_x, A_wq, A_wk, A_wv, A_wo, B_x, B_w1, B_w3, B_w2):
    def _A_ref(x, wq, wk, wv, wo):
        B, S, D = x.shape
        H = 32
        Dh = D // H
        q = (lambda x, *d: x.permute(*d))((x @ wq).reshape(B, S, H, Dh), 0, 2, 1, 3)
        k = x @ wk
        v = x @ wv
        scores = torch.einsum("bhqd,bkd->bhqk", q, k) * (Dh ** -0.5)
        p = _softmax(scores, axis=-1)
        o = torch.einsum("bhqk,bkd->bhqd", p, v)
        return (lambda x, *d: x.permute(*d))(o, 0, 2, 1, 3).reshape(B, S, H * Dh) @ wo

    def _B_ref(x, w1, w3, w2):
        gate = torch.einsum("bsd,df->bsf", x, w1)
        up = torch.einsum("bsd,df->bsf", x, w3)
        h = _silu(gate) * up
        out = torch.einsum("bsf,fd->bsd", h, w2)
        return out

    x = A_x
    xn = _layernorm(x, axis=-1)
    s = _A_ref(xn, A_wq, A_wk, A_wv, A_wo)
    g = _silu(_B_ref(xn, B_w1, B_w3, B_w2))
    return x + s * g
```

```asm
; @launch grid=(256,1,1) block=(512,1,1) lds=158592
.amdgcn_target "amdgcn-amd-amdhsa--gfx950"
.text
.p2align 8
.globl recurrent_scan__grouped_kv_mqa__glu_gated_swiglu__prompt_kernel
.type recurrent_scan__grouped_kv_mqa__glu_gated_swiglu__prompt_kernel,@function
recurrent_scan__grouped_kv_mqa__glu_gated_swiglu__prompt_kernel:
    s_cmp_ge_u32 s2, 256
    s_cbranch_scc1 KB_END
    s_load_dwordx8 s[4:11], s[0:1], 0
    s_load_dwordx2 s[12:13], s[0:1], 32
    s_load_dwordx4 s[16:19], s[0:1], 48
    s_load_dwordx2 s[20:21], s[0:1], 64
    s_load_dwordx2 s[22:23], s[0:1], 88
    s_load_dwordx4 s[64:67], s[0:1], 72
    v_lshrrev_b32 v1, 6, v0
    v_and_b32 v0, 63, v0
    v_readfirstlane_b32 s44, v1
    s_getreg_b32 s54, hwreg(HW_REG_XCC_ID)
    s_and_b32 s54, s54, 7
    s_lshl_b32 s46, s54, 2
    s_lshr_b32 s55, s2, 6
    s_add_u32 s46, s46, s55
    v_lshrrev_b32 v6, 4, v0
    v_and_b32 v10, 7, v0
    v_xor_b32 v6, v6, v10
    v_lshrrev_b32 v10, 3, v0
    v_mul_u32_u24 v12, 1152, v10
    v_lshl_add_u32 v12, v6, 4, v12
    v_xor_b32 v13, 64, v12
    s_mul_i32 s56, s44, 10240
    s_add_u32 s56, s56, 73728
    s_lshl_b32 s55, s44, 1
    s_and_b32 s55, s55, 2
    v_bfe_u32 v8, v0, 2, 3
    v_mul_u32_u24 v4, 9216, v8
    v_and_b32 v6, 3, v0
    v_xor_b32 v6, s55, v6
    v_lshl_add_u32 v4, v6, 4, v4
    v_lshrrev_b32 v6, 5, v0
    v_lshl_add_u32 v4, v6, 6, v4
    s_and_b32 s54, s44, 3
    s_lshr_b32 s55, s44, 2
    s_lshl_b32 s52, s55, 13
    s_lshl_b32 s55, s54, 10
    s_add_u32 s52, s52, s55
    s_mul_i32 s53, s54, 73728
    s_lshl_b32 s55, s46, 8
    s_add_u32 s53, s53, s55
    s_bfe_u32 s55, s46, 65536
    s_lshl_b32 s55, s55, 7
    s_add_u32 s53, s53, s55
    s_cmp_lt_u32 s44, 4
    s_waitcnt lgkmcnt(0)
    s_cselect_b32 s28, s16, s18
    s_cselect_b32 s29, s17, s19
    s_mov_b32 s40, s66
    s_mov_b32 s41, s67
    s_mov_b32 s42, 256
    s_mov_b32 s43, 0x00020000
    s_mov_b32 s60, s46
    v_mov_b32 v9, 0
    s_cmp_lg_u32 s44, 0
    s_cbranch_scc1 KA_NOTK
    s_mov_b64 exec, 1
    s_and_b32 s54, s60, 1
    s_lshl_b32 s54, s54, 7
    s_lshr_b32 s55, s60, 1
    s_lshl_b32 s55, s55, 2
    s_add_u32 s54, s54, s55
    v_mov_b32 v7, 1
    buffer_atomic_add v7, v9, s[40:43], s54 offen offset:4 sc0 sc1
    s_mov_b64 exec, -1
KA_NOTK:
    s_mov_b32 s24, s4
    s_mov_b32 s25, s5
    s_mov_b32 s26, 2359296
    s_mov_b32 s27, 0x00020000
    s_mov_b32 s30, 5308416
    s_mov_b32 s31, 0x00020000
    s_mov_b32 s36, s22
    s_mov_b32 s37, s23
    s_mov_b32 s38, 33554432
    s_mov_b32 s39, 0x00020000
    s_lshl_b32 s54, s2, 3
    s_add_u32 s54, s54, s44
    s_mul_i32 s59, s54, 1152
    v_lshlrev_b32 v6, 7, v0
    s_mov_b32 m0, 158208
    s_mov_b64 exec, 511
    buffer_load_dword v6, s[24:27], s59 offen lds
    s_mov_b64 exec, -1
    s_add_u32 m0, s52, 0
    s_add_u32 s59, s53, 0
    buffer_load_dwordx4 v4, s[28:31], s59 offen nt lds
    s_add_u32 m0, s52, 4096
    s_add_u32 s59, s53, 294912
    buffer_load_dwordx4 v4, s[28:31], s59 offen nt lds
    s_add_u32 m0, s52, 16384
    s_add_u32 s59, s53, 589824
    buffer_load_dwordx4 v4, s[28:31], s59 offen nt lds
    s_add_u32 m0, s52, 20480
    s_add_u32 s59, s53, 884736
    buffer_load_dwordx4 v4, s[28:31], s59 offen nt lds
    s_mov_b32 s14, 0x33333333
    s_mov_b32 s15, 0xcccccccc
    s_cmp_lt_u32 s44, 4
    s_cbranch_scc1 KA_MSK
    s_not_b64 s[14:15], s[14:15]
KA_MSK:
    v_lshrrev_b32 v6, 4, v0
    v_lshlrev_b32 v1, 10, v6
    v_and_b32 v6, 1, v6
    v_lshl_add_u32 v1, v6, 5, v1
    v_bfe_u32 v6, v0, 2, 2
    v_lshl_add_u32 v1, v6, 6, v1
    v_and_b32 v6, 3, v0
    v_lshl_add_u32 v1, v6, 3, v1
    v_xor_b32 v2, 32, v1
    s_and_b32 s54, s44, 1
    s_lshl_b32 s54, s54, 5
    v_xor_b32 v3, s54, v1
    s_bfe_u32 s54, s44, 0x10001
    s_lshl_b32 s54, s54, 13
    s_lshr_b32 s55, s44, 2
    s_lshl_b32 s55, s55, 9
    s_add_u32 s54, s54, s55
    v_add_u32 v3, s54, v3
    v_bfe_u32 v6, v0, 1, 3
    v_lshrrev_b32 v10, 4, v0
    v_xor_b32 v6, v6, v10
    v_lshlrev_b32 v6, 4, v6
    v_and_b32 v10, 15, v0
    v_lshl_add_u32 v6, v10, 7, v6
    v_add_u32 v14, s56, v6
    v_xor_b32 v15, 64, v14
    s_mov_b32 vcc_lo, 0x11111111
    s_mov_b32 vcc_hi, 0x11111111
    v_mov_b32 v6, 0x3f803f80
    v_cndmask_b32 v240, 0, v6, vcc
    v_cndmask_b32 v241, 0, v6, vcc
    v_cndmask_b32 v242, 0, v6, vcc
    v_cndmask_b32 v243, 0, v6, vcc
    v_mov_b32 v10, 158576
    s_cmp_lg_u32 s44, 0
    s_cbranch_scc1 KA_NOTK2
    s_waitcnt vmcnt(5)
    s_mov_b64 exec, 1
KA_TKL:
    v_readfirstlane_b32 s59, v7
    s_cmp_lt_u32 s59, 8
    s_cbranch_scc1 KA_TKOK
    s_add_u32 s60, s60, 1
    s_and_b32 s60, s60, 31
    s_cmp_lg_u32 s60, s46
    s_cbranch_scc1 KA_TKN
    s_and_b32 s60, s2, 31
    s_lshr_b32 s59, s2, 5
    s_branch KA_TKOK
KA_TKN:
    s_and_b32 s54, s60, 1
    s_lshl_b32 s54, s54, 7
    s_lshr_b32 s55, s60, 1
    s_lshl_b32 s55, s55, 2
    s_add_u32 s54, s54, s55
    v_mov_b32 v7, 1
    buffer_atomic_add v7, v9, s[40:43], s54 offen offset:4 sc0 sc1
    s_waitcnt vmcnt(0)
    s_branch KA_TKL
KA_TKOK:
    s_lshl_b32 s59, s59, 5
    s_add_u32 s59, s59, s60
    v_mov_b32 v7, s59
    ds_write_b32 v10, v7
    s_waitcnt lgkmcnt(0)
    s_mov_b64 exec, -1
KA_NOTK2:
    s_barrier
    ds_read_b32 v7, v10
    s_waitcnt lgkmcnt(0)
    v_readfirstlane_b32 s59, v7
    s_lshr_b32 s45, s59, 5
    s_and_b32 s59, s59, 31
    s_cmp_eq_u32 s59, s46
    s_cbranch_scc1 KA_FNOK
    s_mov_b32 s46, s59
    s_and_b32 s54, s44, 3
    s_mul_i32 s53, s54, 73728
    s_lshl_b32 s55, s46, 8
    s_add_u32 s53, s53, s55
    s_bfe_u32 s55, s46, 65536
    s_lshl_b32 s55, s55, 7
    s_add_u32 s53, s53, s55
    s_waitcnt vmcnt(0)
    s_add_u32 m0, s52, 0
    s_add_u32 s59, s53, 0
    buffer_load_dwordx4 v4, s[28:31], s59 offen nt lds
    s_add_u32 m0, s52, 4096
    s_add_u32 s59, s53, 294912
    buffer_load_dwordx4 v4, s[28:31], s59 offen nt lds
    s_add_u32 m0, s52, 16384
    s_add_u32 s59, s53, 589824
    buffer_load_dwordx4 v4, s[28:31], s59 offen nt lds
    s_add_u32 m0, s52, 20480
    s_add_u32 s59, s53, 884736
    buffer_load_dwordx4 v4, s[28:31], s59 offen nt lds
KA_FNOK:
    s_lshl_b32 s54, s45, 3
    s_add_u32 s54, s54, s44
    s_mul_i32 s48, s54, 36864
    s_add_u32 s49, s48, 9216
    s_add_u32 s50, s48, 18432
    s_add_u32 s51, s48, 27648
    s_add_u32 m0, s56, 0
    s_nop 0
    buffer_load_dwordx4 v12, s[24:27], s48 offen offset:0 lds
    s_add_u32 m0, s56, 1024
    s_nop 0
    buffer_load_dwordx4 v13, s[24:27], s49 offen offset:0 lds
    s_add_u32 m0, s56, 2048
    s_nop 0
    buffer_load_dwordx4 v12, s[24:27], s50 offen offset:0 lds
    s_add_u32 m0, s56, 3072
    s_nop 0
    buffer_load_dwordx4 v13, s[24:27], s51 offen offset:0 lds
    s_and_b32 s55, s46, 3
    s_lshl_b32 s47, s55, 3
    s_lshr_b32 s55, s46, 2
    s_xor_b32 s55, s55, 4
    s_add_u32 s47, s47, s55
    s_lshl_b32 s54, s45, 3
    s_add_u32 s54, s54, s44
    s_lshr_b32 s55, s54, 1
    s_mul_i32 s57, s55, 589824
    s_and_b32 s55, s44, 1
    s_lshl_b32 s55, s55, 11
    s_add_u32 s57, s57, s55
    s_mov_b32 s32, s6
    s_mov_b32 s33, s7
    s_mov_b32 s34, 663552
    s_mov_b32 s35, 0x00020000
    s_mov_b32 s58, 0xbe715bef
    s_cmp_lt_u32 s47, 18
    s_cbranch_scc1 KA_ROLE_DONE
    s_mov_b32 s58, 0xbf317218
    s_mov_b32 s34, 0
    s_cmp_gt_u32 s47, 19
    s_cbranch_scc1 KA_ROLE_DONE
    s_cmp_eq_u32 s47, 18
    s_cselect_b32 s32, s8, s10
    s_cselect_b32 s33, s9, s11
    s_mov_b32 s34, 20736
KA_ROLE_DONE:
    s_lshr_b32 s59, s54, 1
    s_lshl_b32 s63, s59, 8
    s_lshl_b32 s59, s46, 3
    s_add_u32 s63, s63, s59
    s_lshr_b32 s55, s55, 9
    s_add_u32 s63, s63, s55
    s_add_u32 s63, s63, 30154752
    s_lshl_b32 s59, s46, 14
    s_add_u32 s8, s57, s59
    s_bfe_u32 s55, s46, 65536
    s_lshl_b32 s55, s55, 13
    s_sub_u32 s9, s8, s55
    s_add_u32 s8, s8, s55
    s_lshr_b32 s4, s45, 1
    s_and_b32 s54, s46, 28
    s_add_u32 s4, s4, s54
    s_and_b32 s5, s45, 1
    s_lshl_b32 s5, s5, 2
    s_and_b32 s54, s46, 3
    s_add_u32 s5, s5, s54
    s_mov_b32 s10, 0xf0
    s_cmp_lg_u32 s2, 0
    s_cbranch_scc1 KA_NOZ
    s_mul_i32 s54, s44, 3072
    s_add_u32 s54, s54, 30146560
    v_lshlrev_b32 v6, 4, v0
    v_mov_b32 v8, 0
    v_mov_b32 v9, 0
    v_mov_b32 v10, 0
    v_mov_b32 v11, 0
    buffer_store_dwordx4 v[8:11], v6, s[36:39], s54 offen sc1
    buffer_store_dwordx4 v[8:11], v6, s[36:39], s54 offen offset:1024 sc1
    buffer_store_dwordx4 v[8:11], v6, s[36:39], s54 offen offset:2048 sc1
KA_NOZ:
    v_lshlrev_b32 v0, 4, v0
    s_waitcnt vmcnt(6)
    s_barrier
    s_add_u32 m0, s56, 3968
    s_nop 0
    buffer_load_dwordx4 v12, s[24:27], s48 offen offset:128 lds
    s_add_u32 m0, s56, 4992
    s_nop 0
    buffer_load_dwordx4 v13, s[24:27], s49 offen offset:128 lds
    s_add_u32 m0, s56, 6016
    s_nop 0
    buffer_load_dwordx4 v12, s[24:27], s50 offen offset:128 lds
    s_add_u32 m0, s56, 7040
    s_nop 0
    buffer_load_dwordx4 v13, s[24:27], s51 offen offset:128 lds
    ds_read_b64_tr_b16 v[224:225], v1 offset:0
    ds_read_b64_tr_b16 v[226:227], v1 offset:256
    ds_read_b64_tr_b16 v[228:229], v2 offset:0
    ds_read_b64_tr_b16 v[230:231], v2 offset:256
    ds_read_b64_tr_b16 v[232:233], v1 offset:8192
    ds_read_b64_tr_b16 v[234:235], v1 offset:8448
    s_waitcnt vmcnt(6)
    ds_read_b128 v[16:19], v14 offset:0
    ds_read_b128 v[24:27], v15 offset:0
    s_waitcnt vmcnt(4)
    ds_read_b128 v[20:23], v14 offset:2048
    ds_read_b128 v[28:31], v15 offset:2048
    s_waitcnt lgkmcnt(3)
    v_mfma_f32_16x16x32_bf16 v[160:163], v[224:227], v[16:19], 0
    ds_read_b64_tr_b16 v[236:237], v2 offset:8192
    s_add_u32 m0, s56, 7936
    s_nop 0
    buffer_load_dwordx4 v12, s[24:27], s48 offen offset:256 lds
    s_waitcnt lgkmcnt(2)
    v_mfma_f32_16x16x32_bf16 v[164:167], v[224:227], v[20:23], 0
    ds_read_b64_tr_b16 v[238:239], v2 offset:8448
    ds_read_b64_tr_b16 v[8:9], v3 offset:0
    ds_read_b64_tr_b16 v[10:11], v3 offset:256
    v_mfma_f32_16x16x32_bf16 v[168:171], v[228:231], v[16:19], 0
    ds_read_b64_tr_b16 v[224:225], v1 offset:512
    s_add_u32 m0, s56, 8960
    s_nop 0
    buffer_load_dwordx4 v13, s[24:27], s49 offen offset:256 lds
    v_mfma_f32_16x16x32_bf16 v[248:251], v[240:243], v[16:19], 0
    v_mfma_f32_16x16x32_bf16 v[172:175], v[228:231], v[20:23], 0
    ds_read_b64_tr_b16 v[226:227], v1 offset:768
    v_mfma_f32_16x16x32_bf16 v[176:179], v[232:235], v[16:19], 0
    ds_read_b64_tr_b16 v[228:229], v2 offset:512
    s_add_u32 m0, s52, 32768
    s_add_u32 s59, s53, 1179648
    buffer_load_dwordx4 v4, s[28:31], s59 offen nt lds
    v_mfma_f32_16x16x32_bf16 v[252:255], v[16:19], v[16:19], 0
    v_mfma_f32_16x16x32_bf16 v[180:183], v[232:235], v[20:23], 0
    ds_read_b64_tr_b16 v[230:231], v2 offset:768
    s_waitcnt lgkmcnt(4)
    v_mfma_f32_16x16x32_bf16 v[244:247], v[240:243], v[8:11], 0
    v_mfma_f32_16x16x32_bf16 v[184:187], v[236:239], v[16:19], 0
    ds_read_b64_tr_b16 v[232:233], v1 offset:8704
    s_add_u32 m0, s52, 36864
    s_add_u32 s59, s53, 1474560
    buffer_load_dwordx4 v4, s[28:31], s59 offen nt lds
    v_mfma_f32_16x16x32_bf16 v[188:191], v[236:239], v[20:23], 0
    ds_read_b64_tr_b16 v[234:235], v1 offset:8960
    s_waitcnt lgkmcnt(4)
    v_mfma_f32_16x16x32_bf16 v[192:195], v[224:227], v[16:19], 0
    ds_read_b64_tr_b16 v[236:237], v2 offset:8704
    s_add_u32 m0, s56, -256
    s_nop 0
    buffer_load_dwordx4 v12, s[24:27], s50 offen offset:256 lds
    v_mfma_f32_16x16x32_bf16 v[196:199], v[224:227], v[20:23], 0
    ds_read_b64_tr_b16 v[238:239], v2 offset:8960
    ds_read_b64_tr_b16 v[8:9], v3 offset:4096
    ds_read_b64_tr_b16 v[10:11], v3 offset:4352
    s_waitcnt lgkmcnt(6)
    v_mfma_f32_16x16x32_bf16 v[200:203], v[228:231], v[16:19], 0
    ds_read_b64_tr_b16 v[224:225], v1 offset:4096
    s_add_u32 m0, s56, 768
    s_nop 0
    buffer_load_dwordx4 v13, s[24:27], s51 offen offset:256 lds
    v_mfma_f32_16x16x32_bf16 v[204:207], v[228:231], v[20:23], 0
    ds_read_b64_tr_b16 v[226:227], v1 offset:4352
    s_waitcnt lgkmcnt(6)
    v_mfma_f32_16x16x32_bf16 v[208:211], v[232:235], v[16:19], 0
    ds_read_b64_tr_b16 v[228:229], v2 offset:4096
    s_add_u32 m0, s56, 1664
    s_nop 0
    buffer_load_dwordx4 v12, s[24:27], s48 offen offset:384 lds
    v_mfma_f32_16x16x32_bf16 v[212:215], v[232:235], v[20:23], 0
    ds_read_b64_tr_b16 v[230:231], v2 offset:4352
    s_waitcnt lgkmcnt(4)
    v_mfma_f32_16x16x32_bf16 v[244:247], v[240:243], v[8:11], v[244:247]
    v_mfma_f32_16x16x32_bf16 v[216:219], v[236:239], v[16:19], 0
    ds_read_b64_tr_b16 v[232:233], v1 offset:12288
    s_add_u32 m0, s56, 2688
    s_nop 0
    buffer_load_dwordx4 v13, s[24:27], s49 offen offset:384 lds
    v_mfma_f32_16x16x32_bf16 v[220:223], v[236:239], v[20:23], 0
    ds_read_b64_tr_b16 v[234:235], v1 offset:12544
    s_waitcnt lgkmcnt(4)
    v_mfma_f32_16x16x32_bf16 v[160:163], v[224:227], v[24:27], v[160:163]
    ds_read_b64_tr_b16 v[236:237], v2 offset:12288
    s_add_u32 m0, s52, 49152
    s_add_u32 s59, s53, 1769472
    buffer_load_dwordx4 v4, s[28:31], s59 offen nt lds
    v_mfma_f32_16x16x32_bf16 v[164:167], v[224:227], v[28:31], v[164:167]
    ds_read_b64_tr_b16 v[238:239], v2 offset:12544
    s_waitcnt lgkmcnt(4)
    v_mfma_f32_16x16x32_bf16 v[168:171], v[228:231], v[24:27], v[168:171]
    ds_read_b64_tr_b16 v[224:225], v1 offset:4608
    s_waitcnt vmcnt(11)
    ds_read_b128 v[32:35], v14 offset:4096
    v_mfma_f32_16x16x32_bf16 v[248:251], v[240:243], v[24:27], v[248:251]
    v_mfma_f32_16x16x32_bf16 v[172:175], v[228:231], v[28:31], v[172:175]
    ds_read_b64_tr_b16 v[226:227], v1 offset:4864
    ds_read_b128 v[40:43], v15 offset:4096
    s_waitcnt lgkmcnt(6)
    v_mfma_f32_16x16x32_bf16 v[176:179], v[232:235], v[24:27], v[176:179]
    ds_read_b64_tr_b16 v[228:229], v2 offset:4608
    s_waitcnt vmcnt(9)
    ds_read_b128 v[36:39], v14 offset:6144
    s_add_u32 m0, s52, 53248
    s_add_u32 s59, s53, 2064384
    buffer_load_dwordx4 v4, s[28:31], s59 offen nt lds
    v_mfma_f32_16x16x32_bf16 v[252:255], v[24:27], v[24:27], v[252:255]
    v_mfma_f32_16x16x32_bf16 v[180:183], v[232:235], v[28:31], v[180:183]
    ds_read_b64_tr_b16 v[230:231], v2 offset:4864
    ds_read_b128 v[44:47], v15 offset:6144
    s_waitcnt lgkmcnt(8)
    v_mfma_f32_16x16x32_bf16 v[184:187], v[236:239], v[24:27], v[184:187]
    ds_read_b64_tr_b16 v[232:233], v1 offset:12800
    v_mfma_f32_16x16x32_bf16 v[188:191], v[236:239], v[28:31], v[188:191]
    ds_read_b64_tr_b16 v[234:235], v1 offset:13056
    s_waitcnt lgkmcnt(7)
    v_mfma_f32_16x16x32_bf16 v[192:195], v[224:227], v[24:27], v[192:195]
    ds_read_b64_tr_b16 v[236:237], v2 offset:12800
    v_mfma_f32_16x16x32_bf16 v[196:199], v[224:227], v[28:31], v[196:199]
    ds_read_b64_tr_b16 v[238:239], v2 offset:13056
    s_barrier
    s_waitcnt lgkmcnt(5)
    v_mfma_f32_16x16x32_bf16 v[200:203], v[228:231], v[24:27], v[200:203]
    ds_read_b64_tr_b16 v[224:225], v1 offset:16384
    v_mfma_f32_16x16x32_bf16 v[204:207], v[228:231], v[28:31], v[204:207]
    ds_read_b64_tr_b16 v[226:227], v1 offset:16640
    s_waitcnt lgkmcnt(4)
    v_mfma_f32_16x16x32_bf16 v[208:211], v[232:235], v[24:27], v[208:211]
    ds_read_b64_tr_b16 v[228:229], v2 offset:16384
    v_mfma_f32_16x16x32_bf16 v[212:215], v[232:235], v[28:31], v[212:215]
    ds_read_b64_tr_b16 v[230:231], v2 offset:16640
    s_waitcnt lgkmcnt(4)
    v_mfma_f32_16x16x32_bf16 v[216:219], v[236:239], v[24:27], v[216:219]
    ds_read_b64_tr_b16 v[232:233], v1 offset:24576
    v_mfma_f32_16x16x32_bf16 v[220:223], v[236:239], v[28:31], v[220:223]
    ds_read_b64_tr_b16 v[234:235], v1 offset:24832
    s_waitcnt lgkmcnt(4)
    v_mfma_f32_16x16x32_bf16 v[160:163], v[224:227], v[32:35], v[160:163]
    ds_read_b64_tr_b16 v[236:237], v2 offset:24576
    s_add_u32 m0, s56, 3712
    s_nop 0
    buffer_load_dwordx4 v12, s[24:27], s50 offen offset:384 lds
    v_mfma_f32_16x16x32_bf16 v[164:167], v[224:227], v[36:39], v[164:167]
    ds_read_b64_tr_b16 v[238:239], v2 offset:24832
    ds_read_b64_tr_b16 v[8:9], v3 offset:16384
    ds_read_b64_tr_b16 v[10:11], v3 offset:16640
    s_waitcnt lgkmcnt(6)
    v_mfma_f32_16x16x32_bf16 v[168:171], v[228:231], v[32:35], v[168:171]
    ds_read_b64_tr_b16 v[224:225], v1 offset:16896
    v_mfma_f32_16x16x32_bf16 v[248:251], v[240:243], v[32:35], v[248:251]
    v_mfma_f32_16x16x32_bf16 v[172:175], v[228:231], v[36:39], v[172:175]
    ds_read_b64_tr_b16 v[226:227], v1 offset:17152
    s_waitcnt lgkmcnt(6)
    v_mfma_f32_16x16x32_bf16 v[176:179], v[232:235], v[32:35], v[176:179]
    ds_read_b64_tr_b16 v[228:229], v2 offset:16896
    v_mfma_f32_16x16x32_bf16 v[252:255], v[32:35], v[32:35], v[252:255]
    v_mfma_f32_16x16x32_bf16 v[180:183], v[232:235], v[36:39], v[180:183]
    ds_read_b64_tr_b16 v[230:231], v2 offset:17152
    s_waitcnt lgkmcnt(4)
    v_mfma_f32_16x16x32_bf16 v[244:247], v[240:243], v[8:11], v[244:247]
    v_mfma_f32_16x16x32_bf16 v[184:187], v[236:239], v[32:35], v[184:187]
    ds_read_b64_tr_b16 v[232:233], v1 offset:25088
    s_add_u32 m0, s56, 4736
    s_nop 0
    buffer_load_dwordx4 v13, s[24:27], s51 offen offset:384 lds
    v_mfma_f32_16x16x32_bf16 v[188:191], v[236:239], v[36:39], v[188:191]
    ds_read_b64_tr_b16 v[234:235], v1 offset:25344
    s_waitcnt lgkmcnt(4)
    v_mfma_f32_16x16x32_bf16 v[192:195], v[224:227], v[32:35], v[192:195]
    ds_read_b64_tr_b16 v[236:237], v2 offset:25088
    v_mfma_f32_16x16x32_bf16 v[196:199], v[224:227], v[36:39], v[196:199]
    ds_read_b64_tr_b16 v[238:239], v2 offset:25344
    ds_read_b64_tr_b16 v[8:9], v3 offset:20480
    ds_read_b64_tr_b16 v[10:11], v3 offset:20736
    s_waitcnt lgkmcnt(6)
    v_mfma_f32_16x16x32_bf16 v[200:203], v[228:231], v[32:35], v[200:203]
    ds_read_b64_tr_b16 v[224:225], v1 offset:20480
    v_mfma_f32_16x16x32_bf16 v[204:207], v[228:231], v[36:39], v[204:207]
    ds_read_b64_tr_b16 v[226:227], v1 offset:20736
    s_waitcnt lgkmcnt(6)
    v_mfma_f32_16x16x32_bf16 v[208:211], v[232:235], v[32:35], v[208:211]
    ds_read_b64_tr_b16 v[228:229], v2 offset:20480
    s_add_u32 m0, s56, 5632
    s_nop 0
    buffer_load_dwordx4 v12, s[24:27], s48 offen offset:512 lds
    v_mfma_f32_16x16x32_bf16 v[212:215], v[232:235], v[36:39], v[212:215]
    ds_read_b64_tr_b16 v[230:231], v2 offset:20736
    s_waitcnt lgkmcnt(4)
    v_mfma_f32_16x16x32_bf16 v[244:247], v[240:243], v[8:11], v[244:247]
    v_mfma_f32_16x16x32_bf16 v[216:219], v[236:239], v[32:35], v[216:219]
    ds_read_b64_tr_b16 v[232:233], v1 offset:28672
    v_mfma_f32_16x16x32_bf16 v[220:223], v[236:239], v[36:39], v[220:223]
    ds_read_b64_tr_b16 v[234:235], v1 offset:28928
    s_waitcnt lgkmcnt(4)
    v_mfma_f32_16x16x32_bf16 v[160:163], v[224:227], v[40:43], v[160:163]
    ds_read_b64_tr_b16 v[236:237], v2 offset:28672
    v_mfma_f32_16x16x32_bf16 v[164:167], v[224:227], v[44:47], v[164:167]
    ds_read_b64_tr_b16 v[238:239], v2 offset:28928
    s_waitcnt lgkmcnt(4)
    v_mfma_f32_16x16x32_bf16 v[168:171], v[228:231], v[40:43], v[168:171]
    ds_read_b64_tr_b16 v[224:225], v1 offset:20992
    s_waitcnt vmcnt(11)
    ds_read_b128 v[48:51], v14 offset:8192
    s_add_u32 m0, s56, 6656
    s_nop 0
    buffer_load_dwordx4 v13, s[24:27], s49 offen offset:512 lds
    v_mfma_f32_16x16x32_bf16 v[248:251], v[240:243], v[40:43], v[248:251]
    v_mfma_f32_16x16x32_bf16 v[172:175], v[228:231], v[44:47], v[172:175]
    ds_read_b64_tr_b16 v[226:227], v1 offset:21248
    ds_read_b128 v[56:59], v15 offset:8192
    s_waitcnt lgkmcnt(6)
    v_mfma_f32_16x16x32_bf16 v[176:179], v[232:235], v[40:43], v[176:179]
    ds_read_b64_tr_b16 v[228:229], v2 offset:20992
    s_waitcnt vmcnt(8)
    ds_read_b128 v[52:55], v14 offset:0
    v_mfma_f32_16x16x32_bf16 v[252:255], v[40:43], v[40:43], v[252:255]
    v_mfma_f32_16x16x32_bf16 v[180:183], v[232:235], v[44:47], v[180:183]
    ds_read_b64_tr_b16 v[230:231], v2 offset:21248
    ds_read_b128 v[60:63], v15 offset:0
    s_waitcnt lgkmcnt(8)
    v_mfma_f32_16x16x32_bf16 v[184:187], v[236:239], v[40:43], v[184:187]
    ds_read_b64_tr_b16 v[232:233], v1 offset:29184
    v_mfma_f32_16x16x32_bf16 v[188:191], v[236:239], v[44:47], v[188:191]
    ds_read_b64_tr_b16 v[234:235], v1 offset:29440
    s_waitcnt lgkmcnt(7)
    v_mfma_f32_16x16x32_bf16 v[192:195], v[224:227], v[40:43], v[192:195]
    ds_read_b64_tr_b16 v[236:237], v2 offset:29184
    v_mfma_f32_16x16x32_bf16 v[196:199], v[224:227], v[44:47], v[196:199]
    ds_read_b64_tr_b16 v[238:239], v2 offset:29440
    s_barrier
    s_waitcnt lgkmcnt(5)
    v_mfma_f32_16x16x32_bf16 v[200:203], v[228:231], v[40:43], v[200:203]
    ds_read_b64_tr_b16 v[224:225], v1 offset:32768
    v_mfma_f32_16x16x32_bf16 v[204:207], v[228:231], v[44:47], v[204:207]
    ds_read_b64_tr_b16 v[226:227], v1 offset:33024
    s_waitcnt lgkmcnt(4)
    v_mfma_f32_16x16x32_bf16 v[208:211], v[232:235], v[40:43], v[208:211]
    ds_read_b64_tr_b16 v[228:229], v2 offset:32768
    v_mfma_f32_16x16x32_bf16 v[212:215], v[232:235], v[44:47], v[212:215]
    ds_read_b64_tr_b16 v[230:231], v2 offset:33024
    s_lshl_b32 s54, s2, 3
    s_add_u32 s54, s54, s44
    s_cmp_lg_u32 s54, 0
    s_cbranch_scc1 KA_NOZS
    s_mov_b32 s40, s66
    s_mov_b32 s41, s67
    s_mov_b32 s42, 256
    s_mov_b32 s43, 0x00020000
    v_mov_b32 v5, 1
    s_mov_b64 exec, 1
    buffer_store_dword v5, v0, s[40:43], 0 offen sc1
    s_mov_b64 exec, -1
KA_NOZS:
    s_waitcnt lgkmcnt(4)
    v_mfma_f32_16x16x32_bf16 v[216:219], v[236:239], v[40:43], v[216:219]
    ds_read_b64_tr_b16 v[232:233], v1 offset:40960
    v_mfma_f32_16x16x32_bf16 v[220:223], v[236:239], v[44:47], v[220:223]
    ds_read_b64_tr_b16 v[234:235], v1 offset:41216
    s_waitcnt lgkmcnt(4)
    v_mfma_f32_16x16x32_bf16 v[160:163], v[224:227], v[48:51], v[160:163]
    ds_read_b64_tr_b16 v[236:237], v2 offset:40960
    s_add_u32 m0, s56, 7680
    s_nop 0
    buffer_load_dwordx4 v12, s[24:27], s50 offen offset:512 lds
    v_mfma_f32_16x16x32_bf16 v[164:167], v[224:227], v[52:55], v[164:167]
    ds_read_b64_tr_b16 v[238:239], v2 offset:41216
    ds_read_b64_tr_b16 v[8:9], v3 offset:32768
    ds_read_b64_tr_b16 v[10:11], v3 offset:33024
    s_waitcnt lgkmcnt(6)
    v_mfma_f32_16x16x32_bf16 v[168:171], v[228:231], v[48:51], v[168:171]
    ds_read_b64_tr_b16 v[224:225], v1 offset:33280
    v_mfma_f32_16x16x32_bf16 v[248:251], v[240:243], v[48:51], v[248:251]
    v_mfma_f32_16x16x32_bf16 v[172:175], v[228:231], v[52:55], v[172:175]
    ds_read_b64_tr_b16 v[226:227], v1 offset:33536
    s_add_u32 m0, s52, 0
    s_add_u32 s59, s53, 2359296
    buffer_load_dwordx4 v4, s[28:31], s59 offen nt lds
    s_waitcnt lgkmcnt(6)
    v_mfma_f32_16x16x32_bf16 v[176:179], v[232:235], v[48:51], v[176:179]
    ds_read_b64_tr_b16 v[228:229], v2 offset:33280
    v_mfma_f32_16x16x32_bf16 v[252:255], v[48:51], v[48:51], v[252:255]
    v_mfma_f32_16x16x32_bf16 v[180:183], v[232:235], v[52:55], v[180:183]
    ds_read_b64_tr_b16 v[230:231], v2 offset:33536
    s_waitcnt lgkmcnt(4)
    v_mfma_f32_16x16x32_bf16 v[244:247], v[240:243], v[8:11], v[244:247]
    v_mfma_f32_16x16x32_bf16 v[184:187], v[236:239], v[48:51], v[184:187]
    ds_read_b64_tr_b16 v[232:233], v1 offset:41472
    s_add_u32 m0, s56, 8704
    s_nop 0
    buffer_load_dwordx4 v13, s[24:27], s51 offen offset:512 lds
    v_mfma_f32_16x16x32_bf16 v[188:191], v[236:239], v[52:55], v[188:191]
    ds_read_b64_tr_b16 v[234:235], v1 offset:41728
    s_waitcnt lgkmcnt(4)
    v_mfma_f32_16x16x32_bf16 v[192:195], v[224:227], v[48:51], v[192:195]
    ds_read_b64_tr_b16 v[236:237], v2 offset:41472
    v_mfma_f32_16x16x32_bf16 v[196:199], v[224:227], v[52:55], v[196:199]
    ds_read_b64_tr_b16 v[238:239], v2 offset:41728
    ds_read_b64_tr_b16 v[8:9], v3 offset:36864
    ds_read_b64_tr_b16 v[10:11], v3 offset:37120
    s_waitcnt lgkmcnt(6)
    v_mfma_f32_16x16x32_bf16 v[200:203], v[228:231], v[48:51], v[200:203]
    ds_read_b64_tr_b16 v[224:225], v1 offset:36864
    v_mfma_f32_16x16x32_bf16 v[204:207], v[228:231], v[52:55], v[204:207]
    ds_read_b64_tr_b16 v[226:227], v1 offset:37120
    s_waitcnt lgkmcnt(6)
    v_mfma_f32_16x16x32_bf16 v[208:211], v[232:235], v[48:51], v[208:211]
    ds_read_b64_tr_b16 v[228:229], v2 offset:36864
    s_add_u32 m0, s56, -640
    s_nop 0
    buffer_load_dwordx4 v12, s[24:27], s48 offen offset:640 lds
    v_mfma_f32_16x16x32_bf16 v[212:215], v[232:235], v[52:55], v[212:215]
    ds_read_b64_tr_b16 v[230:231], v2 offset:37120
    s_waitcnt lgkmcnt(4)
    v_mfma_f32_16x16x32_bf16 v[244:247], v[240:243], v[8:11], v[244:247]
    v_mfma_f32_16x16x32_bf16 v[216:219], v[236:239], v[48:51], v[216:219]
    ds_read_b64_tr_b16 v[232:233], v1 offset:45056
    v_mfma_f32_16x16x32_bf16 v[220:223], v[236:239], v[52:55], v[220:223]
    ds_read_b64_tr_b16 v[234:235], v1 offset:45312
    s_add_u32 m0, s52, 4096
    s_add_u32 s59, s53, 2654208
    buffer_load_dwordx4 v4, s[28:31], s59 offen nt lds
    s_waitcnt lgkmcnt(4)
    v_mfma_f32_16x16x32_bf16 v[160:163], v[224:227], v[56:59], v[160:163]
    ds_read_b64_tr_b16 v[236:237], v2 offset:45056
    s_lshl_b32 s54, s2, 2
    s_and_b32 s55, s44, 3
    s_add_u32 s54, s54, s55
    s_lshr_b32 s55, s54, 3
    s_mul_i32 s59, s55, 9216
    s_and_b32 s55, s54, 7
    s_lshl_b32 s55, s55, 7
    s_add_u32 s59, s59, s55
    s_add_u32 s59, s59, 8192
    v_mul_u32_u24 v5, 73728, v0
    s_mov_b32 m0, 158208
    s_mov_b64 exec, 0x1f
    buffer_load_dword v5, s[28:31], s59 offen lds
    s_mov_b64 exec, -1
    v_mfma_f32_16x16x32_bf16 v[164:167], v[224:227], v[60:63], v[164:167]
    ds_read_b64_tr_b16 v[238:239], v2 offset:45312
    s_waitcnt lgkmcnt(4)
    v_mfma_f32_16x16x32_bf16 v[168:171], v[228:231], v[56:59], v[168:171]
    ds_read_b64_tr_b16 v[224:225], v1 offset:37376
    s_waitcnt vmcnt(12)
    ds_read_b128 v[64:67], v14 offset:2048
    s_add_u32 m0, s56, 384
    s_nop 0
    buffer_load_dwordx4 v13, s[24:27], s49 offen offset:640 lds
    v_mfma_f32_16x16x32_bf16 v[248:251], v[240:243], v[56:59], v[248:251]
    v_mfma_f32_16x16x32_bf16 v[172:175], v[228:231], v[60:63], v[172:175]
    ds_read_b64_tr_b16 v[226:227], v1 offset:37632
    ds_read_b128 v[72:75], v15 offset:2048
    s_waitcnt lgkmcnt(6)
    v_mfma_f32_16x16x32_bf16 v[176:179], v[232:235], v[56:59], v[176:179]
    ds_read_b64_tr_b16 v[228:229], v2 offset:37376
    s_waitcnt vmcnt(9)
    ds_read_b128 v[68:71], v14 offset:4096
    v_mfma_f32_16x16x32_bf16 v[252:255], v[56:59], v[56:59], v[252:255]
    v_mfma_f32_16x16x32_bf16 v[180:183], v[232:235], v[60:63], v[180:183]
    ds_read_b64_tr_b16 v[230:231], v2 offset:37632
    ds_read_b128 v[76:79], v15 offset:4096
    s_waitcnt lgkmcnt(8)
    v_mfma_f32_16x16x32_bf16 v[184:187], v[236:239], v[56:59], v[184:187]
    ds_read_b64_tr_b16 v[232:233], v1 offset:45568
    v_mfma_f32_16x16x32_bf16 v[188:191], v[236:239], v[60:63], v[188:191]
    ds_read_b64_tr_b16 v[234:235], v1 offset:45824
    s_waitcnt lgkmcnt(7)
    v_mfma_f32_16x16x32_bf16 v[192:195], v[224:227], v[56:59], v[192:195]
    ds_read_b64_tr_b16 v[236:237], v2 offset:45568
    v_mfma_f32_16x16x32_bf16 v[196:199], v[224:227], v[60:63], v[196:199]
    ds_read_b64_tr_b16 v[238:239], v2 offset:45824
    s_barrier
    s_waitcnt lgkmcnt(5)
    v_mfma_f32_16x16x32_bf16 v[200:203], v[228:231], v[56:59], v[200:203]
    ds_read_b64_tr_b16 v[224:225], v1 offset:49152
    v_mfma_f32_16x16x32_bf16 v[204:207], v[228:231], v[60:63], v[204:207]
    ds_read_b64_tr_b16 v[226:227], v1 offset:49408
    s_waitcnt lgkmcnt(4)
    v_mfma_f32_16x16x32_bf16 v[208:211], v[232:235], v[56:59], v[208:211]
    ds_read_b64_tr_b16 v[228:229], v2 offset:49152
    v_mfma_f32_16x16x32_bf16 v[212:215], v[232:235], v[60:63], v[212:215]
    ds_read_b64_tr_b16 v[230:231], v2 offset:49408
    s_waitcnt lgkmcnt(4)
    v_mfma_f32_16x16x32_bf16 v[216:219], v[236:239], v[56:59], v[216:219]
    ds_read_b64_tr_b16 v[232:233], v1 offset:57344
    v_mfma_f32_16x16x32_bf16 v[220:223], v[236:239], v[60:63], v[220:223]
    ds_read_b64_tr_b16 v[234:235], v1 offset:57600
    s_waitcnt lgkmcnt(4)
    v_mfma_f32_16x16x32_bf16 v[160:163], v[224:227], v[64:67], v[160:163]
    ds_read_b64_tr_b16 v[236:237], v2 offset:57344
    s_add_u32 m0, s56, 1408
    s_nop 0
    buffer_load_dwordx4 v12, s[24:27], s50 offen offset:640 lds
    v_mfma_f32_16x16x32_bf16 v[164:167], v[224:227], v[68:71], v[164:167]
    ds_read_b64_tr_b16 v[238:239], v2 offset:57600
    ds_read_b64_tr_b16 v[8:9], v3 offset:49152
    ds_read_b64_tr_b16 v[10:11], v3 offset:49408
    s_waitcnt lgkmcnt(6)
    v_mfma_f32_16x16x32_bf16 v[168:171], v[228:231], v[64:67], v[168:171]
    ds_read_b64_tr_b16 v[224:225], v1 offset:49664
    v_mfma_f32_16x16x32_bf16 v[248:251], v[240:243], v[64:67], v[248:251]
    v_mfma_f32_16x16x32_bf16 v[172:175], v[228:231], v[68:71], v[172:175]
    ds_read_b64_tr_b16 v[226:227], v1 offset:49920
    s_add_u32 m0, s52, 16384
    s_add_u32 s59, s53, 2949120
    buffer_load_dwordx4 v4, s[28:31], s59 offen nt lds
    s_waitcnt lgkmcnt(6)
    v_mfma_f32_16x16x32_bf16 v[176:179], v[232:235], v[64:67], v[176:179]
    ds_read_b64_tr_b16 v[228:229], v2 offset:49664
    v_mfma_f32_16x16x32_bf16 v[252:255], v[64:67], v[64:67], v[252:255]
    v_mfma_f32_16x16x32_bf16 v[180:183], v[232:235], v[68:71], v[180:183]
    ds_read_b64_tr_b16 v[230:231], v2 offset:49920
    s_waitcnt lgkmcnt(4)
    v_mfma_f32_16x16x32_bf16 v[244:247], v[240:243], v[8:11], v[244:247]
    v_mfma_f32_16x16x32_bf16 v[184:187], v[236:239], v[64:67], v[184:187]
    ds_read_b64_tr_b16 v[232:233], v1 offset:57856
    s_add_u32 m0, s56, 2432
    s_nop 0
    buffer_load_dwordx4 v13, s[24:27], s51 offen offset:640 lds
    v_mfma_f32_16x16x32_bf16 v[188:191], v[236:239], v[68:71], v[188:191]
    ds_read_b64_tr_b16 v[234:235], v1 offset:58112
    s_waitcnt lgkmcnt(4)
    v_mfma_f32_16x16x32_bf16 v[192:195], v[224:227], v[64:67], v[192:195]
    ds_read_b64_tr_b16 v[236:237], v2 offset:57856
    v_mfma_f32_16x16x32_bf16 v[196:199], v[224:227], v[68:71], v[196:199]
    ds_read_b64_tr_b16 v[238:239], v2 offset:58112
    ds_read_b64_tr_b16 v[8:9], v3 offset:53248
    ds_read_b64_tr_b16 v[10:11], v3 offset:53504
    s_waitcnt lgkmcnt(6)
    v_mfma_f32_16x16x32_bf16 v[200:203], v[228:231], v[64:67], v[200:203]
    ds_read_b64_tr_b16 v[224:225], v1 offset:53248
    v_mfma_f32_16x16x32_bf16 v[204:207], v[228:231], v[68:71], v[204:207]
    ds_read_b64_tr_b16 v[226:227], v1 offset:53504
    s_waitcnt lgkmcnt(6)
    v_mfma_f32_16x16x32_bf16 v[208:211], v[232:235], v[64:67], v[208:211]
    ds_read_b64_tr_b16 v[228:229], v2 offset:53248
    s_add_u32 m0, s56, 3328
    s_nop 0
    buffer_load_dwordx4 v12, s[24:27], s48 offen offset:768 lds
    v_mfma_f32_16x16x32_bf16 v[212:215], v[232:235], v[68:71], v[212:215]
    ds_read_b64_tr_b16 v[230:231], v2 offset:53504
    s_waitcnt lgkmcnt(4)
    v_mfma_f32_16x16x32_bf16 v[244:247], v[240:243], v[8:11], v[244:247]
    v_mfma_f32_16x16x32_bf16 v[216:219], v[236:239], v[64:67], v[216:219]
    ds_read_b64_tr_b16 v[232:233], v1 offset:61440
    v_mfma_f32_16x16x32_bf16 v[220:223], v[236:239], v[68:71], v[220:223]
    ds_read_b64_tr_b16 v[234:235], v1 offset:61696
    s_add_u32 m0, s52, 20480
    s_add_u32 s59, s53, 3244032
    buffer_load_dwordx4 v4, s[28:31], s59 offen nt lds
    s_waitcnt lgkmcnt(4)
    v_mfma_f32_16x16x32_bf16 v[160:163], v[224:227], v[72:75], v[160:163]
    ds_read_b64_tr_b16 v[236:237], v2 offset:61440
    v_mfma_f32_16x16x32_bf16 v[164:167], v[224:227], v[76:79], v[164:167]
    ds_read_b64_tr_b16 v[238:239], v2 offset:61696
    s_waitcnt lgkmcnt(4)
    v_mfma_f32_16x16x32_bf16 v[168:171], v[228:231], v[72:75], v[168:171]
    ds_read_b64_tr_b16 v[224:225], v1 offset:53760
    s_waitcnt vmcnt(12)
    ds_read_b128 v[80:83], v14 offset:6144
    s_add_u32 m0, s56, 4352
    s_nop 0
    buffer_load_dwordx4 v13, s[24:27], s49 offen offset:768 lds
    v_mfma_f32_16x16x32_bf16 v[248:251], v[240:243], v[72:75], v[248:251]
    v_mfma_f32_16x16x32_bf16 v[172:175], v[228:231], v[76:79], v[172:175]
    ds_read_b64_tr_b16 v[226:227], v1 offset:54016
    ds_read_b128 v[88:91], v15 offset:6144
    s_waitcnt lgkmcnt(6)
    v_mfma_f32_16x16x32_bf16 v[176:179], v[232:235], v[72:75], v[176:179]
    ds_read_b64_tr_b16 v[228:229], v2 offset:53760
    s_waitcnt vmcnt(10)
    ds_read_b128 v[84:87], v14 offset:8192
    v_mfma_f32_16x16x32_bf16 v[252:255], v[72:75], v[72:75], v[252:255]
    v_mfma_f32_16x16x32_bf16 v[180:183], v[232:235], v[76:79], v[180:183]
    ds_read_b64_tr_b16 v[230:231], v2 offset:54016
    ds_read_b128 v[92:95], v15 offset:8192
    s_waitcnt lgkmcnt(8)
    v_mfma_f32_16x16x32_bf16 v[184:187], v[236:239], v[72:75], v[184:187]
    ds_read_b64_tr_b16 v[232:233], v1 offset:61952
    v_mfma_f32_16x16x32_bf16 v[188:191], v[236:239], v[76:79], v[188:191]
    ds_read_b64_tr_b16 v[234:235], v1 offset:62208
    s_waitcnt lgkmcnt(7)
    v_mfma_f32_16x16x32_bf16 v[192:195], v[224:227], v[72:75], v[192:195]
    ds_read_b64_tr_b16 v[236:237], v2 offset:61952
    s_mov_b32 s40, s6
    s_mov_b32 s41, s7
    s_mov_b32 s42, 663552
    s_mov_b32 s43, 0x00020000
    s_lshl_b32 s54, s2, 3
    s_add_u32 s54, s54, s44
    s_lshl_b32 s59, s54, 7
    v_mul_u32_u24 v5, 16384, v0
    s_mov_b32 m0, 158208
    s_mov_b64 exec, 0x7
    buffer_load_dword v5, s[40:43], s59 offen lds
    s_mov_b64 exec, -1
    v_mfma_f32_16x16x32_bf16 v[196:199], v[224:227], v[76:79], v[196:199]
    ds_read_b64_tr_b16 v[238:239], v2 offset:62208
    s_waitcnt vmcnt(9)
    s_barrier
    s_waitcnt lgkmcnt(5)
    v_mfma_f32_16x16x32_bf16 v[200:203], v[228:231], v[72:75], v[200:203]
    ds_read_b64_tr_b16 v[224:225], v1 offset:0
    v_mfma_f32_16x16x32_bf16 v[204:207], v[228:231], v[76:79], v[204:207]
    ds_read_b64_tr_b16 v[226:227], v1 offset:256
    s_waitcnt lgkmcnt(4)
    v_mfma_f32_16x16x32_bf16 v[208:211], v[232:235], v[72:75], v[208:211]
    ds_read_b64_tr_b16 v[228:229], v2 offset:0
    v_mfma_f32_16x16x32_bf16 v[212:215], v[232:235], v[76:79], v[212:215]
    ds_read_b64_tr_b16 v[230:231], v2 offset:256
    s_waitcnt lgkmcnt(4)
    v_mfma_f32_16x16x32_bf16 v[216:219], v[236:239], v[72:75], v[216:219]
    ds_read_b64_tr_b16 v[232:233], v1 offset:8192
    v_mfma_f32_16x16x32_bf16 v[220:223], v[236:239], v[76:79], v[220:223]
    ds_read_b64_tr_b16 v[234:235], v1 offset:8448
    s_waitcnt lgkmcnt(4)
    v_mfma_f32_16x16x32_bf16 v[160:163], v[224:227], v[80:83], v[160:163]
    ds_read_b64_tr_b16 v[236:237], v2 offset:8192
    s_add_u32 m0, s56, 5376
    s_nop 0
    buffer_load_dwordx4 v12, s[24:27], s50 offen offset:768 lds
    v_mfma_f32_16x16x32_bf16 v[164:167], v[224:227], v[84:87], v[164:167]
    ds_read_b64_tr_b16 v[238:239], v2 offset:8448
    ds_read_b64_tr_b16 v[8:9], v3 offset:0
    ds_read_b64_tr_b16 v[10:11], v3 offset:256
    s_waitcnt lgkmcnt(6)
    v_mfma_f32_16x16x32_bf16 v[168:171], v[228:231], v[80:83], v[168:171]
    ds_read_b64_tr_b16 v[224:225], v1 offset:512
    v_mfma_f32_16x16x32_bf16 v[248:251], v[240:243], v[80:83], v[248:251]
    v_mfma_f32_16x16x32_bf16 v[172:175], v[228:231], v[84:87], v[172:175]
    ds_read_b64_tr_b16 v[226:227], v1 offset:768
    s_add_u32 m0, s52, 32768
    s_add_u32 s59, s53, 3538944
    buffer_load_dwordx4 v4, s[28:31], s59 offen nt lds
    s_waitcnt lgkmcnt(6)
    v_mfma_f32_16x16x32_bf16 v[176:179], v[232:235], v[80:83], v[176:179]
    ds_read_b64_tr_b16 v[228:229], v2 offset:512
    v_mfma_f32_16x16x32_bf16 v[252:255], v[80:83], v[80:83], v[252:255]
    v_mfma_f32_16x16x32_bf16 v[180:183], v[232:235], v[84:87], v[180:183]
    ds_read_b64_tr_b16 v[230:231], v2 offset:768
    s_waitcnt lgkmcnt(4)
    v_mfma_f32_16x16x32_bf16 v[244:247], v[240:243], v[8:11], v[244:247]
    v_mfma_f32_16x16x32_bf16 v[184:187], v[236:239], v[80:83], v[184:187]
    ds_read_b64_tr_b16 v[232:233], v1 offset:8704
    s_add_u32 m0, s56, 6400
    s_nop 0
    buffer_load_dwordx4 v13, s[24:27], s51 offen offset:768 lds
    v_mfma_f32_16x16x32_bf16 v[188:191], v[236:239], v[84:87], v[188:191]
    ds_read_b64_tr_b16 v[234:235], v1 offset:8960
    s_waitcnt lgkmcnt(4)
    v_mfma_f32_16x16x32_bf16 v[192:195], v[224:227], v[80:83], v[192:195]
    ds_read_b64_tr_b16 v[236:237], v2 offset:8704
    v_mfma_f32_16x16x32_bf16 v[196:199], v[224:227], v[84:87], v[196:199]
    ds_read_b64_tr_b16 v[238:239], v2 offset:8960
    ds_read_b64_tr_b16 v[8:9], v3 offset:4096
    ds_read_b64_tr_b16 v[10:11], v3 offset:4352
    s_waitcnt lgkmcnt(6)
    v_mfma_f32_16x16x32_bf16 v[200:203], v[228:231], v[80:83], v[200:203]
    ds_read_b64_tr_b16 v[224:225], v1 offset:4096
    v_mfma_f32_16x16x32_bf16 v[204:207], v[228:231], v[84:87], v[204:207]
    ds_read_b64_tr_b16 v[226:227], v1 offset:4352
    s_waitcnt lgkmcnt(6)
    v_mfma_f32_16x16x32_bf16 v[208:211], v[232:235], v[80:83], v[208:211]
    ds_read_b64_tr_b16 v[228:229], v2 offset:4096
    s_add_u32 m0, s56, 7296
    s_nop 0
    buffer_load_dwordx4 v12, s[24:27], s48 offen offset:896 lds
    v_mfma_f32_16x16x32_bf16 v[212:215], v[232:235], v[84:87], v[212:215]
    ds_read_b64_tr_b16 v[230:231], v2 offset:4352
    s_waitcnt lgkmcnt(4)
    v_mfma_f32_16x16x32_bf16 v[244:247], v[240:243], v[8:11], v[244:247]
    v_mfma_f32_16x16x32_bf16 v[216:219], v[236:239], v[80:83], v[216:219]
    ds_read_b64_tr_b16 v[232:233], v1 offset:12288
    v_mfma_f32_16x16x32_bf16 v[220:223], v[236:239], v[84:87], v[220:223]
    ds_read_b64_tr_b16 v[234:235], v1 offset:12544
    s_add_u32 m0, s52, 36864
    s_add_u32 s59, s53, 3833856
    buffer_load_dwordx4 v4, s[28:31], s59 offen nt lds
    s_waitcnt lgkmcnt(4)
    v_mfma_f32_16x16x32_bf16 v[160:163], v[224:227], v[88:91], v[160:163]
    ds_read_b64_tr_b16 v[236:237], v2 offset:12288
    v_mfma_f32_16x16x32_bf16 v[164:167], v[224:227], v[92:95], v[164:167]
    ds_read_b64_tr_b16 v[238:239], v2 offset:12544
    s_waitcnt lgkmcnt(4)
    v_mfma_f32_16x16x32_bf16 v[168:171], v[228:231], v[88:91], v[168:171]
    ds_read_b64_tr_b16 v[224:225], v1 offset:4608
    s_waitcnt vmcnt(12)
    ds_read_b128 v[96:99], v14 offset:0
    s_add_u32 m0, s56, 8320
    s_nop 0
    buffer_load_dwordx4 v13, s[24:27], s49 offen offset:896 lds
    v_mfma_f32_16x16x32_bf16 v[248:251], v[240:243], v[88:91], v[248:251]
    v_mfma_f32_16x16x32_bf16 v[172:175], v[228:231], v[92:95], v[172:175]
    ds_read_b64_tr_b16 v[226:227], v1 offset:4864
    ds_read_b128 v[104:107], v15 offset:0
    s_waitcnt lgkmcnt(6)
    v_mfma_f32_16x16x32_bf16 v[176:179], v[232:235], v[88:91], v[176:179]
    ds_read_b64_tr_b16 v[228:229], v2 offset:4608
    s_waitcnt vmcnt(10)
    ds_read_b128 v[100:103], v14 offset:2048
    v_mfma_f32_16x16x32_bf16 v[252:255], v[88:91], v[88:91], v[252:255]
    v_mfma_f32_16x16x32_bf16 v[180:183], v[232:235], v[92:95], v[180:183]
    ds_read_b64_tr_b16 v[230:231], v2 offset:4864
    ds_read_b128 v[108:111], v15 offset:2048
    s_waitcnt lgkmcnt(8)
    v_mfma_f32_16x16x32_bf16 v[184:187], v[236:239], v[88:91], v[184:187]
    ds_read_b64_tr_b16 v[232:233], v1 offset:12800
    s_cmp_lg_u32 s34, 20736
    s_cbranch_scc1 KA_NOTKV
    s_mul_i32 s59, s44, 2688
    v_mul_u32_u24 v5, 8, v0
    s_mov_b32 m0, 158208
    s_mov_b64 exec, 0x1fffff
    buffer_load_dword v5, s[32:35], s59 offen lds
    s_mov_b64 exec, -1
KA_NOTKV:
    v_mfma_f32_16x16x32_bf16 v[188:191], v[236:239], v[92:95], v[188:191]
    ds_read_b64_tr_b16 v[234:235], v1 offset:13056
    s_waitcnt lgkmcnt(7)
    v_mfma_f32_16x16x32_bf16 v[192:195], v[224:227], v[88:91], v[192:195]
    ds_read_b64_tr_b16 v[236:237], v2 offset:12800
    v_mfma_f32_16x16x32_bf16 v[196:199], v[224:227], v[92:95], v[196:199]
    ds_read_b64_tr_b16 v[238:239], v2 offset:13056
    s_waitcnt vmcnt(8)
    s_barrier
    s_waitcnt lgkmcnt(5)
    v_mfma_f32_16x16x32_bf16 v[200:203], v[228:231], v[88:91], v[200:203]
    ds_read_b64_tr_b16 v[224:225], v1 offset:16384
    v_mfma_f32_16x16x32_bf16 v[204:207], v[228:231], v[92:95], v[204:207]
    ds_read_b64_tr_b16 v[226:227], v1 offset:16640
    s_waitcnt lgkmcnt(4)
    v_mfma_f32_16x16x32_bf16 v[208:211], v[232:235], v[88:91], v[208:211]
    ds_read_b64_tr_b16 v[228:229], v2 offset:16384
    v_mfma_f32_16x16x32_bf16 v[212:215], v[232:235], v[92:95], v[212:215]
    ds_read_b64_tr_b16 v[230:231], v2 offset:16640
    s_waitcnt lgkmcnt(4)
    v_mfma_f32_16x16x32_bf16 v[216:219], v[236:239], v[88:91], v[216:219]
    ds_read_b64_tr_b16 v[232:233], v1 offset:24576
    v_mfma_f32_16x16x32_bf16 v[220:223], v[236:239], v[92:95], v[220:223]
    ds_read_b64_tr_b16 v[234:235], v1 offset:24832
    s_waitcnt lgkmcnt(4)
    v_mfma_f32_16x16x32_bf16 v[160:163], v[224:227], v[96:99], v[160:163]
    ds_read_b64_tr_b16 v[236:237], v2 offset:24576
    s_add_u32 m0, s56, -896
    s_nop 0
    buffer_load_dwordx4 v12, s[24:27], s50 offen offset:896 lds
    v_mfma_f32_16x16x32_bf16 v[164:167], v[224:227], v[100:103], v[164:167]
    ds_read_b64_tr_b16 v[238:239], v2 offset:24832
    ds_read_b64_tr_b16 v[8:9], v3 offset:16384
    ds_read_b64_tr_b16 v[10:11], v3 offset:16640
    s_waitcnt lgkmcnt(6)
    v_mfma_f32_16x16x32_bf16 v[168:171], v[228:231], v[96:99], v[168:171]
    ds_read_b64_tr_b16 v[224:225], v1 offset:16896
    v_mfma_f32_16x16x32_bf16 v[248:251], v[240:243], v[96:99], v[248:251]
    v_mfma_f32_16x16x32_bf16 v[172:175], v[228:231], v[100:103], v[172:175]
    ds_read_b64_tr_b16 v[226:227], v1 offset:17152
    s_add_u32 m0, s52, 49152
    s_add_u32 s59, s53, 4128768
    buffer_load_dwordx4 v4, s[28:31], s59 offen nt lds
    s_waitcnt lgkmcnt(6)
    v_mfma_f32_16x16x32_bf16 v[176:179], v[232:235], v[96:99], v[176:179]
    ds_read_b64_tr_b16 v[228:229], v2 offset:16896
    v_mfma_f32_16x16x32_bf16 v[252:255], v[96:99], v[96:99], v[252:255]
    v_mfma_f32_16x16x32_bf16 v[180:183], v[232:235], v[100:103], v[180:183]
    ds_read_b64_tr_b16 v[230:231], v2 offset:17152
    s_waitcnt lgkmcnt(4)
    v_mfma_f32_16x16x32_bf16 v[244:247], v[240:243], v[8:11], v[244:247]
    v_mfma_f32_16x16x32_bf16 v[184:187], v[236:239], v[96:99], v[184:187]
    ds_read_b64_tr_b16 v[232:233], v1 offset:25088
    s_add_u32 m0, s56, 128
    s_nop 0
    buffer_load_dwordx4 v13, s[24:27], s51 offen offset:896 lds
    v_mfma_f32_16x16x32_bf16 v[188:191], v[236:239], v[100:103], v[188:191]
    ds_read_b64_tr_b16 v[234:235], v1 offset:25344
    s_waitcnt lgkmcnt(4)
    v_mfma_f32_16x16x32_bf16 v[192:195], v[224:227], v[96:99], v[192:195]
    ds_read_b64_tr_b16 v[236:237], v2 offset:25088
    v_mfma_f32_16x16x32_bf16 v[196:199], v[224:227], v[100:103], v[196:199]
    ds_read_b64_tr_b16 v[238:239], v2 offset:25344
    ds_read_b64_tr_b16 v[8:9], v3 offset:20480
    ds_read_b64_tr_b16 v[10:11], v3 offset:20736
    s_waitcnt lgkmcnt(6)
    v_mfma_f32_16x16x32_bf16 v[200:203], v[228:231], v[96:99], v[200:203]
    ds_read_b64_tr_b16 v[224:225], v1 offset:20480
    v_mfma_f32_16x16x32_bf16 v[204:207], v[228:231], v[100:103], v[204:207]
    ds_read_b64_tr_b16 v[226:227], v1 offset:20736
    s_waitcnt lgkmcnt(6)
    v_mfma_f32_16x16x32_bf16 v[208:211], v[232:235], v[96:99], v[208:211]
    ds_read_b64_tr_b16 v[228:229], v2 offset:20480
    s_add_u32 m0, s56, 1024
    s_nop 0
    buffer_load_dwordx4 v12, s[24:27], s48 offen offset:1024 lds
    v_mfma_f32_16x16x32_bf16 v[212:215], v[232:235], v[100:103], v[212:215]
    ds_read_b64_tr_b16 v[230:231], v2 offset:20736
    s_waitcnt lgkmcnt(4)
    v_mfma_f32_16x16x32_bf16 v[244:247], v[240:243], v[8:11], v[244:247]
    v_mfma_f32_16x16x32_bf16 v[216:219], v[236:239], v[96:99], v[216:219]
    ds_read_b64_tr_b16 v[232:233], v1 offset:28672
    v_mfma_f32_16x16x32_bf16 v[220:223], v[236:239], v[100:103], v[220:223]
    ds_read_b64_tr_b16 v[234:235], v1 offset:28928
    s_add_u32 m0, s52, 53248
    s_add_u32 s59, s53, 4423680
    buffer_load_dwordx4 v4, s[28:31], s59 offen nt lds
    s_waitcnt lgkmcnt(4)
    v_mfma_f32_16x16x32_bf16 v[160:163], v[224:227], v[104:107], v[160:163]
    ds_read_b64_tr_b16 v[236:237], v2 offset:28672
    v_mfma_f32_16x16x32_bf16 v[164:167], v[224:227], v[108:111], v[164:167]
    ds_read_b64_tr_b16 v[238:239], v2 offset:28928
    s_waitcnt lgkmcnt(4)
    v_mfma_f32_16x16x32_bf16 v[168:171], v[228:231], v[104:107], v[168:171]
    ds_read_b64_tr_b16 v[224:225], v1 offset:20992
    s_waitcnt vmcnt(12)
    ds_read_b128 v[112:115], v14 offset:4096
    s_add_u32 m0, s56, 2048
    s_nop 0
    buffer_load_dwordx4 v13, s[24:27], s49 offen offset:1024 lds
    v_mfma_f32_16x16x32_bf16 v[248:251], v[240:243], v[104:107], v[248:251]
    v_mfma_f32_16x16x32_bf16 v[172:175], v[228:231], v[108:111], v[172:175]
    ds_read_b64_tr_b16 v[226:227], v1 offset:21248
    ds_read_b128 v[120:123], v15 offset:4096
    s_waitcnt lgkmcnt(6)
    v_mfma_f32_16x16x32_bf16 v[176:179], v[232:235], v[104:107], v[176:179]
    ds_read_b64_tr_b16 v[228:229], v2 offset:20992
    s_waitcnt vmcnt(9)
    ds_read_b128 v[116:119], v14 offset:6144
    s_mul_i32 s54, s45, 72
    s_and_b32 s55, s44, 3
    s_mul_i32 s55, s55, 18
    s_add_u32 s54, s54, s55
    s_mul_i32 s59, s54, 9216
    s_lshl_b32 s55, s46, 8
    s_add_u32 s59, s59, s55
    s_bfe_u32 s55, s46, 65536
    s_lshl_b32 s55, s55, 7
    s_sub_u32 s59, s59, s55
    s_add_u32 s59, s59, 128
    v_mul_u32_u24 v5, 576, v0
    s_mov_b32 m0, 158208
    s_mov_b64 exec, 0x1ff
    buffer_load_dword v5, s[28:31], s59 offen lds
    s_mov_b64 exec, -1
    v_mfma_f32_16x16x32_bf16 v[252:255], v[104:107], v[104:107], v[252:255]
    v_mfma_f32_16x16x32_bf16 v[180:183], v[232:235], v[108:111], v[180:183]
    ds_read_b64_tr_b16 v[230:231], v2 offset:21248
    ds_read_b128 v[124:127], v15 offset:6144
    s_waitcnt lgkmcnt(8)
    v_mfma_f32_16x16x32_bf16 v[184:187], v[236:239], v[104:107], v[184:187]
    ds_read_b64_tr_b16 v[232:233], v1 offset:29184
    v_mfma_f32_16x16x32_bf16 v[188:191], v[236:239], v[108:111], v[188:191]
    ds_read_b64_tr_b16 v[234:235], v1 offset:29440
    s_waitcnt lgkmcnt(7)
    v_mfma_f32_16x16x32_bf16 v[192:195], v[224:227], v[104:107], v[192:195]
    ds_read_b64_tr_b16 v[236:237], v2 offset:29184
    v_mfma_f32_16x16x32_bf16 v[196:199], v[224:227], v[108:111], v[196:199]
    ds_read_b64_tr_b16 v[238:239], v2 offset:29440
    s_waitcnt vmcnt(8)
    s_barrier
    s_waitcnt lgkmcnt(5)
    v_mfma_f32_16x16x32_bf16 v[200:203], v[228:231], v[104:107], v[200:203]
    ds_read_b64_tr_b16 v[224:225], v1 offset:32768
    s_add_u32 m0, s56, 3072
    s_nop 0
    buffer_load_dwordx4 v12, s[24:27], s50 offen offset:1024 lds
    v_mfma_f32_16x16x32_bf16 v[204:207], v[228:231], v[108:111], v[204:207]
    ds_read_b64_tr_b16 v[226:227], v1 offset:33024
    s_waitcnt lgkmcnt(4)
    v_mfma_f32_16x16x32_bf16 v[208:211], v[232:235], v[104:107], v[208:211]
    ds_read_b64_tr_b16 v[228:229], v2 offset:32768
    s_add_u32 m0, s56, 4096
    s_nop 0
    buffer_load_dwordx4 v13, s[24:27], s51 offen offset:1024 lds
    s_add_u32 m0, s52, 0
    s_add_u32 s59, s53, 4718592
    buffer_load_dwordx4 v4, s[28:31], s59 offen nt lds
    v_mfma_f32_16x16x32_bf16 v[212:215], v[232:235], v[108:111], v[212:215]
    ds_read_b64_tr_b16 v[230:231], v2 offset:33024
    s_waitcnt lgkmcnt(4)
    v_mfma_f32_16x16x32_bf16 v[216:219], v[236:239], v[104:107], v[216:219]
    ds_read_b64_tr_b16 v[232:233], v1 offset:40960
    v_mfma_f32_16x16x32_bf16 v[220:223], v[236:239], v[108:111], v[220:223]
    ds_read_b64_tr_b16 v[234:235], v1 offset:41216
    s_add_u32 m0, s52, 4096
    s_add_u32 s59, s53, 5013504
    buffer_load_dwordx4 v4, s[28:31], s59 offen nt lds
    s_waitcnt lgkmcnt(4)
    v_mfma_f32_16x16x32_bf16 v[160:163], v[224:227], v[112:115], v[160:163]
    ds_read_b64_tr_b16 v[236:237], v2 offset:40960
    v_mfma_f32_16x16x32_bf16 v[164:167], v[224:227], v[116:119], v[164:167]
    ds_read_b64_tr_b16 v[238:239], v2 offset:41216
    ds_read_b64_tr_b16 v[8:9], v3 offset:32768
    ds_read_b64_tr_b16 v[10:11], v3 offset:33024
    s_waitcnt lgkmcnt(6)
    v_mfma_f32_16x16x32_bf16 v[168:171], v[228:231], v[112:115], v[168:171]
    ds_read_b64_tr_b16 v[224:225], v1 offset:33280
    v_mfma_f32_16x16x32_bf16 v[248:251], v[240:243], v[112:115], v[248:251]
    v_mfma_f32_16x16x32_bf16 v[172:175], v[228:231], v[116:119], v[172:175]
    ds_read_b64_tr_b16 v[226:227], v1 offset:33536
    s_waitcnt lgkmcnt(6)
    v_mfma_f32_16x16x32_bf16 v[176:179], v[232:235], v[112:115], v[176:179]
    ds_read_b64_tr_b16 v[228:229], v2 offset:33280
    v_mfma_f32_16x16x32_bf16 v[252:255], v[112:115], v[112:115], v[252:255]
    v_mfma_f32_16x16x32_bf16 v[180:183], v[232:235], v[116:119], v[180:183]
    ds_read_b64_tr_b16 v[230:231], v2 offset:33536
    s_waitcnt lgkmcnt(4)
    v_mfma_f32_16x16x32_bf16 v[244:247], v[240:243], v[8:11], v[244:247]
    v_mfma_f32_16x16x32_bf16 v[184:187], v[236:239], v[112:115], v[184:187]
    ds_read_b64_tr_b16 v[232:233], v1 offset:41472
    v_mfma_f32_16x16x32_bf16 v[188:191], v[236:239], v[116:119], v[188:191]
    ds_read_b64_tr_b16 v[234:235], v1 offset:41728
    s_waitcnt lgkmcnt(4)
    v_mfma_f32_16x16x32_bf16 v[192:195], v[224:227], v[112:115], v[192:195]
    ds_read_b64_tr_b16 v[236:237], v2 offset:41472
    v_mfma_f32_16x16x32_bf16 v[196:199], v[224:227], v[116:119], v[196:199]
    ds_read_b64_tr_b16 v[238:239], v2 offset:41728
    ds_read_b64_tr_b16 v[8:9], v3 offset:36864
    ds_read_b64_tr_b16 v[10:11], v3 offset:37120
    s_waitcnt lgkmcnt(6)
    v_mfma_f32_16x16x32_bf16 v[200:203], v[228:231], v[112:115], v[200:203]
    ds_read_b64_tr_b16 v[224:225], v1 offset:36864
    v_mfma_f32_16x16x32_bf16 v[204:207], v[228:231], v[116:119], v[204:207]
    ds_read_b64_tr_b16 v[226:227], v1 offset:37120
    s_waitcnt lgkmcnt(6)
    v_mfma_f32_16x16x32_bf16 v[208:211], v[232:235], v[112:115], v[208:211]
    ds_read_b64_tr_b16 v[228:229], v2 offset:36864
    v_mfma_f32_16x16x32_bf16 v[212:215], v[232:235], v[116:119], v[212:215]
    ds_read_b64_tr_b16 v[230:231], v2 offset:37120
    s_waitcnt lgkmcnt(4)
    v_mfma_f32_16x16x32_bf16 v[244:247], v[240:243], v[8:11], v[244:247]
    v_mfma_f32_16x16x32_bf16 v[216:219], v[236:239], v[112:115], v[216:219]
    ds_read_b64_tr_b16 v[232:233], v1 offset:45056
    v_mfma_f32_16x16x32_bf16 v[220:223], v[236:239], v[116:119], v[220:223]
    ds_read_b64_tr_b16 v[234:235], v1 offset:45312
    s_waitcnt lgkmcnt(4)
    v_mfma_f32_16x16x32_bf16 v[160:163], v[224:227], v[120:123], v[160:163]
    ds_read_b64_tr_b16 v[236:237], v2 offset:45056
    v_mfma_f32_16x16x32_bf16 v[164:167], v[224:227], v[124:127], v[164:167]
    ds_read_b64_tr_b16 v[238:239], v2 offset:45312
    s_waitcnt lgkmcnt(4)
    v_mfma_f32_16x16x32_bf16 v[168:171], v[228:231], v[120:123], v[168:171]
    ds_read_b64_tr_b16 v[224:225], v1 offset:37376
    s_waitcnt vmcnt(11)
    ds_read_b128 v[128:131], v14 offset:8192
    s_mul_i32 s54, s45, 72
    s_and_b32 s55, s44, 3
    s_mul_i32 s55, s55, 18
    s_add_u32 s54, s54, s55
    s_mul_i32 s59, s54, 9216
    s_lshl_b32 s55, s46, 8
    s_add_u32 s59, s59, s55
    s_bfe_u32 s55, s46, 65536
    s_lshl_b32 s55, s55, 7
    s_sub_u32 s59, s59, s55
    s_add_u32 s59, s59, 83072
    v_mul_u32_u24 v5, 576, v0
    s_mov_b32 m0, 158208
    s_mov_b64 exec, 0x1ff
    buffer_load_dword v5, s[28:31], s59 offen lds
    s_mov_b64 exec, -1
    v_mfma_f32_16x16x32_bf16 v[248:251], v[240:243], v[120:123], v[248:251]
    v_mfma_f32_16x16x32_bf16 v[172:175], v[228:231], v[124:127], v[172:175]
    ds_read_b64_tr_b16 v[226:227], v1 offset:37632
    ds_read_b128 v[136:139], v15 offset:8192
    s_waitcnt lgkmcnt(6)
    v_mfma_f32_16x16x32_bf16 v[176:179], v[232:235], v[120:123], v[176:179]
    ds_read_b64_tr_b16 v[228:229], v2 offset:37376
    s_waitcnt vmcnt(9)
    ds_read_b128 v[132:135], v14 offset:0
    v_mfma_f32_16x16x32_bf16 v[252:255], v[120:123], v[120:123], v[252:255]
    v_mfma_f32_16x16x32_bf16 v[180:183], v[232:235], v[124:127], v[180:183]
    ds_read_b64_tr_b16 v[230:231], v2 offset:37632
    ds_read_b128 v[140:143], v15 offset:0
    s_waitcnt lgkmcnt(8)
    v_mfma_f32_16x16x32_bf16 v[184:187], v[236:239], v[120:123], v[184:187]
    ds_read_b64_tr_b16 v[232:233], v1 offset:45568
    v_mfma_f32_16x16x32_bf16 v[188:191], v[236:239], v[124:127], v[188:191]
    ds_read_b64_tr_b16 v[234:235], v1 offset:45824
    s_waitcnt lgkmcnt(7)
    v_mfma_f32_16x16x32_bf16 v[192:195], v[224:227], v[120:123], v[192:195]
    ds_read_b64_tr_b16 v[236:237], v2 offset:45568
    v_mfma_f32_16x16x32_bf16 v[196:199], v[224:227], v[124:127], v[196:199]
    ds_read_b64_tr_b16 v[238:239], v2 offset:45824
    s_waitcnt vmcnt(7)
    s_barrier
    s_waitcnt lgkmcnt(5)
    v_mfma_f32_16x16x32_bf16 v[200:203], v[228:231], v[120:123], v[200:203]
    ds_read_b64_tr_b16 v[224:225], v1 offset:49152
    v_mfma_f32_16x16x32_bf16 v[204:207], v[228:231], v[124:127], v[204:207]
    ds_read_b64_tr_b16 v[226:227], v1 offset:49408
    s_waitcnt lgkmcnt(4)
    v_mfma_f32_16x16x32_bf16 v[208:211], v[232:235], v[120:123], v[208:211]
    ds_read_b64_tr_b16 v[228:229], v2 offset:49152
    v_mfma_f32_16x16x32_bf16 v[212:215], v[232:235], v[124:127], v[212:215]
    ds_read_b64_tr_b16 v[230:231], v2 offset:49408
    s_waitcnt lgkmcnt(4)
    v_mfma_f32_16x16x32_bf16 v[216:219], v[236:239], v[120:123], v[216:219]
    ds_read_b64_tr_b16 v[232:233], v1 offset:57344
    v_lshrrev_b32 v5, 6, v0
    v_mul_u32_u24 v4, 9216, v5
    v_lshrrev_b32 v5, 4, v0
    v_xor_b32 v5, v5, v0
    v_and_b32 v5, 0x20, v5
    v_add_u32 v4, v4, v5
    v_and_b32 v5, 0x10, v0
    v_add_u32 v4, v4, v5
    s_and_b32 s54, s44, 3
    s_lshr_b32 s55, s44, 2
    s_mul_i32 s52, s55, 12288
    s_lshl_b32 s55, s54, 10
    s_add_u32 s52, s52, s55
    s_mul_i32 s53, s54, 147456
    s_lshl_b32 s55, s46, 8
    s_add_u32 s53, s53, s55
    s_bfe_u32 s55, s46, 65536
    s_lshl_b32 s55, s55, 7
    s_sub_u32 s53, s53, s55
    v_mfma_f32_16x16x32_bf16 v[220:223], v[236:239], v[124:127], v[220:223]
    ds_read_b64_tr_b16 v[234:235], v1 offset:57600
    s_waitcnt lgkmcnt(4)
    v_mfma_f32_16x16x32_bf16 v[160:163], v[224:227], v[128:131], v[160:163]
    ds_read_b64_tr_b16 v[236:237], v2 offset:57344
    ds_read_b64_tr_b16 v[8:9], v3 offset:49152
    ds_read_b64_tr_b16 v[10:11], v3 offset:49408
    v_mfma_f32_16x16x32_bf16 v[164:167], v[224:227], v[132:135], v[164:167]
    ds_read_b64_tr_b16 v[238:239], v2 offset:57600
    s_waitcnt lgkmcnt(6)
    v_mfma_f32_16x16x32_bf16 v[168:171], v[228:231], v[128:131], v[168:171]
    ds_read_b64_tr_b16 v[224:225], v1 offset:53248
    s_waitcnt vmcnt(6)
    ds_read_b128 v[144:147], v14 offset:2048
    v_mfma_f32_16x16x32_bf16 v[248:251], v[240:243], v[128:131], v[248:251]
    v_mfma_f32_16x16x32_bf16 v[172:175], v[228:231], v[132:135], v[172:175]
    ds_read_b64_tr_b16 v[226:227], v1 offset:53504
    ds_read_b128 v[152:155], v15 offset:2048
    s_waitcnt lgkmcnt(8)
    v_mfma_f32_16x16x32_bf16 v[176:179], v[232:235], v[128:131], v[176:179]
    ds_read_b64_tr_b16 v[228:229], v2 offset:53248
    s_waitcnt vmcnt(3)
    ds_read_b128 v[148:151], v14 offset:4096
    v_mfma_f32_16x16x32_bf16 v[252:255], v[128:131], v[128:131], v[252:255]
    s_waitcnt lgkmcnt(7)
    v_mfma_f32_16x16x32_bf16 v[244:247], v[240:243], v[8:11], v[244:247]
    v_mfma_f32_16x16x32_bf16 v[180:183], v[232:235], v[132:135], v[180:183]
    ds_read_b64_tr_b16 v[230:231], v2 offset:53504
    ds_read_b128 v[156:159], v15 offset:4096
    ds_read_b64_tr_b16 v[8:9], v3 offset:53248
    ds_read_b64_tr_b16 v[10:11], v3 offset:53504
    s_waitcnt lgkmcnt(10)
    v_mfma_f32_16x16x32_bf16 v[184:187], v[236:239], v[128:131], v[184:187]
    ds_read_b64_tr_b16 v[232:233], v1 offset:61440
    v_mfma_f32_16x16x32_bf16 v[188:191], v[236:239], v[132:135], v[188:191]
    ds_read_b64_tr_b16 v[234:235], v1 offset:61696
    s_waitcnt lgkmcnt(9)
    v_mfma_f32_16x16x32_bf16 v[160:163], v[224:227], v[136:139], v[160:163]
    ds_read_b64_tr_b16 v[236:237], v2 offset:61440
    v_mfma_f32_16x16x32_bf16 v[164:167], v[224:227], v[140:143], v[164:167]
    ds_read_b64_tr_b16 v[238:239], v2 offset:61696
    s_waitcnt lgkmcnt(4)
    v_mfma_f32_16x16x32_bf16 v[244:247], v[240:243], v[8:11], v[244:247]
    s_waitcnt vmcnt(1)
    s_barrier
    v_mfma_f32_16x16x32_bf16 v[168:171], v[228:231], v[136:139], v[168:171]
    ds_read_b64_tr_b16 v[224:225], v1 offset:0
    v_mfma_f32_16x16x32_bf16 v[248:251], v[240:243], v[136:139], v[248:251]
    v_mfma_f32_16x16x32_bf16 v[172:175], v[228:231], v[140:143], v[172:175]
    ds_read_b64_tr_b16 v[226:227], v1 offset:256
    ds_read_b64_tr_b16 v[8:9], v3 offset:0
    ds_read_b64_tr_b16 v[10:11], v3 offset:256
    s_waitcnt lgkmcnt(6)
    v_mfma_f32_16x16x32_bf16 v[176:179], v[232:235], v[136:139], v[176:179]
    ds_read_b64_tr_b16 v[228:229], v2 offset:0
    v_mfma_f32_16x16x32_bf16 v[252:255], v[136:139], v[136:139], v[252:255]
    s_cmp_eq_u32 s34, 20736
    s_cbranch_scc1 KA_S0K
    v_lshrrev_b32 v5, 6, v0
    v_mul_u32_u24 v5, 1152, v5
    v_and_or_b32 v5, v4, 48, v5
    s_mul_i32 s59, s44, 18432
    s_lshl_b32 s55, s47, 6
    s_add_u32 s59, s59, s55
    s_add_u32 s59, s59, 0
    s_lshl_b32 s54, s44, 10
    s_add_u32 m0, s54, 86016
    s_cmp_gt_u32 s44, 3
    buffer_load_dwordx4 v5, s[32:35], s59 offen lds
    s_cbranch_scc1 KA_S0E
    s_add_u32 m0, s54, 94208
    s_add_u32 s59, s59, 147456
    buffer_load_dwordx4 v5, s[32:35], s59 offen lds
    s_branch KA_S0E
KA_S0K:
    s_lshl_b32 s55, s44, 4
    s_and_b32 s55, s55, 32
    v_lshrrev_b32 v5, 2, v0
    v_and_b32 v5, 60, v5
    v_xor_b32 v5, s55, v5
    v_cmp_gt_u32 vcc, 36, v5
    v_mov_b32 v7, 0x7fffff00
    s_mul_i32 s60, s44, 144
    v_cndmask_b32 v5, v7, v5, vcc
    v_lshrrev_b32 v7, 8, v0
    v_mad_u32_u24 v5, v7, 36, v5
    s_lshl_b32 s54, s44, 8
    s_add_u32 m0, s54, 86016
    s_add_u32 s59, s60, 0
    buffer_load_dword v5, s[32:35], s59 offen lds
    s_add_u32 m0, s54, 88064
    s_add_u32 s59, s60, 1152
    buffer_load_dword v5, s[32:35], s59 offen lds
    s_add_u32 m0, s54, 90112
    s_add_u32 s59, s60, 2304
    buffer_load_dword v5, s[32:35], s59 offen lds
    s_add_u32 m0, s54, 92160
    s_add_u32 s59, s60, 3456
    buffer_load_dword v5, s[32:35], s59 offen lds
    s_add_u32 m0, s54, 94208
    s_add_u32 s59, s60, 4608
    buffer_load_dword v5, s[32:35], s59 offen lds
    s_add_u32 m0, s54, 96256
    s_add_u32 s59, s60, 5760
    buffer_load_dword v5, s[32:35], s59 offen lds
KA_S0E:
    v_mfma_f32_16x16x32_bf16 v[180:183], v[232:235], v[140:143], v[180:183]
    ds_read_b64_tr_b16 v[230:231], v2 offset:256
    s_waitcnt lgkmcnt(6)
    v_mfma_f32_16x16x32_bf16 v[184:187], v[236:239], v[136:139], v[184:187]
    ds_read_b64_tr_b16 v[232:233], v1 offset:8192
    v_mfma_f32_16x16x32_bf16 v[188:191], v[236:239], v[140:143], v[188:191]
    ds_read_b64_tr_b16 v[234:235], v1 offset:8448
    s_waitcnt lgkmcnt(4)
    v_mfma_f32_16x16x32_bf16 v[244:247], v[240:243], v[8:11], v[244:247]
    v_mfma_f32_16x16x32_bf16 v[160:163], v[224:227], v[144:147], v[160:163]
    ds_read_b64_tr_b16 v[236:237], v2 offset:8192
    ds_read_b64_tr_b16 v[8:9], v3 offset:4096
    ds_read_b64_tr_b16 v[10:11], v3 offset:4352
    v_mfma_f32_16x16x32_bf16 v[164:167], v[224:227], v[148:151], v[164:167]
    ds_read_b64_tr_b16 v[238:239], v2 offset:8448
    s_and_b32 s54, s44, 3
    s_mul_i32 s59, s54, 147456
    s_lshl_b32 s55, s46, 5
    s_add_u32 s59, s59, s55
    s_add_u32 s59, s59, 8192
    s_lshl_b32 s54, s54, 10
    s_add_u32 m0, s54, 73728
    v_and_b32 v5, 0xffffffdf, v4
    s_mov_b64 exec, s[14:15]
    buffer_load_dwordx4 v5, s[28:31], s59 offen lds
    s_mov_b64 exec, -1
    s_waitcnt lgkmcnt(6)
    v_mfma_f32_16x16x32_bf16 v[168:171], v[228:231], v[144:147], v[168:171]
    ds_read_b64_tr_b16 v[224:225], v1 offset:4096
    v_mfma_f32_16x16x32_bf16 v[248:251], v[240:243], v[144:147], v[248:251]
    v_mfma_f32_16x16x32_bf16 v[172:175], v[228:231], v[148:151], v[172:175]
    ds_read_b64_tr_b16 v[226:227], v1 offset:4352
    s_waitcnt lgkmcnt(6)
    v_mfma_f32_16x16x32_bf16 v[176:179], v[232:235], v[144:147], v[176:179]
    ds_read_b64_tr_b16 v[228:229], v2 offset:4096
    v_mfma_f32_16x16x32_bf16 v[252:255], v[144:147], v[144:147], v[252:255]
    s_waitcnt lgkmcnt(4)
    v_mfma_f32_16x16x32_bf16 v[244:247], v[240:243], v[8:11], v[244:247]
    v_mfma_f32_16x16x32_bf16 v[180:183], v[232:235], v[148:151], v[180:183]
    ds_read_b64_tr_b16 v[230:231], v2 offset:4352
    s_waitcnt lgkmcnt(4)
    v_mfma_f32_16x16x32_bf16 v[184:187], v[236:239], v[144:147], v[184:187]
    ds_read_b64_tr_b16 v[232:233], v1 offset:12288
    s_and_b32 s54, s44, 3
    s_mul_i32 s59, s54, 147456
    s_lshl_b32 s55, s46, 5
    s_add_u32 s59, s59, s55
    s_add_u32 s59, s59, 598016
    s_lshl_b32 s54, s54, 10
    s_add_u32 m0, s54, 77824
    v_and_b32 v5, 0xffffffdf, v4
    s_mov_b64 exec, s[14:15]
    buffer_load_dwordx4 v5, s[28:31], s59 offen lds
    s_mov_b64 exec, -1
    v_mfma_f32_16x16x32_bf16 v[188:191], v[236:239], v[148:151], v[188:191]
    ds_read_b64_tr_b16 v[234:235], v1 offset:12544
    s_waitcnt lgkmcnt(4)
    v_mfma_f32_16x16x32_bf16 v[160:163], v[224:227], v[152:155], v[160:163]
    ds_read_b64_tr_b16 v[236:237], v2 offset:12288
    v_mfma_f32_16x16x32_bf16 v[164:167], v[224:227], v[156:159], v[164:167]
    ds_read_b64_tr_b16 v[238:239], v2 offset:12544
    s_waitcnt lgkmcnt(4)
    v_mfma_f32_16x16x32_bf16 v[168:171], v[228:231], v[152:155], v[168:171]
    ds_read_b64_tr_b16 v[224:225], v1 offset:49664
    v_mfma_f32_16x16x32_bf16 v[248:251], v[240:243], v[152:155], v[248:251]
    v_lshrrev_b32 v5, 2, v0
    s_lshl_b32 s54, s44, 6
    s_add_u32 s54, s54, 155648
    v_add_u32 v5, s54, v5
    s_mov_b64 exec, 0xffff
    ds_write_b32 v5, v244
    s_mov_b64 exec, -1
    v_mfma_f32_16x16x32_bf16 v[172:175], v[228:231], v[156:159], v[172:175]
    ds_read_b64_tr_b16 v[226:227], v1 offset:49920
    s_and_b32 s54, s44, 3
    s_mul_i32 s59, s54, 147456
    s_lshl_b32 s55, s46, 5
    s_add_u32 s59, s59, s55
    s_add_u32 s59, s59, 1187840
    s_lshl_b32 s54, s54, 10
    s_add_u32 m0, s54, 81920
    v_and_b32 v5, 0xffffffdf, v4
    s_mov_b64 exec, s[14:15]
    buffer_load_dwordx4 v5, s[28:31], s59 offen lds
    s_mov_b64 exec, -1
    s_waitcnt lgkmcnt(5)
    v_mfma_f32_16x16x32_bf16 v[176:179], v[232:235], v[152:155], v[176:179]
    ds_read_b64_tr_b16 v[228:229], v2 offset:49664
    v_mfma_f32_16x16x32_bf16 v[252:255], v[152:155], v[152:155], v[252:255]
    v_mfma_f32_16x16x32_bf16 v[180:183], v[232:235], v[156:159], v[180:183]
    ds_read_b64_tr_b16 v[230:231], v2 offset:49920
    s_waitcnt lgkmcnt(5)
    v_mfma_f32_16x16x32_bf16 v[184:187], v[236:239], v[152:155], v[184:187]
    ds_read_b64_tr_b16 v[232:233], v1 offset:57856
    v_mfma_f32_16x16x32_bf16 v[188:191], v[236:239], v[156:159], v[188:191]
    ds_read_b64_tr_b16 v[234:235], v1 offset:58112
    s_waitcnt lgkmcnt(5)
    s_barrier
    v_mfma_f32_16x16x32_bf16 v[8:11], v[240:243], v[20:23], 0
    v_mul_f32 v12, 0xbae38e39, v248
    s_mov_b32 vcc_lo, 0x100001
    s_mov_b32 vcc_hi, 0x10000100
    v_cndmask_b32 v14, 0, v252, vcc
    v_mfma_f32_16x16x32_bf16 v[244:247], v[20:23], v[20:23], 0
    s_cmp_eq_u32 s34, 20736
    s_cbranch_scc1 KA_S1K
    v_lshrrev_b32 v5, 6, v0
    v_mul_u32_u24 v5, 1152, v5
    v_and_or_b32 v5, v4, 48, v5
    s_mul_i32 s59, s44, 18432
    s_lshl_b32 s55, s47, 6
    s_add_u32 s59, s59, s55
    s_add_u32 s59, s59, 221184
    s_lshl_b32 s54, s44, 10
    s_add_u32 m0, s54, 110592
    s_cmp_gt_u32 s44, 3
    buffer_load_dwordx4 v5, s[32:35], s59 offen lds
    s_cbranch_scc1 KA_S1E
    s_add_u32 m0, s54, 118784
    s_add_u32 s59, s59, 147456
    buffer_load_dwordx4 v5, s[32:35], s59 offen lds
    s_branch KA_S1E
KA_S1K:
    s_lshl_b32 s55, s44, 4
    s_and_b32 s55, s55, 32
    v_lshrrev_b32 v5, 2, v0
    v_and_b32 v5, 60, v5
    v_xor_b32 v5, s55, v5
    v_cmp_gt_u32 vcc, 36, v5
    v_mov_b32 v7, 0x7fffff00
    s_mul_i32 s60, s44, 144
    v_cndmask_b32 v5, v7, v5, vcc
    v_lshrrev_b32 v7, 8, v0
    v_mad_u32_u24 v5, v7, 36, v5
    s_lshl_b32 s54, s44, 8
    s_add_u32 m0, s54, 110592
    s_add_u32 s59, s60, 6912
    buffer_load_dword v5, s[32:35], s59 offen lds
    s_add_u32 m0, s54, 112640
    s_add_u32 s59, s60, 8064
    buffer_load_dword v5, s[32:35], s59 offen lds
    s_add_u32 m0, s54, 114688
    s_add_u32 s59, s60, 9216
    buffer_load_dword v5, s[32:35], s59 offen lds
    s_add_u32 m0, s54, 116736
    s_add_u32 s59, s60, 10368
    buffer_load_dword v5, s[32:35], s59 offen lds
    s_add_u32 m0, s54, 118784
    s_add_u32 s59, s60, 11520
    buffer_load_dword v5, s[32:35], s59 offen lds
    s_add_u32 m0, s54, 120832
    s_add_u32 s59, s60, 12672
    buffer_load_dword v5, s[32:35], s59 offen lds
KA_S1E:
    s_mov_b32 vcc_lo, 0x200002
    s_mov_b32 vcc_hi, 0x20000200
    v_cndmask_b32 v14, v14, v253, vcc
    s_mov_b32 vcc_lo, 0x400004
    s_mov_b32 vcc_hi, 0x40000400
    v_cndmask_b32 v14, v14, v254, vcc
    v_mfma_f32_16x16x32_bf16 v[8:11], v[240:243], v[28:31], v[8:11]
    s_mov_b32 vcc_lo, 0x800008
    s_mov_b32 vcc_hi, 0x80000800
    v_cndmask_b32 v14, v14, v255, vcc
    v_mov_b32 v6, v14
    s_nop 1
    v_mfma_f32_16x16x32_bf16 v[244:247], v[28:31], v[28:31], v[244:247]
    v_permlane32_swap_b32 v6, v14
    s_nop 1
    v_mfma_f32_16x16x32_bf16 v[8:11], v[240:243], v[36:39], v[8:11]
    v_add_f32 v14, v6, v14
    v_mov_b32 v6, v14
    v_mfma_f32_16x16x32_bf16 v[244:247], v[36:39], v[36:39], v[244:247]
    s_nop 1
    v_permlane16_swap_b32 v6, v14
    s_nop 1
    v_mfma_f32_16x16x32_bf16 v[8:11], v[240:243], v[44:47], v[8:11]
    v_add_f32 v14, v6, v14
    v_mul_f32 v6, v12, v12
    v_mfma_f32_16x16x32_bf16 v[244:247], v[44:47], v[44:47], v[244:247]
    v_mul_f32 v14, 0x3ae38e39, v14
    v_sub_f32 v14, v14, v6
    v_mfma_f32_16x16x32_bf16 v[8:11], v[240:243], v[52:55], v[8:11]
    s_and_b32 s54, s44, 3
    s_mul_i32 s59, s54, 147456
    s_lshl_b32 s55, s46, 5
    s_add_u32 s59, s59, s55
    s_add_u32 s59, s59, 1777664
    s_lshl_b32 s54, s54, 10
    s_add_u32 m0, s54, 98304
    v_and_b32 v5, 0xffffffdf, v4
    s_mov_b64 exec, s[14:15]
    buffer_load_dwordx4 v5, s[28:31], s59 offen lds
    s_mov_b64 exec, -1
    v_max_f32 v14, 0, v14
    v_add_f32 v6, 0x3727c5ac, v14
    v_rsq_f32 v14, v6
    v_mfma_f32_16x16x32_bf16 v[244:247], v[52:55], v[52:55], v[244:247]
    s_nop 0
    v_mul_f32 v14, 0xbfb8aa3b, v14
    v_mfma_f32_16x16x32_bf16 v[8:11], v[240:243], v[60:63], v[8:11]
    v_lshrrev_b32 v5, 4, v0
    v_and_b32 v5, 48, v5
    v_add_u32 v5, 155648, v5
    ds_read_b128 v[248:251], v5 offset:0
    ds_read_b128 v[252:255], v5 offset:128
    v_mfma_f32_16x16x32_bf16 v[244:247], v[60:63], v[60:63], v[244:247]
    v_mfma_f32_16x16x32_bf16 v[8:11], v[240:243], v[68:71], v[8:11]
    s_waitcnt lgkmcnt(0)
    v_mfma_f32_16x16x32_bf16 v[244:247], v[68:71], v[68:71], v[244:247]
    v_fma_f32 v160, v12, v248, v160
    v_fma_f32 v161, v12, v249, v161
    v_fma_f32 v162, v12, v250, v162
    v_mfma_f32_16x16x32_bf16 v[8:11], v[240:243], v[76:79], v[8:11]
    v_fma_f32 v163, v12, v251, v163
    v_fma_f32 v176, v12, v252, v176
    v_mfma_f32_16x16x32_bf16 v[244:247], v[76:79], v[76:79], v[244:247]
    s_and_b32 s54, s44, 3
    s_mul_i32 s59, s54, 147456
    s_lshl_b32 s55, s46, 5
    s_add_u32 s59, s59, s55
    s_add_u32 s59, s59, 2367488
    s_lshl_b32 s54, s54, 10
    s_add_u32 m0, s54, 102400
    v_and_b32 v5, 0xffffffdf, v4
    s_mov_b64 exec, s[14:15]
    buffer_load_dwordx4 v5, s[28:31], s59 offen lds
    s_mov_b64 exec, -1
    v_fma_f32 v177, v12, v253, v177
    v_fma_f32 v178, v12, v254, v178
    v_mfma_f32_16x16x32_bf16 v[8:11], v[240:243], v[84:87], v[8:11]
    v_fma_f32 v179, v12, v255, v179
    v_mul_f32 v176, v160, v176
    v_mul_f32 v177, v161, v177
    v_mfma_f32_16x16x32_bf16 v[244:247], v[84:87], v[84:87], v[244:247]
    v_mul_f32 v178, v162, v178
    v_mul_f32 v179, v163, v179
    v_mfma_f32_16x16x32_bf16 v[8:11], v[240:243], v[92:95], v[8:11]
    v_mul_f32 v160, v14, v160
    v_mul_f32 v161, v14, v161
    v_mfma_f32_16x16x32_bf16 v[244:247], v[92:95], v[92:95], v[244:247]
    v_mul_f32 v162, v14, v162
    v_mul_f32 v163, v14, v163
    v_exp_f32 v160, v160
    v_mfma_f32_16x16x32_bf16 v[8:11], v[240:243], v[100:103], v[8:11]
    v_exp_f32 v161, v161
    v_exp_f32 v162, v162
    v_mfma_f32_16x16x32_bf16 v[244:247], v[100:103], v[100:103], v[244:247]
    v_exp_f32 v163, v163
    v_fma_f32 v160, v160, v6, v6
    v_mfma_f32_16x16x32_bf16 v[8:11], v[240:243], v[108:111], v[8:11]
    s_and_b32 s54, s44, 3
    s_mul_i32 s59, s54, 147456
    s_lshl_b32 s55, s46, 5
    s_add_u32 s59, s59, s55
    s_add_u32 s59, s59, 2957312
    s_lshl_b32 s54, s54, 10
    s_add_u32 m0, s54, 106496
    v_and_b32 v5, 0xffffffdf, v4
    s_mov_b64 exec, s[14:15]
    buffer_load_dwordx4 v5, s[28:31], s59 offen lds
    s_mov_b64 exec, -1
    v_fma_f32 v161, v161, v6, v6
    v_fma_f32 v162, v162, v6, v6
    v_fma_f32 v163, v163, v6, v6
    v_mfma_f32_16x16x32_bf16 v[244:247], v[108:111], v[108:111], v[244:247]
    v_rcp_f32 v160, v160
    v_rcp_f32 v161, v161
    v_mfma_f32_16x16x32_bf16 v[8:11], v[240:243], v[116:119], v[8:11]
    v_rcp_f32 v162, v162
    v_rcp_f32 v163, v163
    v_mul_f32 v176, v160, v176
    v_mfma_f32_16x16x32_bf16 v[244:247], v[116:119], v[116:119], v[244:247]
    v_mul_f32 v177, v161, v177
    v_mul_f32 v178, v162, v178
    v_mfma_f32_16x16x32_bf16 v[8:11], v[240:243], v[124:127], v[8:11]
    v_mul_f32 v179, v163, v179
    v_cvt_pk_bf16_f32 v160, v176, v177
    v_mfma_f32_16x16x32_bf16 v[244:247], v[124:127], v[124:127], v[244:247]
    v_cvt_pk_bf16_f32 v161, v178, v179
    v_lshrrev_b32 v5, 4, v0
    v_and_b32 v5, 48, v5
    v_add_u32 v5, 155648, v5
    ds_read_b128 v[248:251], v5 offset:64
    ds_read_b128 v[252:255], v5 offset:192
    v_mfma_f32_16x16x32_bf16 v[8:11], v[240:243], v[132:135], v[8:11]
    v_mfma_f32_16x16x32_bf16 v[244:247], v[132:135], v[132:135], v[244:247]
    s_cmp_eq_u32 s34, 20736
    s_cbranch_scc1 KA_S2K
    v_lshrrev_b32 v5, 6, v0
    v_mul_u32_u24 v5, 1152, v5
    v_and_or_b32 v5, v4, 48, v5
    s_mul_i32 s59, s44, 18432
    s_lshl_b32 s55, s47, 6
    s_add_u32 s59, s59, s55
    s_add_u32 s59, s59, 442368
    s_lshl_b32 s54, s44, 10
    s_add_u32 m0, s54, 36864
    s_cmp_gt_u32 s44, 3
    buffer_load_dwordx4 v5, s[32:35], s59 offen lds
    s_cbranch_scc1 KA_S2E
    s_add_u32 m0, s54, 45056
    s_add_u32 s59, s59, 147456
    buffer_load_dwordx4 v5, s[32:35], s59 offen lds
    s_branch KA_S2E
KA_S2K:
    s_lshl_b32 s55, s44, 4
    s_and_b32 s55, s55, 32
    v_lshrrev_b32 v5, 2, v0
    v_and_b32 v5, 60, v5
    v_xor_b32 v5, s55, v5
    v_cmp_gt_u32 vcc, 36, v5
    v_mov_b32 v7, 0x7fffff00
    s_mul_i32 s60, s44, 144
    v_cndmask_b32 v5, v7, v5, vcc
    v_lshrrev_b32 v7, 8, v0
    v_mad_u32_u24 v5, v7, 36, v5
    s_lshl_b32 s54, s44, 8
    s_add_u32 m0, s54, 36864
    s_add_u32 s59, s60, 13824
    buffer_load_dword v5, s[32:35], s59 offen lds
    s_add_u32 m0, s54, 38912
    s_add_u32 s59, s60, 14976
    buffer_load_dword v5, s[32:35], s59 offen lds
    s_add_u32 m0, s54, 40960
    s_add_u32 s59, s60, 16128
    buffer_load_dword v5, s[32:35], s59 offen lds
    s_add_u32 m0, s54, 43008
    s_add_u32 s59, s60, 17280
    buffer_load_dword v5, s[32:35], s59 offen lds
    s_add_u32 m0, s54, 45056
    s_add_u32 s59, s60, 18432
    buffer_load_dword v5, s[32:35], s59 offen lds
    s_add_u32 m0, s54, 47104
    s_add_u32 s59, s60, 19584
    buffer_load_dword v5, s[32:35], s59 offen lds
KA_S2E:
    s_waitcnt lgkmcnt(0)
    v_mfma_f32_16x16x32_bf16 v[8:11], v[240:243], v[140:143], v[8:11]
    v_fma_f32 v168, v12, v248, v168
    v_fma_f32 v169, v12, v249, v169
    v_mfma_f32_16x16x32_bf16 v[244:247], v[140:143], v[140:143], v[244:247]
    v_fma_f32 v170, v12, v250, v170
    v_fma_f32 v171, v12, v251, v171
    v_mfma_f32_16x16x32_bf16 v[8:11], v[240:243], v[148:151], v[8:11]
    v_fma_f32 v184, v12, v252, v184
    v_fma_f32 v185, v12, v253, v185
    v_mfma_f32_16x16x32_bf16 v[244:247], v[148:151], v[148:151], v[244:247]
    v_fma_f32 v186, v12, v254, v186
    v_fma_f32 v187, v12, v255, v187
    v_mul_f32 v184, v168, v184
    v_mfma_f32_16x16x32_bf16 v[8:11], v[240:243], v[156:159], v[8:11]
    v_mul_f32 v185, v169, v185
    v_mul_f32 v186, v170, v186
    v_mfma_f32_16x16x32_bf16 v[244:247], v[156:159], v[156:159], v[244:247]
    v_mul_f32 v187, v171, v187
    v_mul_f32 v168, v14, v168
    v_mul_f32 v169, v14, v169
    v_mfma_f32_16x16x32_bf16 v[192:195], v[224:227], v[128:131], v[192:195]
    ds_read_b64_tr_b16 v[236:237], v2 offset:57856
    v_mul_f32 v170, v14, v170
    v_mul_f32 v171, v14, v171
    v_exp_f32 v168, v168
    v_mfma_f32_16x16x32_bf16 v[196:199], v[224:227], v[132:135], v[196:199]
    ds_read_b64_tr_b16 v[238:239], v2 offset:58112
    v_exp_f32 v169, v169
    v_exp_f32 v170, v170
    v_exp_f32 v171, v171
    v_mfma_f32_16x16x32_bf16 v[200:203], v[228:231], v[128:131], v[200:203]
    ds_read_b64_tr_b16 v[224:225], v1 offset:53760
    s_and_b32 s54, s44, 3
    s_mul_i32 s59, s54, 147456
    s_lshl_b32 s55, s46, 5
    s_add_u32 s59, s59, s55
    s_add_u32 s59, s59, 3547136
    s_lshl_b32 s54, s54, 10
    s_add_u32 m0, s54, 24576
    v_and_b32 v5, 0xffffffdf, v4
    s_mov_b64 exec, s[14:15]
    buffer_load_dwordx4 v5, s[28:31], s59 offen lds
    s_mov_b64 exec, -1
    v_mul_f32 v13, 0xbae38e39, v8
    v_fma_f32 v168, v168, v6, v6
    s_mov_b32 vcc_lo, 0x100001
    s_mov_b32 vcc_hi, 0x10000100
    v_cndmask_b32 v15, 0, v244, vcc
    v_mfma_f32_16x16x32_bf16 v[204:207], v[228:231], v[132:135], v[204:207]
    ds_read_b64_tr_b16 v[226:227], v1 offset:54016
    v_fma_f32 v169, v169, v6, v6
    s_mov_b32 vcc_lo, 0x200002
    s_mov_b32 vcc_hi, 0x20000200
    v_cndmask_b32 v15, v15, v245, vcc
    v_fma_f32 v170, v170, v6, v6
    v_mfma_f32_16x16x32_bf16 v[208:211], v[232:235], v[128:131], v[208:211]
    ds_read_b64_tr_b16 v[228:229], v2 offset:53760
    s_mov_b32 vcc_lo, 0x400004
    s_mov_b32 vcc_hi, 0x40000400
    v_cndmask_b32 v15, v15, v246, vcc
    v_fma_f32 v171, v171, v6, v6
    s_mov_b32 vcc_lo, 0x800008
    s_mov_b32 vcc_hi, 0x80000800
    v_cndmask_b32 v15, v15, v247, vcc
    v_mfma_f32_16x16x32_bf16 v[212:215], v[232:235], v[132:135], v[212:215]
    ds_read_b64_tr_b16 v[230:231], v2 offset:54016
    v_rcp_f32 v168, v168
    v_mov_b32 v7, v15
    v_rcp_f32 v169, v169
    s_waitcnt lgkmcnt(4)
    v_mfma_f32_16x16x32_bf16 v[216:219], v[236:239], v[128:131], v[216:219]
    ds_read_b64_tr_b16 v[232:233], v1 offset:61952
    s_nop 1
    v_rcp_f32 v170, v170
    v_permlane32_swap_b32 v7, v15
    v_mfma_f32_16x16x32_bf16 v[220:223], v[236:239], v[132:135], v[220:223]
    ds_read_b64_tr_b16 v[234:235], v1 offset:62208
    v_rcp_f32 v171, v171
    s_nop 1
    v_mul_f32 v184, v168, v184
    s_waitcnt lgkmcnt(4)
    v_mfma_f32_16x16x32_bf16 v[192:195], v[224:227], v[136:139], v[192:195]
    ds_read_b64_tr_b16 v[236:237], v2 offset:61952
    v_add_f32 v15, v7, v15
    v_mul_f32 v185, v169, v185
    v_mov_b32 v7, v15
    v_mfma_f32_16x16x32_bf16 v[196:199], v[224:227], v[140:143], v[196:199]
    ds_read_b64_tr_b16 v[238:239], v2 offset:62208
    v_mul_f32 v186, v170, v186
    s_nop 1
    v_mul_f32 v187, v171, v187
    s_waitcnt lgkmcnt(4)
    v_mfma_f32_16x16x32_bf16 v[200:203], v[228:231], v[136:139], v[200:203]
    ds_read_b64_tr_b16 v[224:225], v1 offset:512
    v_permlane16_swap_b32 v7, v15
    v_cvt_pk_bf16_f32 v162, v184, v185
    s_nop 1
    v_mfma_f32_16x16x32_bf16 v[204:207], v[228:231], v[140:143], v[204:207]
    ds_read_b64_tr_b16 v[226:227], v1 offset:768
    s_and_b32 s54, s44, 3
    s_mul_i32 s59, s54, 147456
    s_lshl_b32 s55, s46, 5
    s_add_u32 s59, s59, s55
    s_add_u32 s59, s59, 4136960
    s_lshl_b32 s54, s54, 10
    s_add_u32 m0, s54, 28672
    v_and_b32 v5, 0xffffffdf, v4
    s_mov_b64 exec, s[14:15]
    buffer_load_dwordx4 v5, s[28:31], s59 offen lds
    s_mov_b64 exec, -1
    v_cvt_pk_bf16_f32 v163, v186, v187
    v_add_f32 v15, v7, v15
    s_add_u32 s54, s8, 0
    buffer_store_dwordx4 v[160:163], v0, s[36:39], s54 offen sc1
    s_waitcnt lgkmcnt(4)
    v_mfma_f32_16x16x32_bf16 v[208:211], v[232:235], v[136:139], v[208:211]
    ds_read_b64_tr_b16 v[228:229], v2 offset:512
    v_mul_f32 v7, v13, v13
    v_mul_f32 v15, 0x3ae38e39, v15
    v_sub_f32 v15, v15, v7
    v_mfma_f32_16x16x32_bf16 v[212:215], v[232:235], v[140:143], v[212:215]
    ds_read_b64_tr_b16 v[230:231], v2 offset:768
    v_max_f32 v15, 0, v15
    v_add_f32 v7, 0x3727c5ac, v15
    v_rsq_f32 v15, v7
    s_waitcnt lgkmcnt(4)
    v_mfma_f32_16x16x32_bf16 v[216:219], v[236:239], v[136:139], v[216:219]
    ds_read_b64_tr_b16 v[232:233], v1 offset:8704
    s_nop 0
    v_mul_f32 v15, 0xbfb8aa3b, v15
    v_fma_f32 v172, v13, v248, v172
    v_mfma_f32_16x16x32_bf16 v[220:223], v[236:239], v[140:143], v[220:223]
    ds_read_b64_tr_b16 v[234:235], v1 offset:8960
    v_fma_f32 v173, v13, v249, v173
    v_fma_f32 v174, v13, v250, v174
    v_fma_f32 v175, v13, v251, v175
    s_waitcnt lgkmcnt(4)
    v_mfma_f32_16x16x32_bf16 v[192:195], v[224:227], v[144:147], v[192:195]
    ds_read_b64_tr_b16 v[236:237], v2 offset:8704
    v_fma_f32 v188, v13, v252, v188
    v_fma_f32 v189, v13, v253, v189
    v_fma_f32 v190, v13, v254, v190
    v_mfma_f32_16x16x32_bf16 v[196:199], v[224:227], v[148:151], v[196:199]
    ds_read_b64_tr_b16 v[238:239], v2 offset:8960
    v_fma_f32 v191, v13, v255, v191
    v_lshrrev_b32 v5, 4, v0
    v_and_b32 v5, 48, v5
    v_add_u32 v5, 155648, v5
    ds_read_b128 v[248:251], v5 offset:0
    ds_read_b128 v[252:255], v5 offset:128
    v_mul_f32 v188, v172, v188
    s_waitcnt lgkmcnt(6)
    v_mfma_f32_16x16x32_bf16 v[200:203], v[228:231], v[144:147], v[200:203]
    ds_read_b64_tr_b16 v[224:225], v1 offset:4608
    v_mul_f32 v189, v173, v189
    v_mul_f32 v190, v174, v190
    v_mul_f32 v191, v175, v191
    v_mfma_f32_16x16x32_bf16 v[204:207], v[228:231], v[148:151], v[204:207]
    ds_read_b64_tr_b16 v[226:227], v1 offset:4864
    v_mul_f32 v172, v15, v172
    v_mul_f32 v173, v15, v173
    v_mul_f32 v174, v15, v174
    s_waitcnt lgkmcnt(6)
    v_mfma_f32_16x16x32_bf16 v[208:211], v[232:235], v[144:147], v[208:211]
    ds_read_b64_tr_b16 v[228:229], v2 offset:4608
    s_and_b32 s54, s44, 3
    s_mul_i32 s59, s54, 147456
    s_lshl_b32 s55, s46, 5
    s_add_u32 s59, s59, s55
    s_add_u32 s59, s59, 4726784
    s_lshl_b32 s54, s54, 10
    s_add_u32 m0, s54, 32768
    v_and_b32 v5, 0xffffffdf, v4
    s_mov_b64 exec, s[14:15]
    buffer_load_dwordx4 v5, s[28:31], s59 offen lds
    s_mov_b64 exec, -1
    v_mul_f32 v175, v15, v175
    v_exp_f32 v172, v172
    v_exp_f32 v173, v173
    v_mfma_f32_16x16x32_bf16 v[212:215], v[232:235], v[148:151], v[212:215]
    ds_read_b64_tr_b16 v[230:231], v2 offset:4864
    v_exp_f32 v174, v174
    v_exp_f32 v175, v175
    v_fma_f32 v172, v172, v7, v7
    s_waitcnt lgkmcnt(6)
    v_mfma_f32_16x16x32_bf16 v[216:219], v[236:239], v[144:147], v[216:219]
    ds_read_b64_tr_b16 v[232:233], v1 offset:12800
    v_fma_f32 v173, v173, v7, v7
    v_fma_f32 v174, v174, v7, v7
    v_fma_f32 v175, v175, v7, v7
    v_mfma_f32_16x16x32_bf16 v[220:223], v[236:239], v[148:151], v[220:223]
    ds_read_b64_tr_b16 v[234:235], v1 offset:13056
    v_rcp_f32 v172, v172
    v_rcp_f32 v173, v173
    v_rcp_f32 v174, v174
    s_waitcnt lgkmcnt(4)
    v_mfma_f32_16x16x32_bf16 v[192:195], v[224:227], v[152:155], v[192:195]
    ds_read_b64_tr_b16 v[236:237], v2 offset:12800
    v_rcp_f32 v175, v175
    v_mul_f32 v188, v172, v188
    v_mul_f32 v189, v173, v189
    v_mfma_f32_16x16x32_bf16 v[196:199], v[224:227], v[156:159], v[196:199]
    ds_read_b64_tr_b16 v[238:239], v2 offset:13056
    v_mul_f32 v190, v174, v190
    v_mul_f32 v191, v175, v191
    v_cvt_pk_bf16_f32 v172, v188, v189
    s_waitcnt vmcnt(9)
    s_barrier
    v_lshrrev_b32 v5, 8, v0
    v_lshlrev_b32 v5, 9, v5
    v_sub_u32 v1, v1, v5
    v_sub_u32 v2, v2, v5
    s_and_b32 s54, s44, 1
    s_lshl_b32 s54, s54, 5
    v_xor_b32 v3, s54, v1
    s_bfe_u32 s54, s44, 0x10001
    s_mul_i32 s54, s54, 12288
    s_lshr_b32 s55, s44, 2
    s_mul_i32 s55, s55, 6144
    s_add_u32 s54, s54, s55
    s_add_u32 s54, s54, 73728
    v_add_u32 v3, s54, v3
    s_waitcnt lgkmcnt(4)
    v_mfma_f32_16x16x32_bf16 v[200:203], v[228:231], v[152:155], v[200:203]
    v_add_u32 v1, 0x12000, v1
    ds_read_b64_tr_b16 v[224:225], v1 offset:0
    v_cvt_pk_bf16_f32 v173, v190, v191
    v_fma_f32 v164, v13, v248, v164
    v_mfma_f32_16x16x32_bf16 v[204:207], v[228:231], v[156:159], v[204:207]
    ds_read_b64_tr_b16 v[226:227], v1 offset:256
    v_fma_f32 v165, v13, v249, v165
    v_fma_f32 v166, v13, v250, v166
    v_fma_f32 v167, v13, v251, v167
    s_waitcnt lgkmcnt(4)
    v_mfma_f32_16x16x32_bf16 v[208:211], v[232:235], v[152:155], v[208:211]
    v_add_u32 v2, 0x12000, v2
    ds_read_b64_tr_b16 v[228:229], v2 offset:0
    v_fma_f32 v180, v13, v252, v180
    v_fma_f32 v181, v13, v253, v181
    v_fma_f32 v182, v13, v254, v182
    v_mfma_f32_16x16x32_bf16 v[212:215], v[232:235], v[156:159], v[212:215]
    ds_read_b64_tr_b16 v[230:231], v2 offset:256
    v_fma_f32 v183, v13, v255, v183
    v_mul_f32 v180, v164, v180
    v_mul_f32 v181, v165, v181
    s_waitcnt lgkmcnt(4)
    v_mfma_f32_16x16x32_bf16 v[216:219], v[236:239], v[152:155], v[216:219]
    ds_read_b64_tr_b16 v[232:233], v1 offset:12288
    v_mul_f32 v182, v166, v182
    v_mul_f32 v183, v167, v183
    v_mul_f32 v164, v15, v164
    v_mfma_f32_16x16x32_bf16 v[220:223], v[236:239], v[156:159], v[220:223]
    ds_read_b64_tr_b16 v[234:235], v1 offset:12544
    v_mul_f32 v165, v15, v165
    v_mul_f32 v166, v15, v166
    v_mul_f32 v167, v15, v167
    v_exp_f32 v164, v164
    v_exp_f32 v165, v165
    v_exp_f32 v166, v166
    v_exp_f32 v167, v167
    v_fma_f32 v164, v164, v7, v7
    v_fma_f32 v165, v165, v7, v7
    v_fma_f32 v166, v166, v7, v7
    v_fma_f32 v167, v167, v7, v7
    v_rcp_f32 v164, v164
    v_rcp_f32 v165, v165
    v_rcp_f32 v166, v166
    v_rcp_f32 v167, v167
    v_mul_f32 v180, v164, v180
    v_mul_f32 v181, v165, v181
    v_mul_f32 v182, v166, v182
    v_mul_f32 v183, v167, v183
    v_cvt_pk_bf16_f32 v164, v180, v181
    v_cvt_pk_bf16_f32 v165, v182, v183
    v_mov_b32 v166, v172
    v_mov_b32 v167, v173
    s_add_u32 s54, s8, 1024
    buffer_store_dwordx4 v[164:167], v0, s[36:39], s54 offen sc1
    s_waitcnt lgkmcnt(4)
    v_mfma_f32_16x16x32_bf16 v[160:163], v[224:227], v[16:19], 0
    ds_read_b64_tr_b16 v[236:237], v2 offset:12288
    v_mfma_f32_16x16x32_bf16 v[164:167], v[224:227], v[20:23], 0
    ds_read_b64_tr_b16 v[238:239], v2 offset:12544
    s_waitcnt lgkmcnt(4)
    v_mfma_f32_16x16x32_bf16 v[168:171], v[228:231], v[16:19], 0
    ds_read_b64_tr_b16 v[224:225], v1 offset:2048
    v_lshrrev_b32 v5, 4, v0
    v_and_b32 v5, 48, v5
    v_add_u32 v5, 155904, v5
    ds_read_b128 v[248:251], v5 offset:0
    ds_read_b128 v[252:255], v5 offset:128
    v_mfma_f32_16x16x32_bf16 v[172:175], v[228:231], v[20:23], 0
    ds_read_b64_tr_b16 v[226:227], v1 offset:2304
    s_waitcnt lgkmcnt(6)
    v_mfma_f32_16x16x32_bf16 v[176:179], v[232:235], v[16:19], 0
    ds_read_b64_tr_b16 v[228:229], v2 offset:2048
    v_mfma_f32_16x16x32_bf16 v[180:183], v[232:235], v[20:23], 0
    ds_read_b64_tr_b16 v[230:231], v2 offset:2304
    s_waitcnt lgkmcnt(6)
    v_mfma_f32_16x16x32_bf16 v[184:187], v[236:239], v[16:19], 0
    ds_read_b64_tr_b16 v[232:233], v1 offset:14336
    s_waitcnt lgkmcnt(4)
    v_mfma_f32_16x16x32_bf16 v[188:191], v[236:239], v[20:23], 0
    ds_read_b64_tr_b16 v[234:235], v1 offset:14592
    s_waitcnt lgkmcnt(4)
    v_mfma_f32_16x16x32_bf16 v[160:163], v[224:227], v[24:27], v[160:163]
    ds_read_b64_tr_b16 v[236:237], v2 offset:14336
    v_fma_f32 v192, v12, v248, v192
    v_mfma_f32_16x16x32_bf16 v[164:167], v[224:227], v[28:31], v[164:167]
    ds_read_b64_tr_b16 v[238:239], v2 offset:14592
    v_fma_f32 v193, v12, v249, v193
    s_waitcnt lgkmcnt(4)
    v_mfma_f32_16x16x32_bf16 v[168:171], v[228:231], v[24:27], v[168:171]
    ds_read_b64_tr_b16 v[224:225], v1 offset:4096
    v_fma_f32 v194, v12, v250, v194
    v_fma_f32 v195, v12, v251, v195
    v_mfma_f32_16x16x32_bf16 v[172:175], v[228:231], v[28:31], v[172:175]
    ds_read_b64_tr_b16 v[226:227], v1 offset:4352
    ds_read_b64_tr_b16 v[8:9], v3 offset:0
    ds_read_b64_tr_b16 v[10:11], v3 offset:256
    v_fma_f32 v208, v12, v252, v208
    s_waitcnt lgkmcnt(6)
    v_mfma_f32_16x16x32_bf16 v[176:179], v[232:235], v[24:27], v[176:179]
    ds_read_b64_tr_b16 v[228:229], v2 offset:4096
    v_fma_f32 v209, v12, v253, v209
    v_mfma_f32_16x16x32_bf16 v[180:183], v[232:235], v[28:31], v[180:183]
    ds_read_b64_tr_b16 v[230:231], v2 offset:4352
    v_fma_f32 v210, v12, v254, v210
    s_waitcnt lgkmcnt(6)
    v_mfma_f32_16x16x32_bf16 v[184:187], v[236:239], v[24:27], v[184:187]
    ds_read_b64_tr_b16 v[232:233], v1 offset:16384
    v_fma_f32 v211, v12, v255, v211
    v_mfma_f32_16x16x32_bf16 v[188:191], v[236:239], v[28:31], v[188:191]
    ds_read_b64_tr_b16 v[234:235], v1 offset:16640
    v_mul_f32 v208, v192, v208
    s_waitcnt lgkmcnt(6)
    v_mfma_f32_16x16x32_bf16 v[160:163], v[224:227], v[32:35], v[160:163]
    ds_read_b64_tr_b16 v[236:237], v2 offset:16384
    s_waitcnt lgkmcnt(5)
    v_mfma_f32_16x16x32_bf16 v[244:247], v[240:243], v[8:11], 0
    v_mul_f32 v209, v193, v209
    v_mfma_f32_16x16x32_bf16 v[164:167], v[224:227], v[36:39], v[164:167]
    ds_read_b64_tr_b16 v[238:239], v2 offset:16640
    ds_read_b64_tr_b16 v[8:9], v3 offset:2048
    ds_read_b64_tr_b16 v[10:11], v3 offset:2304
    v_mul_f32 v210, v194, v210
    s_waitcnt lgkmcnt(6)
    v_mfma_f32_16x16x32_bf16 v[168:171], v[228:231], v[32:35], v[168:171]
    ds_read_b64_tr_b16 v[224:225], v1 offset:6144
    v_mul_f32 v211, v195, v211
    v_mfma_f32_16x16x32_bf16 v[172:175], v[228:231], v[36:39], v[172:175]
    ds_read_b64_tr_b16 v[226:227], v1 offset:6400
    v_mul_f32 v192, v14, v192
    v_mul_f32 v193, v14, v193
    s_waitcnt lgkmcnt(6)
    v_mfma_f32_16x16x32_bf16 v[176:179], v[232:235], v[32:35], v[176:179]
    ds_read_b64_tr_b16 v[228:229], v2 offset:6144
    v_mul_f32 v194, v14, v194
    v_mfma_f32_16x16x32_bf16 v[180:183], v[232:235], v[36:39], v[180:183]
    ds_read_b64_tr_b16 v[230:231], v2 offset:6400
    v_mul_f32 v195, v14, v195
    s_waitcnt lgkmcnt(6)
    v_mfma_f32_16x16x32_bf16 v[184:187], v[236:239], v[32:35], v[184:187]
    ds_read_b64_tr_b16 v[232:233], v1 offset:18432
    s_waitcnt lgkmcnt(5)
    v_mfma_f32_16x16x32_bf16 v[244:247], v[240:243], v[8:11], v[244:247]
    v_exp_f32 v192, v192
    v_mfma_f32_16x16x32_bf16 v[188:191], v[236:239], v[36:39], v[188:191]
    ds_read_b64_tr_b16 v[234:235], v1 offset:18688
    ds_read_b64_tr_b16 v[8:9], v3 offset:4096
    ds_read_b64_tr_b16 v[10:11], v3 offset:4352
    v_exp_f32 v193, v193
    s_waitcnt lgkmcnt(6)
    v_mfma_f32_16x16x32_bf16 v[160:163], v[224:227], v[40:43], v[160:163]
    ds_read_b64_tr_b16 v[236:237], v2 offset:18432
    v_exp_f32 v194, v194
    v_mfma_f32_16x16x32_bf16 v[164:167], v[224:227], v[44:47], v[164:167]
    ds_read_b64_tr_b16 v[238:239], v2 offset:18688
    v_exp_f32 v195, v195
    s_waitcnt lgkmcnt(6)
    v_mfma_f32_16x16x32_bf16 v[168:171], v[228:231], v[40:43], v[168:171]
    ds_read_b64_tr_b16 v[224:225], v1 offset:8192
    v_fma_f32 v192, v192, v6, v6
    v_mfma_f32_16x16x32_bf16 v[172:175], v[228:231], v[44:47], v[172:175]
    ds_read_b64_tr_b16 v[226:227], v1 offset:8448
    v_fma_f32 v193, v193, v6, v6
    v_fma_f32 v194, v194, v6, v6
    s_waitcnt lgkmcnt(6)
    v_mfma_f32_16x16x32_bf16 v[176:179], v[232:235], v[40:43], v[176:179]
    ds_read_b64_tr_b16 v[228:229], v2 offset:8192
    s_waitcnt lgkmcnt(5)
    v_mfma_f32_16x16x32_bf16 v[244:247], v[240:243], v[8:11], v[244:247]
    v_fma_f32 v195, v195, v6, v6
    v_mfma_f32_16x16x32_bf16 v[180:183], v[232:235], v[44:47], v[180:183]
    ds_read_b64_tr_b16 v[230:231], v2 offset:8448
    v_rcp_f32 v192, v192
    s_waitcnt lgkmcnt(4)
    v_mfma_f32_16x16x32_bf16 v[184:187], v[236:239], v[40:43], v[184:187]
    ds_read_b64_tr_b16 v[232:233], v1 offset:20480
    v_rcp_f32 v193, v193
    v_mfma_f32_16x16x32_bf16 v[188:191], v[236:239], v[44:47], v[188:191]
    ds_read_b64_tr_b16 v[234:235], v1 offset:20736
    v_rcp_f32 v194, v194
    s_waitcnt lgkmcnt(4)
    v_mfma_f32_16x16x32_bf16 v[160:163], v[224:227], v[48:51], v[160:163]
    ds_read_b64_tr_b16 v[236:237], v2 offset:20480
    v_rcp_f32 v195, v195
    v_mfma_f32_16x16x32_bf16 v[164:167], v[224:227], v[52:55], v[164:167]
    ds_read_b64_tr_b16 v[238:239], v2 offset:20736
    v_mul_f32 v208, v192, v208
    s_waitcnt lgkmcnt(4)
    v_mfma_f32_16x16x32_bf16 v[168:171], v[228:231], v[48:51], v[168:171]
    ds_read_b64_tr_b16 v[224:225], v1 offset:10240
    v_mul_f32 v209, v193, v209
    v_mfma_f32_16x16x32_bf16 v[172:175], v[228:231], v[52:55], v[172:175]
    ds_read_b64_tr_b16 v[226:227], v1 offset:10496
    v_mul_f32 v210, v194, v210
    s_waitcnt lgkmcnt(4)
    v_mfma_f32_16x16x32_bf16 v[176:179], v[232:235], v[48:51], v[176:179]
    ds_read_b64_tr_b16 v[228:229], v2 offset:10240
    v_mul_f32 v211, v195, v211
    v_cvt_pk_bf16_f32 v192, v208, v209
    v_mfma_f32_16x16x32_bf16 v[180:183], v[232:235], v[52:55], v[180:183]
    ds_read_b64_tr_b16 v[230:231], v2 offset:10496
    v_cvt_pk_bf16_f32 v193, v210, v211
    s_waitcnt lgkmcnt(4)
    v_mfma_f32_16x16x32_bf16 v[184:187], v[236:239], v[48:51], v[184:187]
    ds_read_b64_tr_b16 v[232:233], v1 offset:22528
    v_fma_f32 v196, v13, v248, v196
    v_mfma_f32_16x16x32_bf16 v[188:191], v[236:239], v[52:55], v[188:191]
    ds_read_b64_tr_b16 v[234:235], v1 offset:22784
    v_fma_f32 v197, v13, v249, v197
    s_waitcnt lgkmcnt(4)
    v_mfma_f32_16x16x32_bf16 v[160:163], v[224:227], v[56:59], v[160:163]
    ds_read_b64_tr_b16 v[236:237], v2 offset:22528
    v_fma_f32 v198, v13, v250, v198
    v_mfma_f32_16x16x32_bf16 v[164:167], v[224:227], v[60:63], v[164:167]
    ds_read_b64_tr_b16 v[238:239], v2 offset:22784
    v_fma_f32 v199, v13, v251, v199
    s_waitcnt vmcnt(6)
    s_barrier
    s_waitcnt lgkmcnt(4)
    v_mfma_f32_16x16x32_bf16 v[168:171], v[228:231], v[56:59], v[168:171]
    ds_read_b64_tr_b16 v[224:225], v1 offset:24576
    v_fma_f32 v212, v13, v252, v212
    v_mfma_f32_16x16x32_bf16 v[172:175], v[228:231], v[60:63], v[172:175]
    ds_read_b64_tr_b16 v[226:227], v1 offset:24832
    v_fma_f32 v213, v13, v253, v213
    s_waitcnt lgkmcnt(4)
    v_mfma_f32_16x16x32_bf16 v[176:179], v[232:235], v[56:59], v[176:179]
    ds_read_b64_tr_b16 v[228:229], v2 offset:24576
    v_fma_f32 v214, v13, v254, v214
    v_fma_f32 v215, v13, v255, v215
    s_add_u32 m0, s52, 0
    s_add_u32 s59, s53, 128
    buffer_load_dwordx4 v4, s[28:31], s59 offen lds
    v_mfma_f32_16x16x32_bf16 v[180:183], v[232:235], v[60:63], v[180:183]
    ds_read_b64_tr_b16 v[230:231], v2 offset:24832
    v_mul_f32 v212, v196, v212
    s_waitcnt lgkmcnt(4)
    v_mfma_f32_16x16x32_bf16 v[184:187], v[236:239], v[56:59], v[184:187]
    ds_read_b64_tr_b16 v[232:233], v1 offset:36864
    v_mul_f32 v213, v197, v213
    v_mfma_f32_16x16x32_bf16 v[188:191], v[236:239], v[60:63], v[188:191]
    ds_read_b64_tr_b16 v[234:235], v1 offset:37120
    v_mul_f32 v214, v198, v214
    s_waitcnt lgkmcnt(4)
    v_mfma_f32_16x16x32_bf16 v[160:163], v[224:227], v[64:67], v[160:163]
    ds_read_b64_tr_b16 v[236:237], v2 offset:36864
    v_add_u32 v3, 0x6000, v3
    v_mul_f32 v215, v199, v215
    v_mfma_f32_16x16x32_bf16 v[164:167], v[224:227], v[68:71], v[164:167]
    ds_read_b64_tr_b16 v[238:239], v2 offset:37120
    v_mul_f32 v196, v15, v196
    s_waitcnt lgkmcnt(4)
    v_mfma_f32_16x16x32_bf16 v[168:171], v[228:231], v[64:67], v[168:171]
    ds_read_b64_tr_b16 v[224:225], v1 offset:26624
    v_mul_f32 v197, v15, v197
    v_mfma_f32_16x16x32_bf16 v[172:175], v[228:231], v[68:71], v[172:175]
    ds_read_b64_tr_b16 v[226:227], v1 offset:26880
    v_mul_f32 v198, v15, v198
    s_waitcnt lgkmcnt(4)
    v_mfma_f32_16x16x32_bf16 v[176:179], v[232:235], v[64:67], v[176:179]
    ds_read_b64_tr_b16 v[228:229], v2 offset:26624
    v_mul_f32 v199, v15, v199
    s_add_u32 m0, s52, 4096
    s_add_u32 s59, s53, 589952
    buffer_load_dwordx4 v4, s[28:31], s59 offen lds
    v_mfma_f32_16x16x32_bf16 v[180:183], v[232:235], v[68:71], v[180:183]
    ds_read_b64_tr_b16 v[230:231], v2 offset:26880
    v_exp_f32 v196, v196
    v_exp_f32 v197, v197
    s_waitcnt lgkmcnt(4)
    v_mfma_f32_16x16x32_bf16 v[184:187], v[236:239], v[64:67], v[184:187]
    ds_read_b64_tr_b16 v[232:233], v1 offset:38912
    v_exp_f32 v198, v198
    v_mfma_f32_16x16x32_bf16 v[188:191], v[236:239], v[68:71], v[188:191]
    ds_read_b64_tr_b16 v[234:235], v1 offset:39168
    v_exp_f32 v199, v199
    s_waitcnt lgkmcnt(4)
    v_mfma_f32_16x16x32_bf16 v[160:163], v[224:227], v[72:75], v[160:163]
    ds_read_b64_tr_b16 v[236:237], v2 offset:38912
    v_fma_f32 v196, v196, v7, v7
    v_mfma_f32_16x16x32_bf16 v[164:167], v[224:227], v[76:79], v[164:167]
    ds_read_b64_tr_b16 v[238:239], v2 offset:39168
    v_fma_f32 v197, v197, v7, v7
    s_waitcnt lgkmcnt(4)
    v_mfma_f32_16x16x32_bf16 v[168:171], v[228:231], v[72:75], v[168:171]
    ds_read_b64_tr_b16 v[224:225], v1 offset:28672
    v_fma_f32 v198, v198, v7, v7
    v_mfma_f32_16x16x32_bf16 v[172:175], v[228:231], v[76:79], v[172:175]
    ds_read_b64_tr_b16 v[226:227], v1 offset:28928
    ds_read_b64_tr_b16 v[8:9], v3 offset:0
    ds_read_b64_tr_b16 v[10:11], v3 offset:256
    v_fma_f32 v199, v199, v7, v7
    s_waitcnt lgkmcnt(6)
    v_mfma_f32_16x16x32_bf16 v[176:179], v[232:235], v[72:75], v[176:179]
    ds_read_b64_tr_b16 v[228:229], v2 offset:28672
    v_rcp_f32 v196, v196
    s_add_u32 m0, s52, 8192
    s_add_u32 s59, s53, 1179776
    buffer_load_dwordx4 v4, s[28:31], s59 offen lds
    v_mfma_f32_16x16x32_bf16 v[180:183], v[232:235], v[76:79], v[180:183]
    ds_read_b64_tr_b16 v[230:231], v2 offset:28928
    v_rcp_f32 v197, v197
    v_rcp_f32 v198, v198
    s_waitcnt lgkmcnt(6)
    v_mfma_f32_16x16x32_bf16 v[184:187], v[236:239], v[72:75], v[184:187]
    ds_read_b64_tr_b16 v[232:233], v1 offset:40960
    s_mov_b32 s40, s66
    s_mov_b32 s41, s67
    s_mov_b32 s42, 256
    s_mov_b32 s43, 0x00020000
    v_mov_b32 v209, 0
    buffer_load_dword v208, v209, s[40:43], 0 offen sc1
    v_rcp_f32 v199, v199
    v_mfma_f32_16x16x32_bf16 v[188:191], v[236:239], v[76:79], v[188:191]
    ds_read_b64_tr_b16 v[234:235], v1 offset:41216
    v_mul_f32 v212, v196, v212
    s_waitcnt lgkmcnt(6)
    v_mfma_f32_16x16x32_bf16 v[160:163], v[224:227], v[80:83], v[160:163]
    ds_read_b64_tr_b16 v[236:237], v2 offset:40960
    s_waitcnt lgkmcnt(5)
    v_mfma_f32_16x16x32_bf16 v[244:247], v[240:243], v[8:11], v[244:247]
    v_mul_f32 v213, v197, v213
    v_mfma_f32_16x16x32_bf16 v[164:167], v[224:227], v[84:87], v[164:167]
    ds_read_b64_tr_b16 v[238:239], v2 offset:41216
    ds_read_b64_tr_b16 v[8:9], v3 offset:2048
    ds_read_b64_tr_b16 v[10:11], v3 offset:2304
    v_mul_f32 v214, v198, v214
    s_waitcnt lgkmcnt(6)
    v_mfma_f32_16x16x32_bf16 v[168:171], v[228:231], v[80:83], v[168:171]
    ds_read_b64_tr_b16 v[224:225], v1 offset:30720
    v_mul_f32 v215, v199, v215
    v_mfma_f32_16x16x32_bf16 v[172:175], v[228:231], v[84:87], v[172:175]
    ds_read_b64_tr_b16 v[226:227], v1 offset:30976
    v_cvt_pk_bf16_f32 v196, v212, v213
    s_waitcnt lgkmcnt(6)
    v_mfma_f32_16x16x32_bf16 v[176:179], v[232:235], v[80:83], v[176:179]
    ds_read_b64_tr_b16 v[228:229], v2 offset:30720
    v_cvt_pk_bf16_f32 v197, v214, v215
    s_add_u32 m0, s52, 49152
    s_add_u32 s59, s53, 1769600
    buffer_load_dwordx4 v4, s[28:31], s59 offen lds
    v_mfma_f32_16x16x32_bf16 v[180:183], v[232:235], v[84:87], v[180:183]
    ds_read_b64_tr_b16 v[230:231], v2 offset:30976
    v_lshrrev_b32 v5, 4, v0
    v_and_b32 v5, 48, v5
    v_add_u32 v5, 155904, v5
    ds_read_b128 v[248:251], v5 offset:64
    ds_read_b128 v[252:255], v5 offset:192
    s_waitcnt lgkmcnt(8)
    v_mfma_f32_16x16x32_bf16 v[184:187], v[236:239], v[80:83], v[184:187]
    ds_read_b64_tr_b16 v[232:233], v1 offset:43008
    s_waitcnt lgkmcnt(7)
    v_mfma_f32_16x16x32_bf16 v[244:247], v[240:243], v[8:11], v[244:247]
    v_mfma_f32_16x16x32_bf16 v[188:191], v[236:239], v[84:87], v[188:191]
    ds_read_b64_tr_b16 v[234:235], v1 offset:43264
    ds_read_b64_tr_b16 v[8:9], v3 offset:4096
    ds_read_b64_tr_b16 v[10:11], v3 offset:4352
    s_waitcnt lgkmcnt(8)
    v_mfma_f32_16x16x32_bf16 v[160:163], v[224:227], v[88:91], v[160:163]
    ds_read_b64_tr_b16 v[236:237], v2 offset:43008
    v_mfma_f32_16x16x32_bf16 v[164:167], v[224:227], v[92:95], v[164:167]
    ds_read_b64_tr_b16 v[238:239], v2 offset:43264
    s_waitcnt lgkmcnt(6)
    v_mfma_f32_16x16x32_bf16 v[168:171], v[228:231], v[88:91], v[168:171]
    ds_read_b64_tr_b16 v[224:225], v1 offset:32768
    v_mfma_f32_16x16x32_bf16 v[172:175], v[228:231], v[92:95], v[172:175]
    ds_read_b64_tr_b16 v[226:227], v1 offset:33024
    v_fma_f32 v200, v12, v248, v200
    s_waitcnt lgkmcnt(6)
    v_mfma_f32_16x16x32_bf16 v[176:179], v[232:235], v[88:91], v[176:179]
    ds_read_b64_tr_b16 v[228:229], v2 offset:32768
    s_waitcnt lgkmcnt(5)
    v_mfma_f32_16x16x32_bf16 v[244:247], v[240:243], v[8:11], v[244:247]
    v_fma_f32 v201, v12, v249, v201
    s_add_u32 m0, s52, 53248
    s_add_u32 s59, s53, 2359424
    buffer_load_dwordx4 v4, s[28:31], s59 offen lds
    v_mfma_f32_16x16x32_bf16 v[180:183], v[232:235], v[92:95], v[180:183]
    ds_read_b64_tr_b16 v[230:231], v2 offset:33024
    v_fma_f32 v202, v12, v250, v202
    s_waitcnt lgkmcnt(4)
    v_mfma_f32_16x16x32_bf16 v[184:187], v[236:239], v[88:91], v[184:187]
    ds_read_b64_tr_b16 v[232:233], v1 offset:45056
    v_fma_f32 v203, v12, v251, v203
    v_fma_f32 v216, v12, v252, v216
    v_mfma_f32_16x16x32_bf16 v[188:191], v[236:239], v[92:95], v[188:191]
    ds_read_b64_tr_b16 v[234:235], v1 offset:45312
    v_fma_f32 v217, v12, v253, v217
    s_waitcnt lgkmcnt(4)
    v_mfma_f32_16x16x32_bf16 v[160:163], v[224:227], v[96:99], v[160:163]
    ds_read_b64_tr_b16 v[236:237], v2 offset:45056
    v_fma_f32 v218, v12, v254, v218
    v_mfma_f32_16x16x32_bf16 v[164:167], v[224:227], v[100:103], v[164:167]
    ds_read_b64_tr_b16 v[238:239], v2 offset:45312
    v_fma_f32 v219, v12, v255, v219
    s_waitcnt lgkmcnt(4)
    v_mfma_f32_16x16x32_bf16 v[168:171], v[228:231], v[96:99], v[168:171]
    ds_read_b64_tr_b16 v[224:225], v1 offset:34816
    s_mul_i32 s54, s2, 9216
    s_lshl_b32 s55, s44, 10
    s_add_u32 s54, s54, s55
    s_add_u32 s54, s54, 25165824
    v_mov_b32 v8, -1
    v_mov_b32 v9, -1
    v_mov_b32 v10, -1
    v_mov_b32 v11, -1
    s_cmp_lg_u32 s44, 7
    buffer_store_dwordx4 v[8:11], v0, s[36:39], s54 offen sc1
    s_cbranch_scc1 KA_NOO
    buffer_store_dwordx4 v[8:11], v0, s[36:39], s54 offen offset:1024 sc1
KA_NOO:
    v_mul_f32 v216, v200, v216
    v_mfma_f32_16x16x32_bf16 v[172:175], v[228:231], v[100:103], v[172:175]
    ds_read_b64_tr_b16 v[226:227], v1 offset:35072
    v_mul_f32 v217, v201, v217
    s_waitcnt lgkmcnt(4)
    v_mfma_f32_16x16x32_bf16 v[176:179], v[232:235], v[96:99], v[176:179]
    ds_read_b64_tr_b16 v[228:229], v2 offset:34816
    v_mul_f32 v218, v202, v218
    s_add_u32 m0, s52, 57344
    s_add_u32 s59, s53, 2949248
    buffer_load_dwordx4 v4, s[28:31], s59 offen lds
    v_mfma_f32_16x16x32_bf16 v[180:183], v[232:235], v[100:103], v[180:183]
    ds_read_b64_tr_b16 v[230:231], v2 offset:35072
    v_mul_f32 v219, v203, v219
    s_waitcnt lgkmcnt(4)
    v_mfma_f32_16x16x32_bf16 v[184:187], v[236:239], v[96:99], v[184:187]
    ds_read_b64_tr_b16 v[232:233], v1 offset:47104
    v_mul_f32 v200, v14, v200
    v_mfma_f32_16x16x32_bf16 v[188:191], v[236:239], v[100:103], v[188:191]
    ds_read_b64_tr_b16 v[234:235], v1 offset:47360
    v_mul_f32 v201, v14, v201
    v_mul_f32 v202, v14, v202
    s_waitcnt lgkmcnt(4)
    v_mfma_f32_16x16x32_bf16 v[160:163], v[224:227], v[104:107], v[160:163]
    ds_read_b64_tr_b16 v[236:237], v2 offset:47104
    v_mul_f32 v203, v14, v203
    v_mfma_f32_16x16x32_bf16 v[164:167], v[224:227], v[108:111], v[164:167]
    ds_read_b64_tr_b16 v[238:239], v2 offset:47360
    v_exp_f32 v200, v200
    s_waitcnt vmcnt(9)
    s_barrier
    s_waitcnt lgkmcnt(4)
    v_mfma_f32_16x16x32_bf16 v[168:171], v[228:231], v[104:107], v[168:171]
    v_add_u32 v1, 0xffff4000, v1
    ds_read_b64_tr_b16 v[224:225], v1 offset:0
    v_exp_f32 v201, v201
    v_mfma_f32_16x16x32_bf16 v[172:175], v[228:231], v[108:111], v[172:175]
    ds_read_b64_tr_b16 v[226:227], v1 offset:256
    v_exp_f32 v202, v202
    s_waitcnt lgkmcnt(4)
    v_mfma_f32_16x16x32_bf16 v[176:179], v[232:235], v[104:107], v[176:179]
    v_add_u32 v2, 0xffff4000, v2
    ds_read_b64_tr_b16 v[228:229], v2 offset:0
    v_exp_f32 v203, v203
    s_add_u32 m0, s52, 73728
    s_add_u32 s59, s53, 3539072
    buffer_load_dwordx4 v4, s[28:31], s59 offen lds
    v_mfma_f32_16x16x32_bf16 v[180:183], v[232:235], v[108:111], v[180:183]
    ds_read_b64_tr_b16 v[230:231], v2 offset:256
    v_fma_f32 v200, v200, v6, v6
    s_waitcnt lgkmcnt(4)
    v_mfma_f32_16x16x32_bf16 v[184:187], v[236:239], v[104:107], v[184:187]
    ds_read_b64_tr_b16 v[232:233], v1 offset:12288
    v_fma_f32 v201, v201, v6, v6
    v_mfma_f32_16x16x32_bf16 v[188:191], v[236:239], v[108:111], v[188:191]
    ds_read_b64_tr_b16 v[234:235], v1 offset:12544
    v_fma_f32 v202, v202, v6, v6
    v_fma_f32 v203, v203, v6, v6
    s_waitcnt lgkmcnt(4)
    v_mfma_f32_16x16x32_bf16 v[160:163], v[224:227], v[112:115], v[160:163]
    ds_read_b64_tr_b16 v[236:237], v2 offset:12288
    v_add_u32 v3, 0xfffee000, v3
    v_rcp_f32 v200, v200
    v_mfma_f32_16x16x32_bf16 v[164:167], v[224:227], v[116:119], v[164:167]
    ds_read_b64_tr_b16 v[238:239], v2 offset:12544
    v_rcp_f32 v201, v201
    s_waitcnt lgkmcnt(4)
    v_mfma_f32_16x16x32_bf16 v[168:171], v[228:231], v[112:115], v[168:171]
    ds_read_b64_tr_b16 v[224:225], v1 offset:2048
    v_rcp_f32 v202, v202
    v_mfma_f32_16x16x32_bf16 v[172:175], v[228:231], v[116:119], v[172:175]
    ds_read_b64_tr_b16 v[226:227], v1 offset:2304
    v_rcp_f32 v203, v203
    s_waitcnt lgkmcnt(4)
    v_mfma_f32_16x16x32_bf16 v[176:179], v[232:235], v[112:115], v[176:179]
    ds_read_b64_tr_b16 v[228:229], v2 offset:2048
    v_mul_f32 v216, v200, v216
    v_mfma_f32_16x16x32_bf16 v[180:183], v[232:235], v[116:119], v[180:183]
    ds_read_b64_tr_b16 v[230:231], v2 offset:2304
    v_mul_f32 v217, v201, v217
    s_waitcnt lgkmcnt(4)
    v_mfma_f32_16x16x32_bf16 v[184:187], v[236:239], v[112:115], v[184:187]
    ds_read_b64_tr_b16 v[232:233], v1 offset:14336
    v_mul_f32 v218, v202, v218
    v_mfma_f32_16x16x32_bf16 v[188:191], v[236:239], v[116:119], v[188:191]
    ds_read_b64_tr_b16 v[234:235], v1 offset:14592
    v_mul_f32 v219, v203, v219
    s_waitcnt lgkmcnt(4)
    v_mfma_f32_16x16x32_bf16 v[160:163], v[224:227], v[120:123], v[160:163]
    ds_read_b64_tr_b16 v[236:237], v2 offset:14336
    v_cvt_pk_bf16_f32 v194, v216, v217
    v_cvt_pk_bf16_f32 v195, v218, v219
    v_mfma_f32_16x16x32_bf16 v[164:167], v[224:227], v[124:127], v[164:167]
    ds_read_b64_tr_b16 v[238:239], v2 offset:14592
    s_add_u32 s54, s8, 4096
    buffer_store_dwordx4 v[192:195], v0, s[36:39], s54 offen sc1
    s_waitcnt lgkmcnt(4)
    v_mfma_f32_16x16x32_bf16 v[168:171], v[228:231], v[120:123], v[168:171]
    ds_read_b64_tr_b16 v[224:225], v1 offset:4096
    v_fma_f32 v204, v13, v248, v204
    v_mfma_f32_16x16x32_bf16 v[172:175], v[228:231], v[124:127], v[172:175]
    ds_read_b64_tr_b16 v[226:227], v1 offset:4352
    ds_read_b64_tr_b16 v[8:9], v3 offset:0
    ds_read_b64_tr_b16 v[10:11], v3 offset:256
    v_fma_f32 v205, v13, v249, v205
    s_waitcnt lgkmcnt(6)
    v_mfma_f32_16x16x32_bf16 v[176:179], v[232:235], v[120:123], v[176:179]
    ds_read_b64_tr_b16 v[228:229], v2 offset:4096
    v_fma_f32 v206, v13, v250, v206
    s_add_u32 m0, s52, 77824
    s_add_u32 s59, s53, 4128896
    buffer_load_dwordx4 v4, s[28:31], s59 offen lds
    v_mfma_f32_16x16x32_bf16 v[180:183], v[232:235], v[124:127], v[180:183]
    ds_read_b64_tr_b16 v[230:231], v2 offset:4352
    v_fma_f32 v207, v13, v251, v207
    s_waitcnt lgkmcnt(6)
    v_mfma_f32_16x16x32_bf16 v[184:187], v[236:239], v[120:123], v[184:187]
    ds_read_b64_tr_b16 v[232:233], v1 offset:16384
    v_fma_f32 v220, v13, v252, v220
    v_mfma_f32_16x16x32_bf16 v[188:191], v[236:239], v[124:127], v[188:191]
    ds_read_b64_tr_b16 v[234:235], v1 offset:16640
    v_fma_f32 v221, v13, v253, v221
    s_waitcnt lgkmcnt(6)
    v_mfma_f32_16x16x32_bf16 v[160:163], v[224:227], v[128:131], v[160:163]
    ds_read_b64_tr_b16 v[236:237], v2 offset:16384
    s_waitcnt lgkmcnt(5)
    v_mfma_f32_16x16x32_bf16 v[244:247], v[240:243], v[8:11], v[244:247]
    v_fma_f32 v222, v13, v254, v222
    v_fma_f32 v223, v13, v255, v223
    v_mfma_f32_16x16x32_bf16 v[164:167], v[224:227], v[132:135], v[164:167]
    ds_read_b64_tr_b16 v[238:239], v2 offset:16640
    ds_read_b64_tr_b16 v[8:9], v3 offset:2048
    ds_read_b64_tr_b16 v[10:11], v3 offset:2304
    v_mul_f32 v220, v204, v220
    s_waitcnt lgkmcnt(6)
    v_mfma_f32_16x16x32_bf16 v[168:171], v[228:231], v[128:131], v[168:171]
    ds_read_b64_tr_b16 v[224:225], v1 offset:6144
    v_mul_f32 v221, v205, v221
    v_mfma_f32_16x16x32_bf16 v[172:175], v[228:231], v[132:135], v[172:175]
    ds_read_b64_tr_b16 v[226:227], v1 offset:6400
    v_mul_f32 v222, v206, v222
    s_waitcnt lgkmcnt(6)
    v_mfma_f32_16x16x32_bf16 v[176:179], v[232:235], v[128:131], v[176:179]
    ds_read_b64_tr_b16 v[228:229], v2 offset:6144
    v_mul_f32 v223, v207, v223
    v_mfma_f32_16x16x32_bf16 v[180:183], v[232:235], v[132:135], v[180:183]
    ds_read_b64_tr_b16 v[230:231], v2 offset:6400
    v_mul_f32 v204, v15, v204
    s_waitcnt lgkmcnt(6)
    v_mfma_f32_16x16x32_bf16 v[184:187], v[236:239], v[128:131], v[184:187]
    ds_read_b64_tr_b16 v[232:233], v1 offset:18432
    s_waitcnt lgkmcnt(5)
    v_mfma_f32_16x16x32_bf16 v[244:247], v[240:243], v[8:11], v[244:247]
    v_mul_f32 v205, v15, v205
    v_mfma_f32_16x16x32_bf16 v[188:191], v[236:239], v[132:135], v[188:191]
    ds_read_b64_tr_b16 v[234:235], v1 offset:18688
    ds_read_b64_tr_b16 v[8:9], v3 offset:4096
    ds_read_b64_tr_b16 v[10:11], v3 offset:4352
    v_mul_f32 v206, v15, v206
    s_waitcnt lgkmcnt(6)
    v_mfma_f32_16x16x32_bf16 v[160:163], v[224:227], v[136:139], v[160:163]
    ds_read_b64_tr_b16 v[236:237], v2 offset:18432
    v_mul_f32 v207, v15, v207
    v_mfma_f32_16x16x32_bf16 v[164:167], v[224:227], v[140:143], v[164:167]
    ds_read_b64_tr_b16 v[238:239], v2 offset:18688
    v_exp_f32 v204, v204
    v_exp_f32 v205, v205
    s_waitcnt lgkmcnt(6)
    v_mfma_f32_16x16x32_bf16 v[168:171], v[228:231], v[136:139], v[168:171]
    ds_read_b64_tr_b16 v[224:225], v1 offset:8192
    s_waitcnt vmcnt(7)
    s_mov_b32 s60, 0x40000
KA_ZS:
    v_cmp_ne_u32 vcc, 1, v208
    s_cmp_eq_u64 vcc, 0
    s_cbranch_scc1 KA_ZS_OK
    s_sleep 32
    buffer_load_dword v208, v209, s[40:43], 0 offen sc1
    s_waitcnt vmcnt(0)
    s_sub_u32 s60, s60, 1
    s_cmp_lg_u32 s60, 0
    s_cbranch_scc1 KA_ZS
KA_ZS_OK:
    v_exp_f32 v206, v206
    v_mfma_f32_16x16x32_bf16 v[172:175], v[228:231], v[140:143], v[172:175]
    ds_read_b64_tr_b16 v[226:227], v1 offset:8448
    v_exp_f32 v207, v207
    s_waitcnt lgkmcnt(6)
    v_mfma_f32_16x16x32_bf16 v[176:179], v[232:235], v[136:139], v[176:179]
    ds_read_b64_tr_b16 v[228:229], v2 offset:8192
    s_waitcnt lgkmcnt(5)
    v_mfma_f32_16x16x32_bf16 v[244:247], v[240:243], v[8:11], v[244:247]
    v_fma_f32 v204, v204, v7, v7
    s_add_u32 m0, s52, 81920
    s_add_u32 s59, s53, 4718720
    buffer_load_dwordx4 v4, s[28:31], s59 offen lds
    v_mfma_f32_16x16x32_bf16 v[180:183], v[232:235], v[140:143], v[180:183]
    ds_read_b64_tr_b16 v[230:231], v2 offset:8448
    v_fma_f32 v205, v205, v7, v7
    s_waitcnt lgkmcnt(4)
    v_mfma_f32_16x16x32_bf16 v[184:187], v[236:239], v[136:139], v[184:187]
    ds_read_b64_tr_b16 v[232:233], v1 offset:20480
    v_fma_f32 v206, v206, v7, v7
    v_mfma_f32_16x16x32_bf16 v[188:191], v[236:239], v[140:143], v[188:191]
    ds_read_b64_tr_b16 v[234:235], v1 offset:20736
    v_fma_f32 v207, v207, v7, v7
    s_waitcnt lgkmcnt(4)
    v_mfma_f32_16x16x32_bf16 v[160:163], v[224:227], v[144:147], v[160:163]
    ds_read_b64_tr_b16 v[236:237], v2 offset:20480
    v_rcp_f32 v204, v204
    v_mfma_f32_16x16x32_bf16 v[164:167], v[224:227], v[148:151], v[164:167]
    ds_read_b64_tr_b16 v[238:239], v2 offset:20736
    v_rcp_f32 v205, v205
    v_rcp_f32 v206, v206
    s_waitcnt lgkmcnt(4)
    v_mfma_f32_16x16x32_bf16 v[168:171], v[228:231], v[144:147], v[168:171]
    ds_read_b64_tr_b16 v[224:225], v1 offset:10240
    v_lshrrev_b32 v5, 2, v0
    s_lshl_b32 s54, s44, 6
    s_add_u32 s54, s54, 156672
    v_add_u32 v5, s54, v5
    s_mov_b64 exec, 0xffff
    ds_write_b32 v5, v244
    s_mov_b64 exec, -1
    v_rcp_f32 v207, v207
    v_mfma_f32_16x16x32_bf16 v[172:175], v[228:231], v[148:151], v[172:175]
    ds_read_b64_tr_b16 v[226:227], v1 offset:10496
    v_mul_f32 v220, v204, v220
    s_waitcnt lgkmcnt(5)
    v_mfma_f32_16x16x32_bf16 v[176:179], v[232:235], v[144:147], v[176:179]
    ds_read_b64_tr_b16 v[228:229], v2 offset:10240
    v_mul_f32 v221, v205, v221
    v_mfma_f32_16x16x32_bf16 v[180:183], v[232:235], v[148:151], v[180:183]
    ds_read_b64_tr_b16 v[230:231], v2 offset:10496
    v_mul_f32 v222, v206, v222
    s_waitcnt lgkmcnt(5)
    v_mfma_f32_16x16x32_bf16 v[184:187], v[236:239], v[144:147], v[184:187]
    ds_read_b64_tr_b16 v[232:233], v1 offset:22528
    v_mul_f32 v223, v207, v223
    v_mfma_f32_16x16x32_bf16 v[188:191], v[236:239], v[148:151], v[188:191]
    ds_read_b64_tr_b16 v[234:235], v1 offset:22784
    v_cvt_pk_bf16_f32 v198, v220, v221
    s_waitcnt lgkmcnt(4)
    v_mfma_f32_16x16x32_bf16 v[160:163], v[224:227], v[152:155], v[160:163]
    ds_read_b64_tr_b16 v[236:237], v2 offset:22528
    v_cvt_pk_bf16_f32 v199, v222, v223
    v_mfma_f32_16x16x32_bf16 v[164:167], v[224:227], v[156:159], v[164:167]
    ds_read_b64_tr_b16 v[238:239], v2 offset:22784
    s_add_u32 s54, s8, 5120
    buffer_store_dwordx4 v[196:199], v0, s[36:39], s54 offen sc1
    s_barrier
    s_waitcnt lgkmcnt(4)
    v_mfma_f32_16x16x32_bf16 v[168:171], v[228:231], v[152:155], v[168:171]
    v_add_u32 v1, 0xffffa000, v1
    ds_read_b64_tr_b16 v[224:225], v1 offset:0
    v_mfma_f32_16x16x32_bf16 v[172:175], v[228:231], v[156:159], v[172:175]
    ds_read_b64_tr_b16 v[226:227], v1 offset:256
    s_waitcnt lgkmcnt(4)
    v_mfma_f32_16x16x32_bf16 v[176:179], v[232:235], v[152:155], v[176:179]
    v_add_u32 v2, 0xffffa000, v2
    ds_read_b64_tr_b16 v[228:229], v2 offset:0
    v_mfma_f32_16x16x32_bf16 v[180:183], v[232:235], v[156:159], v[180:183]
    ds_read_b64_tr_b16 v[230:231], v2 offset:256
    s_waitcnt lgkmcnt(4)
    v_mfma_f32_16x16x32_bf16 v[184:187], v[236:239], v[152:155], v[184:187]
    ds_read_b64_tr_b16 v[232:233], v1 offset:12288
    v_mfma_f32_16x16x32_bf16 v[188:191], v[236:239], v[156:159], v[188:191]
    ds_read_b64_tr_b16 v[234:235], v1 offset:12544
    s_waitcnt lgkmcnt(4)
    v_mfma_f32_16x16x32_bf16 v[192:195], v[224:227], v[16:19], 0
    ds_read_b64_tr_b16 v[236:237], v2 offset:12288
    v_add_u32 v3, 0xffffa000, v3
    v_lshrrev_b32 v5, 4, v0
    v_and_b32 v5, 48, v5
    v_add_u32 v5, 156672, v5
    ds_read_b128 v[248:251], v5 offset:128
    ds_read_b128 v[244:247], v5 offset:384
    ds_read_b128 v[252:255], v5 offset:192
    ds_read_b128 v[8:11], v5 offset:448
    v_mfma_f32_16x16x32_bf16 v[196:199], v[224:227], v[20:23], 0
    ds_read_b64_tr_b16 v[238:239], v2 offset:12544
    s_waitcnt lgkmcnt(8)
    v_mfma_f32_16x16x32_bf16 v[200:203], v[228:231], v[16:19], 0
    ds_read_b64_tr_b16 v[224:225], v1 offset:2048
    v_mfma_f32_16x16x32_bf16 v[204:207], v[228:231], v[20:23], 0
    ds_read_b64_tr_b16 v[226:227], v1 offset:2304
    s_waitcnt lgkmcnt(8)
    v_mfma_f32_16x16x32_bf16 v[208:211], v[232:235], v[16:19], 0
    ds_read_b64_tr_b16 v[228:229], v2 offset:2048
    v_mfma_f32_16x16x32_bf16 v[212:215], v[232:235], v[20:23], 0
    ds_read_b64_tr_b16 v[230:231], v2 offset:2304
    s_waitcnt lgkmcnt(5)
    v_add_f32 v248, v248, v244
    v_add_f32 v249, v249, v245
    v_add_f32 v250, v250, v246
    v_add_f32 v251, v251, v247
    s_waitcnt lgkmcnt(4)
    v_mfma_f32_16x16x32_bf16 v[216:219], v[236:239], v[16:19], 0
    ds_read_b64_tr_b16 v[232:233], v1 offset:14336
    v_add_f32 v252, v252, v8
    v_add_f32 v253, v253, v9
    v_add_f32 v254, v254, v10
    v_add_f32 v255, v255, v11
    v_mfma_f32_16x16x32_bf16 v[220:223], v[236:239], v[20:23], 0
    ds_read_b64_tr_b16 v[234:235], v1 offset:14592
    s_waitcnt lgkmcnt(4)
    v_mfma_f32_16x16x32_bf16 v[192:195], v[224:227], v[24:27], v[192:195]
    ds_read_b64_tr_b16 v[236:237], v2 offset:14336
    v_fma_f32 v176, v12, v248, v176
    v_mfma_f32_16x16x32_bf16 v[196:199], v[224:227], v[28:31], v[196:199]
    ds_read_b64_tr_b16 v[238:239], v2 offset:14592
    v_fma_f32 v177, v12, v249, v177
    s_waitcnt lgkmcnt(4)
    v_mfma_f32_16x16x32_bf16 v[200:203], v[228:231], v[24:27], v[200:203]
    ds_read_b64_tr_b16 v[224:225], v1 offset:4096
    v_fma_f32 v178, v12, v250, v178
    v_mfma_f32_16x16x32_bf16 v[204:207], v[228:231], v[28:31], v[204:207]
    ds_read_b64_tr_b16 v[226:227], v1 offset:4352
    ds_read_b64_tr_b16 v[8:9], v3 offset:0
    ds_read_b64_tr_b16 v[10:11], v3 offset:256
    v_fma_f32 v179, v12, v251, v179
    s_waitcnt lgkmcnt(6)
    v_mfma_f32_16x16x32_bf16 v[208:211], v[232:235], v[24:27], v[208:211]
    ds_read_b64_tr_b16 v[228:229], v2 offset:4096
    v_mul_f32 v5, s58, v14
    v_mul_f32 v176, v5, v176
    v_mul_f32 v177, v5, v177
    v_mul_f32 v178, v5, v178
    v_mul_f32 v179, v5, v179
    v_mfma_f32_16x16x32_bf16 v[212:215], v[232:235], v[28:31], v[212:215]
    ds_read_b64_tr_b16 v[230:231], v2 offset:4352
    v_cvt_pk_bf16_f32 v176, v176, v177
    s_waitcnt lgkmcnt(6)
    v_mfma_f32_16x16x32_bf16 v[216:219], v[236:239], v[24:27], v[216:219]
    ds_read_b64_tr_b16 v[232:233], v1 offset:16384
    v_cvt_pk_bf16_f32 v177, v178, v179
    v_mfma_f32_16x16x32_bf16 v[220:223], v[236:239], v[28:31], v[220:223]
    ds_read_b64_tr_b16 v[234:235], v1 offset:16640
    v_fma_f32 v184, v12, v252, v184
    s_waitcnt lgkmcnt(6)
    v_mfma_f32_16x16x32_bf16 v[192:195], v[224:227], v[32:35], v[192:195]
    ds_read_b64_tr_b16 v[236:237], v2 offset:16384
    s_waitcnt lgkmcnt(5)
    v_mfma_f32_16x16x32_bf16 v[244:247], v[240:243], v[8:11], 0
    v_fma_f32 v185, v12, v253, v185
    v_mfma_f32_16x16x32_bf16 v[196:199], v[224:227], v[36:39], v[196:199]
    ds_read_b64_tr_b16 v[238:239], v2 offset:16640
    ds_read_b64_tr_b16 v[8:9], v3 offset:2048
    ds_read_b64_tr_b16 v[10:11], v3 offset:2304
    v_fma_f32 v186, v12, v254, v186
    s_waitcnt lgkmcnt(6)
    v_mfma_f32_16x16x32_bf16 v[200:203], v[228:231], v[32:35], v[200:203]
    ds_read_b64_tr_b16 v[224:225], v1 offset:6144
    v_mfma_f32_16x16x32_bf16 v[204:207], v[228:231], v[36:39], v[204:207]
    ds_read_b64_tr_b16 v[226:227], v1 offset:6400
    v_fma_f32 v187, v12, v255, v187
    s_waitcnt lgkmcnt(6)
    v_mfma_f32_16x16x32_bf16 v[208:211], v[232:235], v[32:35], v[208:211]
    ds_read_b64_tr_b16 v[228:229], v2 offset:6144
    v_mul_f32 v5, s58, v14
    v_mul_f32 v184, v5, v184
    v_mul_f32 v185, v5, v185
    v_mul_f32 v186, v5, v186
    v_mul_f32 v187, v5, v187
    v_mfma_f32_16x16x32_bf16 v[212:215], v[232:235], v[36:39], v[212:215]
    ds_read_b64_tr_b16 v[230:231], v2 offset:6400
    v_cvt_pk_bf16_f32 v178, v184, v185
    s_waitcnt lgkmcnt(6)
    v_mfma_f32_16x16x32_bf16 v[216:219], v[236:239], v[32:35], v[216:219]
    ds_read_b64_tr_b16 v[232:233], v1 offset:18432
    s_waitcnt lgkmcnt(5)
    v_mfma_f32_16x16x32_bf16 v[244:247], v[240:243], v[8:11], v[244:247]
    v_cvt_pk_bf16_f32 v179, v186, v187
    v_mfma_f32_16x16x32_bf16 v[220:223], v[236:239], v[36:39], v[220:223]
    ds_read_b64_tr_b16 v[234:235], v1 offset:18688
    ds_read_b64_tr_b16 v[8:9], v3 offset:4096
    ds_read_b64_tr_b16 v[10:11], v3 offset:4352
    v_fma_f32 v180, v13, v248, v180
    s_waitcnt lgkmcnt(6)
    v_mfma_f32_16x16x32_bf16 v[192:195], v[224:227], v[40:43], v[192:195]
    ds_read_b64_tr_b16 v[236:237], v2 offset:18432
    v_fma_f32 v181, v13, v249, v181
    v_mfma_f32_16x16x32_bf16 v[196:199], v[224:227], v[44:47], v[196:199]
    ds_read_b64_tr_b16 v[238:239], v2 offset:18688
    v_fma_f32 v182, v13, v250, v182
    s_waitcnt lgkmcnt(6)
    v_mfma_f32_16x16x32_bf16 v[200:203], v[228:231], v[40:43], v[200:203]
    ds_read_b64_tr_b16 v[224:225], v1 offset:8192
    v_fma_f32 v183, v13, v251, v183
    v_mfma_f32_16x16x32_bf16 v[204:207], v[228:231], v[44:47], v[204:207]
    ds_read_b64_tr_b16 v[226:227], v1 offset:8448
    v_mul_f32 v5, s58, v15
    v_mul_f32 v180, v5, v180
    v_mul_f32 v181, v5, v181
    v_mul_f32 v182, v5, v182
    v_mul_f32 v183, v5, v183
    s_waitcnt lgkmcnt(6)
    v_mfma_f32_16x16x32_bf16 v[208:211], v[232:235], v[40:43], v[208:211]
    ds_read_b64_tr_b16 v[228:229], v2 offset:8192
    s_waitcnt lgkmcnt(5)
    v_mfma_f32_16x16x32_bf16 v[244:247], v[240:243], v[8:11], v[244:247]
    v_cvt_pk_bf16_f32 v180, v180, v181
    v_mfma_f32_16x16x32_bf16 v[212:215], v[232:235], v[44:47], v[212:215]
    ds_read_b64_tr_b16 v[230:231], v2 offset:8448
    s_waitcnt lgkmcnt(4)
    v_mfma_f32_16x16x32_bf16 v[216:219], v[236:239], v[40:43], v[216:219]
    ds_read_b64_tr_b16 v[232:233], v1 offset:20480
    v_cvt_pk_bf16_f32 v181, v182, v183
    v_mfma_f32_16x16x32_bf16 v[220:223], v[236:239], v[44:47], v[220:223]
    ds_read_b64_tr_b16 v[234:235], v1 offset:20736
    v_fma_f32 v188, v13, v252, v188
    s_waitcnt lgkmcnt(4)
    v_mfma_f32_16x16x32_bf16 v[192:195], v[224:227], v[48:51], v[192:195]
    ds_read_b64_tr_b16 v[236:237], v2 offset:20480
    v_fma_f32 v189, v13, v253, v189
    v_mfma_f32_16x16x32_bf16 v[196:199], v[224:227], v[52:55], v[196:199]
    ds_read_b64_tr_b16 v[238:239], v2 offset:20736
    v_fma_f32 v190, v13, v254, v190
    s_waitcnt lgkmcnt(4)
    v_mfma_f32_16x16x32_bf16 v[200:203], v[228:231], v[48:51], v[200:203]
    ds_read_b64_tr_b16 v[224:225], v1 offset:10240
    v_fma_f32 v191, v13, v255, v191
    v_mfma_f32_16x16x32_bf16 v[204:207], v[228:231], v[52:55], v[204:207]
    ds_read_b64_tr_b16 v[226:227], v1 offset:10496
    v_mul_f32 v5, s58, v15
    v_mul_f32 v188, v5, v188
    v_mul_f32 v189, v5, v189
    v_mul_f32 v190, v5, v190
    v_mul_f32 v191, v5, v191
    s_waitcnt lgkmcnt(4)
    v_mfma_f32_16x16x32_bf16 v[208:211], v[232:235], v[48:51], v[208:211]
    ds_read_b64_tr_b16 v[228:229], v2 offset:10240
    v_cvt_pk_bf16_f32 v182, v188, v189
    v_mfma_f32_16x16x32_bf16 v[212:215], v[232:235], v[52:55], v[212:215]
    ds_read_b64_tr_b16 v[230:231], v2 offset:10496
    v_cvt_pk_bf16_f32 v183, v190, v191
    s_waitcnt lgkmcnt(4)
    v_mfma_f32_16x16x32_bf16 v[216:219], v[236:239], v[48:51], v[216:219]
    ds_read_b64_tr_b16 v[232:233], v1 offset:22528
    s_cmp_gt_u32 s47, 19
    s_cbranch_scc1 KA_QKV_DONE
    v_bfe_u32 v248, v0, 4, 4
    v_lshrrev_b32 v249, 8, v0
    s_lshl_b32 s54, s45, 3
    s_add_u32 s54, s54, s44
    s_cmp_lt_u32 s47, 18
    s_cbranch_scc0 KA_KV
    v_lshlrev_b32 v250, 6, v248
    v_lshl_add_u32 v250, v249, 4, v250
    s_lshl_b32 s55, s47, 17
    s_lshl_b32 s54, s54, 11
    s_add_u32 s55, s55, s54
    s_add_u32 s55, s55, 27525120
    buffer_store_dwordx4 v[176:179], v250, s[36:39], s55 offen sc1
    buffer_store_dwordx4 v[180:183], v250, s[36:39], s55 offen offset:1024 sc1
    s_branch KA_QKV_DONE
KA_KV:
    s_mul_i32 s55, s54, 2304
    s_add_u32 s55, s55, 29884416
    s_mul_i32 s54, s44, 2048
    s_add_u32 s54, s54, 98304
    s_cmp_eq_u32 s47, 18
    s_cbranch_scc0 KA_V
    v_lshrrev_b32 v250, 1, v249
    v_lshlrev_b32 v250, 9, v250
    v_lshl_add_u32 v250, v248, 4, v250
    v_and_b32 v5, 1, v249
    v_lshl_add_u32 v250, v5, 3, v250
    v_add_u32 v250, s54, v250
    ds_write_b64 v250, v[176:177]
    ds_write_b64 v250, v[180:181] offset:256
    v_lshlrev_b32 v250, 2, v248
    v_add_u32 v250, s54, v250
    s_mov_b64 exec, 0xffff
    ds_write_b32 v250, v178 offset:1024
    ds_write_b32 v250, v182 offset:1088
    s_mov_b64 exec, -1
    s_branch KA_KVST
KA_V:
    s_add_u32 s55, s55, 1152
    v_bfe_u32 v250, v248, 2, 1
    v_mul_u32_u24 v250, 288, v250
    v_lshrrev_b32 v5, 3, v248
    v_lshl_add_u32 v250, v5, 3, v250
    v_and_b32 v5, 3, v248
    v_lshl_add_u32 v250, v5, 1, v250
    v_lshl_add_u32 v250, v249, 6, v250
    v_add_u32 v250, s54, v250
    ds_write_b16 v250, v176 offset:0
    ds_write_b16_d16_hi v250, v176 offset:16
    ds_write_b16 v250, v177 offset:32
    ds_write_b16_d16_hi v250, v177 offset:48
    ds_write_b16 v250, v180 offset:576
    ds_write_b16_d16_hi v250, v180 offset:592
    ds_write_b16 v250, v181 offset:608
    ds_write_b16_d16_hi v250, v181 offset:624
    s_mov_b64 exec, 0xffff
    ds_write_b16 v250, v178 offset:256
    ds_write_b16_d16_hi v250, v178 offset:272
    ds_write_b16 v250, v182 offset:832
    ds_write_b16_d16_hi v250, v182 offset:848
    s_mov_b64 exec, -1
KA_KVST:
    v_add_u32 v250, s54, v0
    ds_read_b128 v[176:179], v250
    ds_read_b128 v[180:183], v250 offset:1024
    s_waitcnt lgkmcnt(0)
    buffer_store_dwordx4 v[176:179], v0, s[36:39], s55 offen sc1
    s_mov_b64 exec, 0xff
    buffer_store_dwordx4 v[180:183], v0, s[36:39], s55 offen offset:1024 sc1
    s_mov_b64 exec, -1
KA_QKV_DONE:
    v_mfma_f32_16x16x32_bf16 v[220:223], v[236:239], v[52:55], v[220:223]
    ds_read_b64_tr_b16 v[234:235], v1 offset:22784
    s_waitcnt lgkmcnt(4)
    v_mfma_f32_16x16x32_bf16 v[192:195], v[224:227], v[56:59], v[192:195]
    ds_read_b64_tr_b16 v[236:237], v2 offset:22528
    v_mfma_f32_16x16x32_bf16 v[196:199], v[224:227], v[60:63], v[196:199]
    ds_read_b64_tr_b16 v[238:239], v2 offset:22784
    s_waitcnt vmcnt(5)
    s_barrier
    s_waitcnt lgkmcnt(4)
    v_mfma_f32_16x16x32_bf16 v[200:203], v[228:231], v[56:59], v[200:203]
    ds_read_b64_tr_b16 v[224:225], v1 offset:49152
    v_lshrrev_b32 v5, 4, v0
    v_and_b32 v5, 48, v5
    v_add_u32 v5, 156672, v5
    ds_read_b128 v[248:251], v5 offset:0
    ds_read_b128 v[176:179], v5 offset:256
    ds_read_b128 v[252:255], v5 offset:64
    ds_read_b128 v[180:183], v5 offset:320
    v_mfma_f32_16x16x32_bf16 v[204:207], v[228:231], v[60:63], v[204:207]
    ds_read_b64_tr_b16 v[226:227], v1 offset:49408
    s_waitcnt lgkmcnt(8)
    v_mfma_f32_16x16x32_bf16 v[208:211], v[232:235], v[56:59], v[208:211]
    ds_read_b64_tr_b16 v[228:229], v2 offset:49152
    s_add_u32 m0, s52, 24576
    s_add_u32 s59, s53, 192
    buffer_load_dwordx4 v4, s[28:31], s59 offen lds
    v_mfma_f32_16x16x32_bf16 v[212:215], v[232:235], v[60:63], v[212:215]
    ds_read_b64_tr_b16 v[230:231], v2 offset:49408
    s_waitcnt lgkmcnt(8)
    v_mfma_f32_16x16x32_bf16 v[216:219], v[236:239], v[56:59], v[216:219]
    ds_read_b64_tr_b16 v[232:233], v1 offset:61440
    v_mfma_f32_16x16x32_bf16 v[220:223], v[236:239], v[60:63], v[220:223]
    ds_read_b64_tr_b16 v[234:235], v1 offset:61696
    s_waitcnt lgkmcnt(4)
    v_mfma_f32_16x16x32_bf16 v[192:195], v[224:227], v[64:67], v[192:195]
    ds_read_b64_tr_b16 v[236:237], v2 offset:61440
    v_add_u32 v3, 0xc000, v3
    v_add_f32 v248, v248, v176
    v_add_f32 v249, v249, v177
    v_add_f32 v250, v250, v178
    v_add_f32 v251, v251, v179
    v_mfma_f32_16x16x32_bf16 v[196:199], v[224:227], v[68:71], v[196:199]
    ds_read_b64_tr_b16 v[238:239], v2 offset:61696
    v_add_f32 v252, v252, v180
    v_add_f32 v253, v253, v181
    v_add_f32 v254, v254, v182
    v_add_f32 v255, v255, v183
    s_waitcnt lgkmcnt(4)
    v_mfma_f32_16x16x32_bf16 v[200:203], v[228:231], v[64:67], v[200:203]
    ds_read_b64_tr_b16 v[224:225], v1 offset:51200
    v_fma_f32 v160, v12, v248, v160
    v_mfma_f32_16x16x32_bf16 v[204:207], v[228:231], v[68:71], v[204:207]
    ds_read_b64_tr_b16 v[226:227], v1 offset:51456
    s_waitcnt lgkmcnt(4)
    v_mfma_f32_16x16x32_bf16 v[208:211], v[232:235], v[64:67], v[208:211]
    ds_read_b64_tr_b16 v[228:229], v2 offset:51200
    v_fma_f32 v161, v12, v249, v161
    v_mfma_f32_16x16x32_bf16 v[212:215], v[232:235], v[68:71], v[212:215]
    ds_read_b64_tr_b16 v[230:231], v2 offset:51456
    v_fma_f32 v162, v12, v250, v162
    s_waitcnt lgkmcnt(4)
    v_mfma_f32_16x16x32_bf16 v[216:219], v[236:239], v[64:67], v[216:219]
    ds_read_b64_tr_b16 v[232:233], v1 offset:63488
    v_fma_f32 v163, v12, v251, v163
    v_mfma_f32_16x16x32_bf16 v[220:223], v[236:239], v[68:71], v[220:223]
    ds_read_b64_tr_b16 v[234:235], v1 offset:63744
    v_fma_f32 v168, v12, v252, v168
    s_waitcnt lgkmcnt(4)
    v_mfma_f32_16x16x32_bf16 v[192:195], v[224:227], v[72:75], v[192:195]
    ds_read_b64_tr_b16 v[236:237], v2 offset:63488
    v_mfma_f32_16x16x32_bf16 v[196:199], v[224:227], v[76:79], v[196:199]
    ds_read_b64_tr_b16 v[238:239], v2 offset:63744
    v_fma_f32 v169, v12, v253, v169
    s_waitcnt lgkmcnt(4)
    v_mfma_f32_16x16x32_bf16 v[200:203], v[228:231], v[72:75], v[200:203]
    ds_read_b64_tr_b16 v[224:225], v1 offset:53248
    v_fma_f32 v170, v12, v254, v170
    v_mfma_f32_16x16x32_bf16 v[204:207], v[228:231], v[76:79], v[204:207]
    ds_read_b64_tr_b16 v[226:227], v1 offset:53504
    ds_read_b64_tr_b16 v[8:9], v3 offset:0
    ds_read_b64_tr_b16 v[10:11], v3 offset:256
    v_fma_f32 v171, v12, v255, v171
    s_waitcnt lgkmcnt(6)
    v_mfma_f32_16x16x32_bf16 v[208:211], v[232:235], v[72:75], v[208:211]
    ds_read_b64_tr_b16 v[228:229], v2 offset:53248
    v_mul_f32 v168, v160, v168
    s_add_u32 m0, s52, 28672
    s_add_u32 s59, s53, 590016
    buffer_load_dwordx4 v4, s[28:31], s59 offen lds
    v_mfma_f32_16x16x32_bf16 v[212:215], v[232:235], v[76:79], v[212:215]
    ds_read_b64_tr_b16 v[230:231], v2 offset:53504
    s_waitcnt lgkmcnt(6)
    v_mfma_f32_16x16x32_bf16 v[216:219], v[236:239], v[72:75], v[216:219]
    v_add_u32 v1, 0xc000, v1
    ds_read_b64_tr_b16 v[232:233], v1 offset:16384
    v_mul_f32 v169, v161, v169
    v_mfma_f32_16x16x32_bf16 v[220:223], v[236:239], v[76:79], v[220:223]
    ds_read_b64_tr_b16 v[234:235], v1 offset:16640
    v_mul_f32 v170, v162, v170
    s_waitcnt lgkmcnt(6)
    v_mfma_f32_16x16x32_bf16 v[192:195], v[224:227], v[80:83], v[192:195]
    v_add_u32 v2, 0xc000, v2
    ds_read_b64_tr_b16 v[236:237], v2 offset:16384
    s_waitcnt lgkmcnt(5)
    v_mfma_f32_16x16x32_bf16 v[244:247], v[240:243], v[8:11], v[244:247]
    v_mul_f32 v171, v163, v171
    v_mfma_f32_16x16x32_bf16 v[196:199], v[224:227], v[84:87], v[196:199]
    ds_read_b64_tr_b16 v[238:239], v2 offset:16640
    ds_read_b64_tr_b16 v[8:9], v3 offset:2048
    ds_read_b64_tr_b16 v[10:11], v3 offset:2304
    s_waitcnt lgkmcnt(6)
    v_mfma_f32_16x16x32_bf16 v[200:203], v[228:231], v[80:83], v[200:203]
    ds_read_b64_tr_b16 v[224:225], v1 offset:6144
    v_mul_f32 v160, v14, v160
    v_mfma_f32_16x16x32_bf16 v[204:207], v[228:231], v[84:87], v[204:207]
    ds_read_b64_tr_b16 v[226:227], v1 offset:6400
    v_mul_f32 v161, v14, v161
    s_waitcnt lgkmcnt(6)
    v_mfma_f32_16x16x32_bf16 v[208:211], v[232:235], v[80:83], v[208:211]
    ds_read_b64_tr_b16 v[228:229], v2 offset:6144
    v_mul_f32 v162, v14, v162
    v_mfma_f32_16x16x32_bf16 v[212:215], v[232:235], v[84:87], v[212:215]
    ds_read_b64_tr_b16 v[230:231], v2 offset:6400
    v_mul_f32 v163, v14, v163
    s_waitcnt lgkmcnt(6)
    v_mfma_f32_16x16x32_bf16 v[216:219], v[236:239], v[80:83], v[216:219]
    ds_read_b64_tr_b16 v[232:233], v1 offset:18432
    s_waitcnt lgkmcnt(5)
    v_mfma_f32_16x16x32_bf16 v[244:247], v[240:243], v[8:11], v[244:247]
    v_mfma_f32_16x16x32_bf16 v[220:223], v[236:239], v[84:87], v[220:223]
    ds_read_b64_tr_b16 v[234:235], v1 offset:18688
    ds_read_b64_tr_b16 v[8:9], v3 offset:4096
    ds_read_b64_tr_b16 v[10:11], v3 offset:4352
    v_exp_f32 v160, v160
    s_waitcnt lgkmcnt(6)
    v_mfma_f32_16x16x32_bf16 v[192:195], v[224:227], v[88:91], v[192:195]
    ds_read_b64_tr_b16 v[236:237], v2 offset:18432
    v_exp_f32 v161, v161
    v_mfma_f32_16x16x32_bf16 v[196:199], v[224:227], v[92:95], v[196:199]
    ds_read_b64_tr_b16 v[238:239], v2 offset:18688
    v_exp_f32 v162, v162
    s_waitcnt lgkmcnt(6)
    v_mfma_f32_16x16x32_bf16 v[200:203], v[228:231], v[88:91], v[200:203]
    ds_read_b64_tr_b16 v[224:225], v1 offset:8192
    v_exp_f32 v163, v163
    v_mfma_f32_16x16x32_bf16 v[204:207], v[228:231], v[92:95], v[204:207]
    ds_read_b64_tr_b16 v[226:227], v1 offset:8448
    s_waitcnt lgkmcnt(6)
    v_mfma_f32_16x16x32_bf16 v[208:211], v[232:235], v[88:91], v[208:211]
    ds_read_b64_tr_b16 v[228:229], v2 offset:8192
    s_waitcnt lgkmcnt(5)
    v_mfma_f32_16x16x32_bf16 v[244:247], v[240:243], v[8:11], v[244:247]
    v_fma_f32 v160, v160, v6, v6
    s_add_u32 m0, s52, 32768
    s_add_u32 s59, s53, 1179840
    buffer_load_dwordx4 v4, s[28:31], s59 offen lds
    v_mfma_f32_16x16x32_bf16 v[212:215], v[232:235], v[92:95], v[212:215]
    ds_read_b64_tr_b16 v[230:231], v2 offset:8448
    v_fma_f32 v161, v161, v6, v6
    s_waitcnt lgkmcnt(4)
    v_mfma_f32_16x16x32_bf16 v[216:219], v[236:239], v[88:91], v[216:219]
    ds_read_b64_tr_b16 v[232:233], v1 offset:20480
    v_fma_f32 v162, v162, v6, v6
    v_mfma_f32_16x16x32_bf16 v[220:223], v[236:239], v[92:95], v[220:223]
    ds_read_b64_tr_b16 v[234:235], v1 offset:20736
    v_fma_f32 v163, v163, v6, v6
    s_waitcnt lgkmcnt(4)
    v_mfma_f32_16x16x32_bf16 v[192:195], v[224:227], v[96:99], v[192:195]
    ds_read_b64_tr_b16 v[236:237], v2 offset:20480
    v_mfma_f32_16x16x32_bf16 v[196:199], v[224:227], v[100:103], v[196:199]
    ds_read_b64_tr_b16 v[238:239], v2 offset:20736
    v_rcp_f32 v160, v160
    s_waitcnt lgkmcnt(4)
    v_mfma_f32_16x16x32_bf16 v[200:203], v[228:231], v[96:99], v[200:203]
    ds_read_b64_tr_b16 v[224:225], v1 offset:10240
    v_rcp_f32 v161, v161
    v_mfma_f32_16x16x32_bf16 v[204:207], v[228:231], v[100:103], v[204:207]
    ds_read_b64_tr_b16 v[226:227], v1 offset:10496
    s_lshl_b32 s54, s44, 8
    s_add_u32 s54, s54, s2
    s_mul_i32 s55, s54, 7282
    s_lshr_b32 s55, s55, 16
    s_mul_i32 s59, s55, 9
    s_sub_u32 s59, s54, s59
    s_lshl_b32 s62, s54, 12
    s_add_u32 s62, s62, 18874368
    s_mov_b32 s43, 0x00020000
    s_lshl_b32 s59, s59, 7
    s_lshl_b32 s54, s44, 12
    s_add_u32 s54, s54, 122880
    v_bfe_u32 v8, v0, 7, 1
    v_mul_u32_u24 v8, 1152, v8
    v_and_b32 v9, 0x70, v0
    v_add_u32 v8, v8, v9
    v_bfe_u32 v9, v0, 8, 1
    v_lshrrev_b32 v10, 9, v0
    v_mul_u32_u24 v9, 1152, v9
    v_mul_u32_u24 v10, 1152, v10
    s_cmp_lt_u32 s55, 144
    s_cbranch_scc0 KA_RLWO
    s_mov_b32 s40, s20
    s_mov_b32 s41, s21
    s_mov_b32 s42, 5308416
    s_cmp_lt_u32 s55, 128
    s_cselect_b32 s60, 4, 2
    s_cselect_b32 s61, 4, 8
    s_mul_i32 s61, s61, 1152
    s_mul_i32 s55, s55, 36864
    s_add_u32 s59, s59, s55
    v_lshl_add_u32 v11, v9, 1, v8
    v_lshl_add_u32 v11, v10, s60, v11
    s_add_u32 m0, s54, 0
    s_nop 0
    buffer_load_dwordx4 v11, s[40:43], s59 offen nt lds
    s_add_u32 m0, s54, 1024
    s_add_u32 s59, s59, s61
    buffer_load_dwordx4 v11, s[40:43], s59 offen nt lds
    s_add_u32 m0, s54, 2048
    s_add_u32 s59, s59, s61
    buffer_load_dwordx4 v11, s[40:43], s59 offen nt lds
    s_add_u32 m0, s54, 3072
    s_add_u32 s59, s59, s61
    buffer_load_dwordx4 v11, s[40:43], s59 offen nt lds
    s_branch KA_RLE
KA_RLWO:
    s_mov_b32 s40, s12
    s_mov_b32 s41, s13
    s_cmp_lt_u32 s55, 162
    s_cselect_b32 s42, 663552, 0
    s_cselect_b32 s62, s62, 0x7f000000
    s_sub_u32 s55, s55, 144
    s_lshl_b32 s55, s55, 2
    s_add_u32 s60, s55, 0
    s_mul_i32 s61, s60, 7282
    s_lshr_b32 s61, s61, 16
    s_mul_i32 vcc_lo, s61, 9
    s_sub_u32 s60, s60, vcc_lo
    s_mul_i32 s61, s61, 72
    s_lshr_b32 vcc_lo, s60, 1
    s_mul_i32 vcc_lo, vcc_lo, 18
    s_and_b32 vcc_hi, s60, 1
    s_lshl_b32 vcc_hi, vcc_hi, 2
    s_add_u32 vcc_lo, vcc_lo, vcc_hi
    s_cmp_eq_u32 s60, 8
    s_cselect_b32 vcc_lo, 16, vcc_lo
    s_add_u32 s61, s61, vcc_lo
    s_mul_i32 s61, s61, 1152
    s_add_u32 s61, s61, s59
    s_cmp_eq_u32 s60, 8
    s_cselect_b32 vcc_lo, 18, 2
    s_cselect_b32 vcc_hi, 36, 8
    v_mad_u32_u24 v11, v9, vcc_lo, v8
    v_mad_u32_u24 v11, v10, vcc_hi, v11
    s_add_u32 m0, s54, 0
    s_nop 0
    buffer_load_dwordx4 v11, s[40:43], s61 offen nt lds
    s_add_u32 s60, s55, 1
    s_mul_i32 s61, s60, 7282
    s_lshr_b32 s61, s61, 16
    s_mul_i32 vcc_lo, s61, 9
    s_sub_u32 s60, s60, vcc_lo
    s_mul_i32 s61, s61, 72
    s_lshr_b32 vcc_lo, s60, 1
    s_mul_i32 vcc_lo, vcc_lo, 18
    s_and_b32 vcc_hi, s60, 1
    s_lshl_b32 vcc_hi, vcc_hi, 2
    s_add_u32 vcc_lo, vcc_lo, vcc_hi
    s_cmp_eq_u32 s60, 8
    s_cselect_b32 vcc_lo, 16, vcc_lo
    s_add_u32 s61, s61, vcc_lo
    s_mul_i32 s61, s61, 1152
    s_add_u32 s61, s61, s59
    s_cmp_eq_u32 s60, 8
    s_cselect_b32 vcc_lo, 18, 2
    s_cselect_b32 vcc_hi, 36, 8
    v_mad_u32_u24 v11, v9, vcc_lo, v8
    v_mad_u32_u24 v11, v10, vcc_hi, v11
    s_add_u32 m0, s54, 1024
    s_nop 0
    buffer_load_dwordx4 v11, s[40:43], s61 offen nt lds
    s_add_u32 s60, s55, 2
    s_mul_i32 s61, s60, 7282
    s_lshr_b32 s61, s61, 16
    s_mul_i32 vcc_lo, s61, 9
    s_sub_u32 s60, s60, vcc_lo
    s_mul_i32 s61, s61, 72
    s_lshr_b32 vcc_lo, s60, 1
    s_mul_i32 vcc_lo, vcc_lo, 18
    s_and_b32 vcc_hi, s60, 1
    s_lshl_b32 vcc_hi, vcc_hi, 2
    s_add_u32 vcc_lo, vcc_lo, vcc_hi
    s_cmp_eq_u32 s60, 8
    s_cselect_b32 vcc_lo, 16, vcc_lo
    s_add_u32 s61, s61, vcc_lo
    s_mul_i32 s61, s61, 1152
    s_add_u32 s61, s61, s59
    s_cmp_eq_u32 s60, 8
    s_cselect_b32 vcc_lo, 18, 2
    s_cselect_b32 vcc_hi, 36, 8
    v_mad_u32_u24 v11, v9, vcc_lo, v8
    v_mad_u32_u24 v11, v10, vcc_hi, v11
    s_add_u32 m0, s54, 2048
    s_nop 0
    buffer_load_dwordx4 v11, s[40:43], s61 offen nt lds
    s_add_u32 s60, s55, 3
    s_mul_i32 s61, s60, 7282
    s_lshr_b32 s61, s61, 16
    s_mul_i32 vcc_lo, s61, 9
    s_sub_u32 s60, s60, vcc_lo
    s_mul_i32 s61, s61, 72
    s_lshr_b32 vcc_lo, s60, 1
    s_mul_i32 vcc_lo, vcc_lo, 18
    s_and_b32 vcc_hi, s60, 1
    s_lshl_b32 vcc_hi, vcc_hi, 2
    s_add_u32 vcc_lo, vcc_lo, vcc_hi
    s_cmp_eq_u32 s60, 8
    s_cselect_b32 vcc_lo, 16, vcc_lo
    s_add_u32 s61, s61, vcc_lo
    s_mul_i32 s61, s61, 1152
    s_add_u32 s61, s61, s59
    s_cmp_eq_u32 s60, 8
    s_cselect_b32 vcc_lo, 18, 2
    s_cselect_b32 vcc_hi, 36, 8
    v_mad_u32_u24 v11, v9, vcc_lo, v8
    v_mad_u32_u24 v11, v10, vcc_hi, v11
    s_add_u32 m0, s54, 3072
    s_nop 0
    buffer_load_dwordx4 v11, s[40:43], s61 offen nt lds
KA_RLE:
    v_rcp_f32 v162, v162
    s_waitcnt lgkmcnt(4)
    v_mfma_f32_16x16x32_bf16 v[208:211], v[232:235], v[96:99], v[208:211]
    ds_read_b64_tr_b16 v[228:229], v2 offset:10240
    v_rcp_f32 v163, v163
    v_mfma_f32_16x16x32_bf16 v[212:215], v[232:235], v[100:103], v[212:215]
    ds_read_b64_tr_b16 v[230:231], v2 offset:10496
    s_waitcnt lgkmcnt(4)
    v_mfma_f32_16x16x32_bf16 v[216:219], v[236:239], v[96:99], v[216:219]
    ds_read_b64_tr_b16 v[232:233], v1 offset:22528
    v_mul_f32 v168, v160, v168
    v_mfma_f32_16x16x32_bf16 v[220:223], v[236:239], v[100:103], v[220:223]
    ds_read_b64_tr_b16 v[234:235], v1 offset:22784
    v_mul_f32 v169, v161, v169
    s_waitcnt lgkmcnt(4)
    v_mfma_f32_16x16x32_bf16 v[192:195], v[224:227], v[104:107], v[192:195]
    ds_read_b64_tr_b16 v[236:237], v2 offset:22528
    v_mul_f32 v170, v162, v170
    v_mfma_f32_16x16x32_bf16 v[196:199], v[224:227], v[108:111], v[196:199]
    ds_read_b64_tr_b16 v[238:239], v2 offset:22784
    s_waitcnt vmcnt(8)
    s_waitcnt vmcnt(7)
    s_barrier
    s_cmp_lg_u32 s44, 0
    s_cbranch_scc1 KA_NOES
    s_lshl_b32 s54, s2, 2
    s_add_u32 s54, s54, 30162944
    v_mov_b32 v5, 1
    s_mov_b64 exec, 1
    buffer_store_dword v5, v0, s[36:39], s54 offen sc1
    s_mov_b64 exec, -1
KA_NOES:
    s_waitcnt lgkmcnt(4)
    v_mfma_f32_16x16x32_bf16 v[200:203], v[228:231], v[104:107], v[200:203]
    ds_read_b64_tr_b16 v[224:225], v1 offset:24576
    v_mul_f32 v171, v163, v171
    v_mfma_f32_16x16x32_bf16 v[204:207], v[228:231], v[108:111], v[204:207]
    ds_read_b64_tr_b16 v[226:227], v1 offset:24832
    v_cvt_pk_bf16_f32 v160, v168, v169
    s_waitcnt lgkmcnt(4)
    v_mfma_f32_16x16x32_bf16 v[208:211], v[232:235], v[104:107], v[208:211]
    ds_read_b64_tr_b16 v[228:229], v2 offset:24576
    v_cvt_pk_bf16_f32 v161, v170, v171
    s_add_u32 m0, s52, 0
    s_add_u32 s59, s53, 1769664
    buffer_load_dwordx4 v4, s[28:31], s59 offen lds
    v_mfma_f32_16x16x32_bf16 v[212:215], v[232:235], v[108:111], v[212:215]
    ds_read_b64_tr_b16 v[230:231], v2 offset:24832
    v_fma_f32 v164, v13, v248, v164
    s_waitcnt lgkmcnt(4)
    v_mfma_f32_16x16x32_bf16 v[216:219], v[236:239], v[104:107], v[216:219]
    ds_read_b64_tr_b16 v[232:233], v1 offset:36864
    v_mfma_f32_16x16x32_bf16 v[220:223], v[236:239], v[108:111], v[220:223]
    ds_read_b64_tr_b16 v[234:235], v1 offset:37120
    v_fma_f32 v165, v13, v249, v165
    s_waitcnt lgkmcnt(4)
    v_mfma_f32_16x16x32_bf16 v[192:195], v[224:227], v[112:115], v[192:195]
    ds_read_b64_tr_b16 v[236:237], v2 offset:36864
    v_add_u32 v3, 0x6000, v3
    v_fma_f32 v166, v13, v250, v166
    v_mfma_f32_16x16x32_bf16 v[196:199], v[224:227], v[116:119], v[196:199]
    ds_read_b64_tr_b16 v[238:239], v2 offset:37120
    v_fma_f32 v167, v13, v251, v167
    s_waitcnt lgkmcnt(4)
    v_mfma_f32_16x16x32_bf16 v[200:203], v[228:231], v[112:115], v[200:203]
    ds_read_b64_tr_b16 v[224:225], v1 offset:26624
    v_fma_f32 v172, v13, v252, v172
    v_mfma_f32_16x16x32_bf16 v[204:207], v[228:231], v[116:119], v[204:207]
    ds_read_b64_tr_b16 v[226:227], v1 offset:26880
    s_waitcnt lgkmcnt(4)
    v_mfma_f32_16x16x32_bf16 v[208:211], v[232:235], v[112:115], v[208:211]
    ds_read_b64_tr_b16 v[228:229], v2 offset:26624
    v_fma_f32 v173, v13, v253, v173
    v_mfma_f32_16x16x32_bf16 v[212:215], v[232:235], v[116:119], v[212:215]
    ds_read_b64_tr_b16 v[230:231], v2 offset:26880
    v_fma_f32 v174, v13, v254, v174
    s_waitcnt lgkmcnt(4)
    v_mfma_f32_16x16x32_bf16 v[216:219], v[236:239], v[112:115], v[216:219]
    ds_read_b64_tr_b16 v[232:233], v1 offset:38912
    v_fma_f32 v175, v13, v255, v175
    v_mfma_f32_16x16x32_bf16 v[220:223], v[236:239], v[116:119], v[220:223]
    ds_read_b64_tr_b16 v[234:235], v1 offset:39168
    v_mul_f32 v172, v164, v172
    s_waitcnt lgkmcnt(4)
    v_mfma_f32_16x16x32_bf16 v[192:195], v[224:227], v[120:123], v[192:195]
    ds_read_b64_tr_b16 v[236:237], v2 offset:38912
    v_mfma_f32_16x16x32_bf16 v[196:199], v[224:227], v[124:127], v[196:199]
    ds_read_b64_tr_b16 v[238:239], v2 offset:39168
    v_mul_f32 v173, v165, v173
    s_waitcnt lgkmcnt(4)
    v_mfma_f32_16x16x32_bf16 v[200:203], v[228:231], v[120:123], v[200:203]
    ds_read_b64_tr_b16 v[224:225], v1 offset:28672
    v_mul_f32 v174, v166, v174
    v_mfma_f32_16x16x32_bf16 v[204:207], v[228:231], v[124:127], v[204:207]
    ds_read_b64_tr_b16 v[226:227], v1 offset:28928
    ds_read_b64_tr_b16 v[8:9], v3 offset:0
    ds_read_b64_tr_b16 v[10:11], v3 offset:256
    v_mul_f32 v175, v167, v175
    s_waitcnt lgkmcnt(6)
    v_mfma_f32_16x16x32_bf16 v[208:211], v[232:235], v[120:123], v[208:211]
    ds_read_b64_tr_b16 v[228:229], v2 offset:28672
    v_mul_f32 v164, v15, v164
    s_add_u32 m0, s52, 4096
    s_add_u32 s59, s53, 2359488
    buffer_load_dwordx4 v4, s[28:31], s59 offen lds
    v_mfma_f32_16x16x32_bf16 v[212:215], v[232:235], v[124:127], v[212:215]
    ds_read_b64_tr_b16 v[230:231], v2 offset:28928
    s_waitcnt lgkmcnt(6)
    v_mfma_f32_16x16x32_bf16 v[216:219], v[236:239], v[120:123], v[216:219]
    ds_read_b64_tr_b16 v[232:233], v1 offset:40960
    v_mul_f32 v165, v15, v165
    v_mfma_f32_16x16x32_bf16 v[220:223], v[236:239], v[124:127], v[220:223]
    ds_read_b64_tr_b16 v[234:235], v1 offset:41216
    v_mul_f32 v166, v15, v166
    s_waitcnt lgkmcnt(6)
    v_mfma_f32_16x16x32_bf16 v[192:195], v[224:227], v[128:131], v[192:195]
    ds_read_b64_tr_b16 v[236:237], v2 offset:40960
    s_waitcnt lgkmcnt(5)
    v_mfma_f32_16x16x32_bf16 v[244:247], v[240:243], v[8:11], v[244:247]
    v_mul_f32 v167, v15, v167
    v_mfma_f32_16x16x32_bf16 v[196:199], v[224:227], v[132:135], v[196:199]
    ds_read_b64_tr_b16 v[238:239], v2 offset:41216
    ds_read_b64_tr_b16 v[8:9], v3 offset:2048
    ds_read_b64_tr_b16 v[10:11], v3 offset:2304
    s_waitcnt lgkmcnt(6)
    v_mfma_f32_16x16x32_bf16 v[200:203], v[228:231], v[128:131], v[200:203]
    ds_read_b64_tr_b16 v[224:225], v1 offset:30720
    v_exp_f32 v164, v164
    v_mfma_f32_16x16x32_bf16 v[204:207], v[228:231], v[132:135], v[204:207]
    ds_read_b64_tr_b16 v[226:227], v1 offset:30976
    v_exp_f32 v165, v165
    s_waitcnt lgkmcnt(6)
    v_mfma_f32_16x16x32_bf16 v[208:211], v[232:235], v[128:131], v[208:211]
    ds_read_b64_tr_b16 v[228:229], v2 offset:30720
    v_exp_f32 v166, v166
    v_mfma_f32_16x16x32_bf16 v[212:215], v[232:235], v[132:135], v[212:215]
    ds_read_b64_tr_b16 v[230:231], v2 offset:30976
    v_exp_f32 v167, v167
    s_waitcnt lgkmcnt(6)
    v_mfma_f32_16x16x32_bf16 v[216:219], v[236:239], v[128:131], v[216:219]
    ds_read_b64_tr_b16 v[232:233], v1 offset:43008
    s_waitcnt lgkmcnt(5)
    v_mfma_f32_16x16x32_bf16 v[244:247], v[240:243], v[8:11], v[244:247]
    v_mfma_f32_16x16x32_bf16 v[220:223], v[236:239], v[132:135], v[220:223]
    ds_read_b64_tr_b16 v[234:235], v1 offset:43264
    ds_read_b64_tr_b16 v[8:9], v3 offset:4096
    ds_read_b64_tr_b16 v[10:11], v3 offset:4352
    v_fma_f32 v164, v164, v7, v7
    s_waitcnt lgkmcnt(6)
    v_mfma_f32_16x16x32_bf16 v[192:195], v[224:227], v[136:139], v[192:195]
    ds_read_b64_tr_b16 v[236:237], v2 offset:43008
    v_fma_f32 v165, v165, v7, v7
    v_mfma_f32_16x16x32_bf16 v[196:199], v[224:227], v[140:143], v[196:199]
    ds_read_b64_tr_b16 v[238:239], v2 offset:43264
    v_fma_f32 v166, v166, v7, v7
    s_waitcnt lgkmcnt(6)
    v_mfma_f32_16x16x32_bf16 v[200:203], v[228:231], v[136:139], v[200:203]
    ds_read_b64_tr_b16 v[224:225], v1 offset:32768
    v_fma_f32 v167, v167, v7, v7
    v_mfma_f32_16x16x32_bf16 v[204:207], v[228:231], v[140:143], v[204:207]
    ds_read_b64_tr_b16 v[226:227], v1 offset:33024
    s_waitcnt lgkmcnt(6)
    v_mfma_f32_16x16x32_bf16 v[208:211], v[232:235], v[136:139], v[208:211]
    ds_read_b64_tr_b16 v[228:229], v2 offset:32768
    s_waitcnt lgkmcnt(5)
    v_mfma_f32_16x16x32_bf16 v[244:247], v[240:243], v[8:11], v[244:247]
    v_rcp_f32 v164, v164
    s_add_u32 m0, s52, 8192
    s_add_u32 s59, s53, 2949312
    buffer_load_dwordx4 v4, s[28:31], s59 offen lds
    v_mfma_f32_16x16x32_bf16 v[212:215], v[232:235], v[140:143], v[212:215]
    ds_read_b64_tr_b16 v[230:231], v2 offset:33024
    v_rcp_f32 v165, v165
    s_waitcnt lgkmcnt(4)
    v_mfma_f32_16x16x32_bf16 v[216:219], v[236:239], v[136:139], v[216:219]
    ds_read_b64_tr_b16 v[232:233], v1 offset:45056
    v_rcp_f32 v166, v166
    v_mfma_f32_16x16x32_bf16 v[220:223], v[236:239], v[140:143], v[220:223]
    ds_read_b64_tr_b16 v[234:235], v1 offset:45312
    v_rcp_f32 v167, v167
    s_waitcnt lgkmcnt(4)
    v_mfma_f32_16x16x32_bf16 v[192:195], v[224:227], v[144:147], v[192:195]
    ds_read_b64_tr_b16 v[236:237], v2 offset:45056
    v_mfma_f32_16x16x32_bf16 v[196:199], v[224:227], v[148:151], v[196:199]
    ds_read_b64_tr_b16 v[238:239], v2 offset:45312
    v_mul_f32 v172, v164, v172
    s_waitcnt lgkmcnt(4)
    v_mfma_f32_16x16x32_bf16 v[200:203], v[228:231], v[144:147], v[200:203]
    ds_read_b64_tr_b16 v[224:225], v1 offset:34816
    v_lshrrev_b32 v5, 2, v0
    s_lshl_b32 s54, s44, 6
    s_add_u32 s54, s54, 157184
    v_add_u32 v5, s54, v5
    s_mov_b64 exec, 0xffff
    ds_write_b32 v5, v244
    s_mov_b64 exec, -1
    v_mul_f32 v173, v165, v173
    v_mfma_f32_16x16x32_bf16 v[204:207], v[228:231], v[148:151], v[204:207]
    ds_read_b64_tr_b16 v[226:227], v1 offset:35072
    v_mul_f32 v174, v166, v174
    s_waitcnt lgkmcnt(5)
    v_mfma_f32_16x16x32_bf16 v[208:211], v[232:235], v[144:147], v[208:211]
    ds_read_b64_tr_b16 v[228:229], v2 offset:34816
    v_mul_f32 v175, v167, v175
    v_mfma_f32_16x16x32_bf16 v[212:215], v[232:235], v[148:151], v[212:215]
    ds_read_b64_tr_b16 v[230:231], v2 offset:35072
    s_waitcnt lgkmcnt(5)
    v_mfma_f32_16x16x32_bf16 v[216:219], v[236:239], v[144:147], v[216:219]
    ds_read_b64_tr_b16 v[232:233], v1 offset:47104
    v_cvt_pk_bf16_f32 v162, v172, v173
    v_mfma_f32_16x16x32_bf16 v[220:223], v[236:239], v[148:151], v[220:223]
    ds_read_b64_tr_b16 v[234:235], v1 offset:47360
    v_cvt_pk_bf16_f32 v163, v174, v175
    s_waitcnt lgkmcnt(4)
    v_mfma_f32_16x16x32_bf16 v[192:195], v[224:227], v[152:155], v[192:195]
    ds_read_b64_tr_b16 v[236:237], v2 offset:47104
    s_lshr_b32 s54, s46, 1
    s_lshl_b32 s54, s54, 12
    s_and_b32 s55, s46, 1
    s_lshl_b32 s55, s55, 9
    s_add_u32 s54, s54, s55
    s_add_u32 s54, s54, s57
    s_add_u32 s54, s54, 524288
    v_permlane16_swap_b32 v160, v162
    v_permlane16_swap_b32 v161, v163
    v_and_b32 v5, 0x100, v0
    v_lshlrev_b32 v5, 2, v5
    v_and_or_b32 v5, v0, s10, v5
    v_lshrrev_b32 v164, 1, v0
    v_and_b32 v164, 0x100, v164
    v_add_u32 v5, v5, v164
    buffer_store_dwordx4 v[160:163], v5, s[36:39], s54 offen sc1
    v_mfma_f32_16x16x32_bf16 v[196:199], v[224:227], v[156:159], v[196:199]
    ds_read_b64_tr_b16 v[238:239], v2 offset:47360
    s_waitcnt vmcnt(8)
    s_barrier
    s_waitcnt lgkmcnt(4)
    v_mfma_f32_16x16x32_bf16 v[200:203], v[228:231], v[152:155], v[200:203]
    v_add_u32 v1, 0xffffa000, v1
    ds_read_b64_tr_b16 v[224:225], v1 offset:0
    v_mfma_f32_16x16x32_bf16 v[204:207], v[228:231], v[156:159], v[204:207]
    ds_read_b64_tr_b16 v[226:227], v1 offset:256
    s_waitcnt lgkmcnt(4)
    v_mfma_f32_16x16x32_bf16 v[208:211], v[232:235], v[152:155], v[208:211]
    ds_read_b64_tr_b16 v[228:229], v1 offset:12288
    s_add_u32 m0, s52, 49152
    s_add_u32 s59, s53, 3539136
    buffer_load_dwordx4 v4, s[28:31], s59 offen lds
    v_mfma_f32_16x16x32_bf16 v[212:215], v[232:235], v[156:159], v[212:215]
    ds_read_b64_tr_b16 v[230:231], v1 offset:12544
    s_waitcnt lgkmcnt(4)
    v_mfma_f32_16x16x32_bf16 v[216:219], v[236:239], v[152:155], v[216:219]
    ds_read_b64_tr_b16 v[232:233], v1 offset:2048
    v_mfma_f32_16x16x32_bf16 v[220:223], v[236:239], v[156:159], v[220:223]
    ds_read_b64_tr_b16 v[234:235], v1 offset:2304
    s_waitcnt lgkmcnt(4)
    v_mfma_f32_16x16x32_bf16 v[160:163], v[224:227], v[16:19], 0
    ds_read_b64_tr_b16 v[236:237], v1 offset:14336
    v_lshrrev_b32 v5, 4, v0
    v_and_b32 v5, 48, v5
    v_add_u32 v5, 157184, v5
    ds_read_b128 v[248:251], v5 offset:0
    ds_read_b128 v[244:247], v5 offset:256
    ds_read_b128 v[252:255], v5 offset:128
    ds_read_b128 v[8:11], v5 offset:384
    s_add_u32 m0, s52, 53248
    s_add_u32 s59, s53, 4128960
    buffer_load_dwordx4 v4, s[28:31], s59 offen lds
    v_mfma_f32_16x16x32_bf16 v[164:167], v[224:227], v[20:23], 0
    ds_read_b64_tr_b16 v[238:239], v1 offset:14592
    s_waitcnt lgkmcnt(8)
    v_mfma_f32_16x16x32_bf16 v[176:179], v[228:231], v[16:19], 0
    ds_read_b64_tr_b16 v[224:225], v1 offset:4096
    v_mfma_f32_16x16x32_bf16 v[180:183], v[228:231], v[20:23], 0
    ds_read_b64_tr_b16 v[226:227], v1 offset:4352
    s_waitcnt lgkmcnt(8)
    v_mfma_f32_16x16x32_bf16 v[160:163], v[232:235], v[24:27], v[160:163]
    ds_read_b64_tr_b16 v[228:229], v1 offset:16384
    s_add_u32 m0, s52, 57344
    s_add_u32 s59, s53, 4718784
    buffer_load_dwordx4 v4, s[28:31], s59 offen lds
    v_mfma_f32_16x16x32_bf16 v[164:167], v[232:235], v[28:31], v[164:167]
    ds_read_b64_tr_b16 v[230:231], v1 offset:16640
    s_waitcnt lgkmcnt(5)
    v_add_f32 v248, v248, v244
    v_add_f32 v249, v249, v245
    v_add_f32 v250, v250, v246
    v_add_f32 v251, v251, v247
    s_waitcnt lgkmcnt(4)
    v_mfma_f32_16x16x32_bf16 v[176:179], v[236:239], v[24:27], v[176:179]
    ds_read_b64_tr_b16 v[232:233], v1 offset:6144
    v_add_f32 v252, v252, v8
    v_add_f32 v253, v253, v9
    v_add_f32 v254, v254, v10
    v_add_f32 v255, v255, v11
    v_mfma_f32_16x16x32_bf16 v[180:183], v[236:239], v[28:31], v[180:183]
    ds_read_b64_tr_b16 v[234:235], v1 offset:6400
    s_waitcnt lgkmcnt(4)
    v_mfma_f32_16x16x32_bf16 v[160:163], v[224:227], v[32:35], v[160:163]
    ds_read_b64_tr_b16 v[236:237], v1 offset:18432
    v_fma_f32 v192, v12, v248, v192
    v_fma_f32 v193, v12, v249, v193
    v_mfma_f32_16x16x32_bf16 v[164:167], v[224:227], v[36:39], v[164:167]
    ds_read_b64_tr_b16 v[238:239], v1 offset:18688
    v_add_u32 v3, 0xffff4000, v3
    v_fma_f32 v194, v12, v250, v194
    v_fma_f32 v195, v12, v251, v195
    s_waitcnt lgkmcnt(4)
    v_mfma_f32_16x16x32_bf16 v[176:179], v[228:231], v[32:35], v[176:179]
    ds_read_b64_tr_b16 v[224:225], v1 offset:8192
    ds_read_b64_tr_b16 v[8:9], v3 offset:0
    ds_read_b64_tr_b16 v[10:11], v3 offset:256
    v_fma_f32 v208, v12, v252, v208
    v_mfma_f32_16x16x32_bf16 v[180:183], v[228:231], v[36:39], v[180:183]
    ds_read_b64_tr_b16 v[226:227], v1 offset:8448
    v_fma_f32 v209, v12, v253, v209
    v_fma_f32 v210, v12, v254, v210
    s_waitcnt lgkmcnt(6)
    v_mfma_f32_16x16x32_bf16 v[160:163], v[232:235], v[40:43], v[160:163]
    ds_read_b64_tr_b16 v[228:229], v1 offset:20480
    v_fma_f32 v211, v12, v255, v211
    v_mul_f32 v208, v192, v208
    v_mfma_f32_16x16x32_bf16 v[164:167], v[232:235], v[44:47], v[164:167]
    ds_read_b64_tr_b16 v[230:231], v1 offset:20736
    v_mul_f32 v209, v193, v209
    s_waitcnt lgkmcnt(6)
    v_mfma_f32_16x16x32_bf16 v[176:179], v[236:239], v[40:43], v[176:179]
    ds_read_b64_tr_b16 v[232:233], v1 offset:10240
    s_waitcnt lgkmcnt(4)
    v_mfma_f32_16x16x32_bf16 v[244:247], v[240:243], v[8:11], 0
    s_waitcnt vmcnt(7)
    v_lshrrev_b32 v5, 8, v0
    v_lshlrev_b32 v5, 10, v5
    v_and_b32 v168, 0xc0, v0
    v_lshl_add_u32 v5, v168, 1, v5
    v_bfe_u32 v168, v0, 4, 2
    v_lshl_add_u32 v5, v168, 3, v5
    s_lshl_b32 s54, s44, 12
    s_add_u32 s54, s54, 122880
    v_add_u32 v5, s54, v5
    ds_read_b64_tr_b16 v[168:169], v5 offset:0
    ds_read_b64_tr_b16 v[170:171], v5 offset:512
    ds_read_b64_tr_b16 v[172:173], v5 offset:32
    ds_read_b64_tr_b16 v[174:175], v5 offset:544
    ds_read_b64_tr_b16 v[184:185], v5 offset:64
    ds_read_b64_tr_b16 v[186:187], v5 offset:576
    ds_read_b64_tr_b16 v[188:189], v5 offset:96
    ds_read_b64_tr_b16 v[190:191], v5 offset:608
    v_mul_f32 v210, v194, v210
    v_mul_f32 v211, v195, v211
    v_mfma_f32_16x16x32_bf16 v[180:183], v[236:239], v[44:47], v[180:183]
    ds_read_b64_tr_b16 v[234:235], v1 offset:10496
    ds_read_b64_tr_b16 v[8:9], v3 offset:2048
    ds_read_b64_tr_b16 v[10:11], v3 offset:2304
    v_mul_f32 v192, v14, v192
    v_mul_f32 v193, v14, v193
    s_waitcnt lgkmcnt(14)
    v_mfma_f32_16x16x32_bf16 v[160:163], v[224:227], v[48:51], v[160:163]
    ds_read_b64_tr_b16 v[236:237], v1 offset:22528
    v_mul_f32 v194, v14, v194
    v_mfma_f32_16x16x32_bf16 v[164:167], v[224:227], v[52:55], v[164:167]
    ds_read_b64_tr_b16 v[238:239], v1 offset:22784
    v_mul_f32 v195, v14, v195
    v_exp_f32 v192, v192
    s_waitcnt vmcnt(4)
    s_barrier
    s_waitcnt lgkmcnt(14)
    v_mfma_f32_16x16x32_bf16 v[176:179], v[228:231], v[48:51], v[176:179]
    v_add_u32 v1, 0xffffa000, v1
    ds_read_b64_tr_b16 v[224:225], v1 offset:0
    v_exp_f32 v193, v193
    v_exp_f32 v194, v194
    v_mfma_f32_16x16x32_bf16 v[180:183], v[228:231], v[52:55], v[180:183]
    ds_read_b64_tr_b16 v[226:227], v1 offset:256
    s_waitcnt lgkmcnt(4)
    v_mfma_f32_16x16x32_bf16 v[244:247], v[240:243], v[8:11], v[244:247]
    v_exp_f32 v195, v195
    v_mfma_f32_16x16x32_bf16 v[160:163], v[232:235], v[56:59], v[160:163]
    ds_read_b64_tr_b16 v[228:229], v1 offset:12288
    ds_read_b64_tr_b16 v[8:9], v3 offset:4096
    ds_read_b64_tr_b16 v[10:11], v3 offset:4352
    v_fma_f32 v192, v192, v6, v6
    v_fma_f32 v193, v193, v6, v6
    v_mfma_f32_16x16x32_bf16 v[164:167], v[232:235], v[60:63], v[164:167]
    ds_read_b64_tr_b16 v[230:231], v1 offset:12544
    v_fma_f32 v194, v194, v6, v6
    v_fma_f32 v195, v195, v6, v6
    s_waitcnt lgkmcnt(6)
    v_mfma_f32_16x16x32_bf16 v[176:179], v[236:239], v[56:59], v[176:179]
    ds_read_b64_tr_b16 v[232:233], v1 offset:2048
    buffer_store_dwordx4 v[168:171], v0, s[36:39], s62 offen offset:0 sc1
    v_rcp_f32 v192, v192
    v_mfma_f32_16x16x32_bf16 v[180:183], v[236:239], v[60:63], v[180:183]
    ds_read_b64_tr_b16 v[234:235], v1 offset:2304
    v_rcp_f32 v193, v193
    v_rcp_f32 v194, v194
    s_waitcnt lgkmcnt(6)
    v_mfma_f32_16x16x32_bf16 v[160:163], v[224:227], v[64:67], v[160:163]
    ds_read_b64_tr_b16 v[236:237], v1 offset:14336
    s_waitcnt lgkmcnt(4)
    v_mfma_f32_16x16x32_bf16 v[244:247], v[240:243], v[8:11], v[244:247]
    v_add_u32 v3, 0xffffa000, v3
    v_rcp_f32 v195, v195
    v_mul_f32 v208, v192, v208
    v_mfma_f32_16x16x32_bf16 v[164:167], v[224:227], v[68:71], v[164:167]
    ds_read_b64_tr_b16 v[238:239], v1 offset:14592
    ds_read_b64_tr_b16 v[8:9], v3 offset:0
    ds_read_b64_tr_b16 v[10:11], v3 offset:256
    v_mul_f32 v209, v193, v209
    s_waitcnt lgkmcnt(6)
    v_mfma_f32_16x16x32_bf16 v[176:179], v[228:231], v[64:67], v[176:179]
    ds_read_b64_tr_b16 v[224:225], v1 offset:4096
    buffer_store_dwordx4 v[172:175], v0, s[36:39], s62 offen offset:1024 sc1
    v_mul_f32 v210, v194, v210
    v_mul_f32 v211, v195, v211
    v_mfma_f32_16x16x32_bf16 v[180:183], v[228:231], v[68:71], v[180:183]
    ds_read_b64_tr_b16 v[226:227], v1 offset:4352
    v_cvt_pk_bf16_f32 v192, v208, v209
    v_cvt_pk_bf16_f32 v193, v210, v211
    s_waitcnt lgkmcnt(6)
    v_mfma_f32_16x16x32_bf16 v[160:163], v[232:235], v[72:75], v[160:163]
    ds_read_b64_tr_b16 v[228:229], v1 offset:16384
    v_fma_f32 v196, v13, v248, v196
    v_mfma_f32_16x16x32_bf16 v[164:167], v[232:235], v[76:79], v[164:167]
    ds_read_b64_tr_b16 v[230:231], v1 offset:16640
    s_waitcnt lgkmcnt(4)
    v_mfma_f32_16x16x32_bf16 v[244:247], v[240:243], v[8:11], v[244:247]
    v_fma_f32 v197, v13, v249, v197
    v_fma_f32 v198, v13, v250, v198
    v_mfma_f32_16x16x32_bf16 v[176:179], v[236:239], v[72:75], v[176:179]
    ds_read_b64_tr_b16 v[232:233], v1 offset:6144
    ds_read_b64_tr_b16 v[8:9], v3 offset:2048
    ds_read_b64_tr_b16 v[10:11], v3 offset:2304
    buffer_store_dwordx4 v[184:187], v0, s[36:39], s62 offen offset:2048 sc1
    v_fma_f32 v199, v13, v251, v199
    v_fma_f32 v212, v13, v252, v212
    v_mfma_f32_16x16x32_bf16 v[180:183], v[236:239], v[76:79], v[180:183]
    ds_read_b64_tr_b16 v[234:235], v1 offset:6400
    v_fma_f32 v213, v13, v253, v213
    s_waitcnt lgkmcnt(6)
    v_mfma_f32_16x16x32_bf16 v[160:163], v[224:227], v[80:83], v[160:163]
    ds_read_b64_tr_b16 v[236:237], v1 offset:18432
    v_fma_f32 v214, v13, v254, v214
    v_fma_f32 v215, v13, v255, v215
    v_mfma_f32_16x16x32_bf16 v[164:167], v[224:227], v[84:87], v[164:167]
    ds_read_b64_tr_b16 v[238:239], v1 offset:18688
    v_mul_f32 v212, v196, v212
    v_mul_f32 v213, v197, v213
    s_waitcnt lgkmcnt(6)
    v_mfma_f32_16x16x32_bf16 v[176:179], v[228:231], v[80:83], v[176:179]
    ds_read_b64_tr_b16 v[224:225], v1 offset:8192
    s_waitcnt lgkmcnt(4)
    v_mfma_f32_16x16x32_bf16 v[244:247], v[240:243], v[8:11], v[244:247]
    buffer_store_dwordx4 v[188:191], v0, s[36:39], s62 offen offset:3072 sc1
    v_mul_f32 v214, v198, v214
    v_mfma_f32_16x16x32_bf16 v[180:183], v[228:231], v[84:87], v[180:183]
    ds_read_b64_tr_b16 v[226:227], v1 offset:8448
    ds_read_b64_tr_b16 v[8:9], v3 offset:4096
    ds_read_b64_tr_b16 v[10:11], v3 offset:4352
    v_mul_f32 v215, v199, v215
    v_mul_f32 v196, v15, v196
    s_waitcnt lgkmcnt(6)
    v_mfma_f32_16x16x32_bf16 v[160:163], v[232:235], v[88:91], v[160:163]
    ds_read_b64_tr_b16 v[228:229], v1 offset:20480
    v_mul_f32 v197, v15, v197
    v_mul_f32 v198, v15, v198
    v_mfma_f32_16x16x32_bf16 v[164:167], v[232:235], v[92:95], v[164:167]
    ds_read_b64_tr_b16 v[230:231], v1 offset:20736
    v_mul_f32 v199, v15, v199
    s_waitcnt vmcnt(4)
    s_barrier
    s_waitcnt lgkmcnt(6)
    v_mfma_f32_16x16x32_bf16 v[176:179], v[236:239], v[88:91], v[176:179]
    ds_read_b64_tr_b16 v[232:233], v1 offset:10240
    v_exp_f32 v196, v196
    v_exp_f32 v197, v197
    v_mfma_f32_16x16x32_bf16 v[180:183], v[236:239], v[92:95], v[180:183]
    ds_read_b64_tr_b16 v[234:235], v1 offset:10496
    s_waitcnt lgkmcnt(4)
    v_mfma_f32_16x16x32_bf16 v[244:247], v[240:243], v[8:11], v[244:247]
    v_add_u32 v3, 0xc000, v3
    v_exp_f32 v198, v198
    v_exp_f32 v199, v199
    v_mfma_f32_16x16x32_bf16 v[160:163], v[224:227], v[96:99], v[160:163]
    ds_read_b64_tr_b16 v[236:237], v1 offset:22528
    ds_read_b64_tr_b16 v[8:9], v3 offset:0
    ds_read_b64_tr_b16 v[10:11], v3 offset:256
    v_fma_f32 v196, v196, v7, v7
    v_mfma_f32_16x16x32_bf16 v[164:167], v[224:227], v[100:103], v[164:167]
    ds_read_b64_tr_b16 v[238:239], v1 offset:22784
    v_fma_f32 v197, v197, v7, v7
    v_fma_f32 v198, v198, v7, v7
    s_waitcnt lgkmcnt(6)
    v_mfma_f32_16x16x32_bf16 v[176:179], v[228:231], v[96:99], v[176:179]
    ds_read_b64_tr_b16 v[224:225], v1 offset:49152
    s_lshl_b32 s61, s44, 7
    s_add_u32 s61, s61, 30162944
    v_lshrrev_b32 v169, 2, v0
    v_and_b32 v169, 0x7c, v169
    buffer_load_dword v168, v169, s[36:39], s61 offen sc1
    v_fma_f32 v199, v199, v7, v7
    v_rcp_f32 v196, v196
    v_mfma_f32_16x16x32_bf16 v[180:183], v[228:231], v[100:103], v[180:183]
    ds_read_b64_tr_b16 v[226:227], v1 offset:49408
    v_rcp_f32 v197, v197
    s_waitcnt lgkmcnt(6)
    v_mfma_f32_16x16x32_bf16 v[160:163], v[232:235], v[104:107], v[160:163]
    ds_read_b64_tr_b16 v[228:229], v1 offset:61440
    s_waitcnt lgkmcnt(4)
    v_mfma_f32_16x16x32_bf16 v[244:247], v[240:243], v[8:11], v[244:247]
    v_rcp_f32 v198, v198
    v_rcp_f32 v199, v199
    v_mfma_f32_16x16x32_bf16 v[164:167], v[232:235], v[108:111], v[164:167]
    ds_read_b64_tr_b16 v[230:231], v1 offset:61696
    ds_read_b64_tr_b16 v[8:9], v3 offset:2048
    ds_read_b64_tr_b16 v[10:11], v3 offset:2304
    v_mul_f32 v212, v196, v212
    v_mul_f32 v213, v197, v213
    s_waitcnt lgkmcnt(6)
    v_mfma_f32_16x16x32_bf16 v[176:179], v[236:239], v[104:107], v[176:179]
    ds_read_b64_tr_b16 v[232:233], v1 offset:51200
    v_mul_f32 v214, v198, v214
    v_mfma_f32_16x16x32_bf16 v[180:183], v[236:239], v[108:111], v[180:183]
    ds_read_b64_tr_b16 v[234:235], v1 offset:51456
    v_mul_f32 v215, v199, v215
    v_cvt_pk_bf16_f32 v196, v212, v213
    s_waitcnt lgkmcnt(6)
    v_mfma_f32_16x16x32_bf16 v[160:163], v[224:227], v[112:115], v[160:163]
    ds_read_b64_tr_b16 v[236:237], v1 offset:63488
    v_cvt_pk_bf16_f32 v197, v214, v215
    v_lshrrev_b32 v5, 4, v0
    v_and_b32 v5, 48, v5
    v_add_u32 v5, 157184, v5
    ds_read_b128 v[248:251], v5 offset:64
    ds_read_b128 v[208:211], v5 offset:320
    ds_read_b128 v[252:255], v5 offset:192
    ds_read_b128 v[212:215], v5 offset:448
    v_mfma_f32_16x16x32_bf16 v[164:167], v[224:227], v[116:119], v[164:167]
    ds_read_b64_tr_b16 v[238:239], v1 offset:63744
    s_waitcnt lgkmcnt(8)
    v_mfma_f32_16x16x32_bf16 v[244:247], v[240:243], v[8:11], v[244:247]
    v_mfma_f32_16x16x32_bf16 v[176:179], v[228:231], v[112:115], v[176:179]
    ds_read_b64_tr_b16 v[224:225], v1 offset:53248
    ds_read_b64_tr_b16 v[8:9], v3 offset:4096
    ds_read_b64_tr_b16 v[10:11], v3 offset:4352
    v_mfma_f32_16x16x32_bf16 v[180:183], v[228:231], v[116:119], v[180:183]
    ds_read_b64_tr_b16 v[226:227], v1 offset:53504
    s_waitcnt lgkmcnt(5)
    v_add_f32 v248, v248, v208
    v_add_f32 v249, v249, v209
    v_add_f32 v250, v250, v210
    v_add_f32 v251, v251, v211
    v_mfma_f32_16x16x32_bf16 v[160:163], v[232:235], v[120:123], v[160:163]
    v_add_u32 v1, 0xc000, v1
    ds_read_b64_tr_b16 v[228:229], v1 offset:16384
    v_add_f32 v252, v252, v212
    v_add_f32 v253, v253, v213
    v_add_f32 v254, v254, v214
    v_add_f32 v255, v255, v215
    v_mfma_f32_16x16x32_bf16 v[164:167], v[232:235], v[124:127], v[164:167]
    ds_read_b64_tr_b16 v[230:231], v1 offset:16640
    v_fma_f32 v200, v12, v248, v200
    v_fma_f32 v201, v12, v249, v201
    s_waitcnt lgkmcnt(6)
    v_mfma_f32_16x16x32_bf16 v[176:179], v[236:239], v[120:123], v[176:179]
    ds_read_b64_tr_b16 v[232:233], v1 offset:6144
    s_waitcnt lgkmcnt(4)
    v_mfma_f32_16x16x32_bf16 v[244:247], v[240:243], v[8:11], v[244:247]
    v_fma_f32 v202, v12, v250, v202
    v_fma_f32 v203, v12, v251, v203
    v_mfma_f32_16x16x32_bf16 v[180:183], v[236:239], v[124:127], v[180:183]
    ds_read_b64_tr_b16 v[234:235], v1 offset:6400
    v_fma_f32 v216, v12, v252, v216
    s_waitcnt lgkmcnt(4)
    v_mfma_f32_16x16x32_bf16 v[160:163], v[224:227], v[128:131], v[160:163]
    ds_read_b64_tr_b16 v[236:237], v1 offset:18432
    v_fma_f32 v217, v12, v253, v217
    v_fma_f32 v218, v12, v254, v218
    v_mfma_f32_16x16x32_bf16 v[164:167], v[224:227], v[132:135], v[164:167]
    ds_read_b64_tr_b16 v[238:239], v1 offset:18688
    v_fma_f32 v219, v12, v255, v219
    v_mul_f32 v216, v200, v216
    s_waitcnt lgkmcnt(4)
    v_mfma_f32_16x16x32_bf16 v[176:179], v[228:231], v[128:131], v[176:179]
    ds_read_b64_tr_b16 v[224:225], v1 offset:8192
    v_mul_f32 v217, v201, v217
    v_mfma_f32_16x16x32_bf16 v[180:183], v[228:231], v[132:135], v[180:183]
    ds_read_b64_tr_b16 v[226:227], v1 offset:8448
    v_mul_f32 v218, v202, v218
    v_mul_f32 v219, v203, v219
    s_waitcnt lgkmcnt(4)
    v_mfma_f32_16x16x32_bf16 v[160:163], v[232:235], v[136:139], v[160:163]
    ds_read_b64_tr_b16 v[228:229], v1 offset:20480
    v_lshrrev_b32 v5, 2, v0
    s_lshl_b32 s54, s44, 6
    s_add_u32 s54, s54, 157696
    v_add_u32 v5, s54, v5
    s_mov_b64 exec, 0xffff
    ds_write_b32 v5, v244
    s_mov_b64 exec, -1
    v_mul_f32 v200, v14, v200
    v_mul_f32 v201, v14, v201
    v_mfma_f32_16x16x32_bf16 v[164:167], v[232:235], v[140:143], v[164:167]
    ds_read_b64_tr_b16 v[230:231], v1 offset:20736
    v_mul_f32 v202, v14, v202
    s_waitcnt lgkmcnt(5)
    v_mfma_f32_16x16x32_bf16 v[176:179], v[236:239], v[136:139], v[176:179]
    ds_read_b64_tr_b16 v[232:233], v1 offset:10240
    v_mul_f32 v203, v14, v203
    v_exp_f32 v200, v200
    v_mfma_f32_16x16x32_bf16 v[180:183], v[236:239], v[140:143], v[180:183]
    ds_read_b64_tr_b16 v[234:235], v1 offset:10496
    v_exp_f32 v201, v201
    v_exp_f32 v202, v202
    s_waitcnt lgkmcnt(5)
    v_mfma_f32_16x16x32_bf16 v[160:163], v[224:227], v[144:147], v[160:163]
    ds_read_b64_tr_b16 v[236:237], v1 offset:22528
    v_exp_f32 v203, v203
    v_mfma_f32_16x16x32_bf16 v[164:167], v[224:227], v[148:151], v[164:167]
    ds_read_b64_tr_b16 v[238:239], v1 offset:22784
    v_fma_f32 v200, v200, v6, v6
    v_fma_f32 v201, v201, v6, v6
    s_waitcnt lgkmcnt(4)
    v_mfma_f32_16x16x32_bf16 v[176:179], v[228:231], v[144:147], v[176:179]
    v_add_u32 v2, 0xffffa000, v2
    ds_read_b64_tr_b16 v[224:225], v2 offset:0
    v_fma_f32 v202, v202, v6, v6
    v_fma_f32 v203, v203, v6, v6
    v_mfma_f32_16x16x32_bf16 v[180:183], v[228:231], v[148:151], v[180:183]
    ds_read_b64_tr_b16 v[226:227], v2 offset:256
    v_rcp_f32 v200, v200
    s_waitcnt lgkmcnt(4)
    v_mfma_f32_16x16x32_bf16 v[160:163], v[232:235], v[152:155], v[160:163]
    ds_read_b64_tr_b16 v[228:229], v2 offset:12288
    s_waitcnt vmcnt(0)
    s_mov_b32 s60, 0x40000
KA_ES:
    v_cmp_ne_u32 vcc, 1, v168
    s_cmp_eq_u64 vcc, 0
    s_cbranch_scc1 KA_ES_OK
    s_sleep 32
    buffer_load_dword v168, v169, s[36:39], s61 offen sc1
    s_waitcnt vmcnt(0)
    s_sub_u32 s60, s60, 1
    s_cmp_lg_u32 s60, 0
    s_cbranch_scc1 KA_ES
KA_ES_OK:
    v_rcp_f32 v201, v201
    v_rcp_f32 v202, v202
    v_mfma_f32_16x16x32_bf16 v[164:167], v[232:235], v[156:159], v[164:167]
    ds_read_b64_tr_b16 v[230:231], v2 offset:12544
    v_rcp_f32 v203, v203
    v_mul_f32 v216, v200, v216
    s_barrier
    s_cmp_lg_u32 s44, 0
    s_cbranch_scc1 KA_NORS
    s_lshl_b32 s54, s2, 2
    s_add_u32 s54, s54, 30163968
    v_mov_b32 v5, 1
    s_mov_b64 exec, 1
    buffer_store_dword v5, v0, s[36:39], s54 offen sc1
    s_mov_b64 exec, -1
KA_NORS:
    s_waitcnt lgkmcnt(4)
    v_mfma_f32_16x16x32_bf16 v[176:179], v[236:239], v[152:155], v[176:179]
    ds_read_b64_tr_b16 v[232:233], v2 offset:2048
    v_mul_f32 v217, v201, v217
    v_mfma_f32_16x16x32_bf16 v[180:183], v[236:239], v[156:159], v[180:183]
    ds_read_b64_tr_b16 v[234:235], v2 offset:2304
    s_lshl_b32 s54, s44, 10
    s_add_u32 m0, s54, 73728
    s_add_u32 s59, s54, 29884416
    buffer_load_dwordx4 v0, s[36:39], s59 offen sc1 lds
    v_mul_f32 v218, v202, v218
    v_mul_f32 v219, v203, v219
    s_waitcnt lgkmcnt(4)
    v_mfma_f32_16x16x32_bf16 v[168:171], v[224:227], v[16:19], 0
    ds_read_b64_tr_b16 v[236:237], v2 offset:14336
    v_cvt_pk_bf16_f32 v194, v216, v217
    v_cvt_pk_bf16_f32 v195, v218, v219
    v_mfma_f32_16x16x32_bf16 v[172:175], v[224:227], v[20:23], 0
    ds_read_b64_tr_b16 v[238:239], v2 offset:14592
    v_fma_f32 v204, v13, v248, v204
    s_waitcnt lgkmcnt(4)
    v_mfma_f32_16x16x32_bf16 v[184:187], v[228:231], v[16:19], 0
    ds_read_b64_tr_b16 v[224:225], v2 offset:4096
    v_fma_f32 v205, v13, v249, v205
    v_fma_f32 v206, v13, v250, v206
    v_mfma_f32_16x16x32_bf16 v[188:191], v[228:231], v[20:23], 0
    ds_read_b64_tr_b16 v[226:227], v2 offset:4352
    v_fma_f32 v207, v13, v251, v207
    v_fma_f32 v220, v13, v252, v220
    s_waitcnt lgkmcnt(4)
    v_mfma_f32_16x16x32_bf16 v[168:171], v[232:235], v[24:27], v[168:171]
    ds_read_b64_tr_b16 v[228:229], v2 offset:16384
    v_fma_f32 v221, v13, v253, v221
    v_mfma_f32_16x16x32_bf16 v[172:175], v[232:235], v[28:31], v[172:175]
    ds_read_b64_tr_b16 v[230:231], v2 offset:16640
    s_lshl_b32 s54, s44, 10
    s_add_u32 m0, s54, 81920
    s_add_u32 s59, s54, 29892608
    buffer_load_dwordx4 v0, s[36:39], s59 offen sc1 lds
    v_fma_f32 v222, v13, v254, v222
    v_fma_f32 v223, v13, v255, v223
    s_waitcnt lgkmcnt(4)
    v_mfma_f32_16x16x32_bf16 v[184:187], v[236:239], v[24:27], v[184:187]
    ds_read_b64_tr_b16 v[232:233], v2 offset:6144
    v_mul_f32 v220, v204, v220
    v_mul_f32 v221, v205, v221
    v_mfma_f32_16x16x32_bf16 v[188:191], v[236:239], v[28:31], v[188:191]
    ds_read_b64_tr_b16 v[234:235], v2 offset:6400
    v_mul_f32 v222, v206, v222
    s_waitcnt lgkmcnt(4)
    v_mfma_f32_16x16x32_bf16 v[168:171], v[224:227], v[32:35], v[168:171]
    ds_read_b64_tr_b16 v[236:237], v2 offset:18432
    v_mul_f32 v223, v207, v223
    v_mul_f32 v204, v15, v204
    v_mfma_f32_16x16x32_bf16 v[172:175], v[224:227], v[36:39], v[172:175]
    ds_read_b64_tr_b16 v[238:239], v2 offset:18688
    v_mul_f32 v205, v15, v205
    v_mul_f32 v206, v15, v206
    s_waitcnt lgkmcnt(4)
    v_mfma_f32_16x16x32_bf16 v[184:187], v[228:231], v[32:35], v[184:187]
    ds_read_b64_tr_b16 v[224:225], v2 offset:8192
    v_mul_f32 v207, v15, v207
    v_mfma_f32_16x16x32_bf16 v[188:191], v[228:231], v[36:39], v[188:191]
    ds_read_b64_tr_b16 v[226:227], v2 offset:8448
    v_exp_f32 v204, v204
    v_exp_f32 v205, v205
    s_waitcnt lgkmcnt(4)
    v_mfma_f32_16x16x32_bf16 v[168:171], v[232:235], v[40:43], v[168:171]
    ds_read_b64_tr_b16 v[228:229], v2 offset:20480
    s_lshl_b32 s54, s44, 10
    s_add_u32 m0, s54, 90112
    s_add_u32 s59, s54, 29900800
    buffer_load_dwordx4 v0, s[36:39], s59 offen sc1 lds
    s_cmp_lt_u32 s44, 4
    s_cbranch_scc1 KA_NOQ0
    s_lshl_b32 s54, s5, 2
    s_and_b32 s55, s44, 3
    s_add_u32 s54, s54, s55
    s_mul_i32 s54, s54, 18
    s_add_u32 s54, s54, 0
    s_lshl_b32 s55, s4, 12
    s_add_u32 s55, s55, 27525120
    v_and_b32 v32, 0x1f0, v0
    v_lshlrev_b32 v32, 2, v32
    v_lshrrev_b32 v33, 6, v0
    v_and_b32 v33, 8, v33
    v_add_u32 v33, s54, v33
    v_lshrrev_b32 v34, 5, v33
    v_lshl_add_u32 v34, v34, 17, v32
    v_and_b32 v35, 12, v33
    v_lshl_add_u32 v34, v35, 2, v34
    v_bfe_u32 v35, v33, 4, 1
    v_lshl_add_u32 v34, v35, 3, v34
    buffer_load_dwordx2 v[16:17], v34, s[36:39], s55 offen sc1
    buffer_load_dwordx2 v[24:25], v34, s[36:39], s55 offen offset:2048 sc1
KA_NOQ0:
    v_exp_f32 v206, v206
    v_exp_f32 v207, v207
    v_mfma_f32_16x16x32_bf16 v[172:175], v[232:235], v[44:47], v[172:175]
    ds_read_b64_tr_b16 v[230:231], v2 offset:20736
    v_fma_f32 v204, v204, v7, v7
    s_waitcnt lgkmcnt(4)
    v_mfma_f32_16x16x32_bf16 v[184:187], v[236:239], v[40:43], v[184:187]
    ds_read_b64_tr_b16 v[232:233], v2 offset:10240
    v_fma_f32 v205, v205, v7, v7
    v_fma_f32 v206, v206, v7, v7
    v_mfma_f32_16x16x32_bf16 v[188:191], v[236:239], v[44:47], v[188:191]
    ds_read_b64_tr_b16 v[234:235], v2 offset:10496
    v_fma_f32 v207, v207, v7, v7
    v_rcp_f32 v204, v204
    s_waitcnt lgkmcnt(4)
    v_mfma_f32_16x16x32_bf16 v[168:171], v[224:227], v[48:51], v[168:171]
    ds_read_b64_tr_b16 v[236:237], v2 offset:22528
    v_rcp_f32 v205, v205
    v_mfma_f32_16x16x32_bf16 v[172:175], v[224:227], v[52:55], v[172:175]
    ds_read_b64_tr_b16 v[238:239], v2 offset:22784
    v_rcp_f32 v206, v206
    v_rcp_f32 v207, v207
    s_waitcnt lgkmcnt(4)
    v_mfma_f32_16x16x32_bf16 v[184:187], v[228:231], v[48:51], v[184:187]
    v_add_u32 v2, 0xffffa000, v2
    ds_read_b64_tr_b16 v[224:225], v2 offset:0
    s_lshl_b32 s54, s44, 10
    s_add_u32 m0, s54, 98304
    s_add_u32 s59, s54, 29908992
    buffer_load_dwordx4 v0, s[36:39], s59 offen sc1 lds
    v_mul_f32 v220, v204, v220
    v_mul_f32 v221, v205, v221
    v_mfma_f32_16x16x32_bf16 v[188:191], v[228:231], v[52:55], v[188:191]
    ds_read_b64_tr_b16 v[226:227], v2 offset:256
    v_mul_f32 v222, v206, v222
    s_waitcnt lgkmcnt(4)
    v_mfma_f32_16x16x32_bf16 v[168:171], v[232:235], v[56:59], v[168:171]
    ds_read_b64_tr_b16 v[228:229], v2 offset:12288
    s_cmp_lt_u32 s44, 4
    s_cbranch_scc1 KA_NOQ1
    s_lshl_b32 s54, s5, 2
    s_and_b32 s55, s44, 3
    s_add_u32 s54, s54, s55
    s_mul_i32 s54, s54, 18
    s_add_u32 s54, s54, 4
    s_lshl_b32 s55, s4, 12
    s_add_u32 s55, s55, 27525120
    v_and_b32 v32, 0x1f0, v0
    v_lshlrev_b32 v32, 2, v32
    v_lshrrev_b32 v33, 6, v0
    v_and_b32 v33, 8, v33
    v_add_u32 v33, s54, v33
    v_lshrrev_b32 v34, 5, v33
    v_lshl_add_u32 v34, v34, 17, v32
    v_and_b32 v35, 12, v33
    v_lshl_add_u32 v34, v35, 2, v34
    v_bfe_u32 v35, v33, 4, 1
    v_lshl_add_u32 v34, v35, 3, v34
    buffer_load_dwordx2 v[18:19], v34, s[36:39], s55 offen sc1
    buffer_load_dwordx2 v[26:27], v34, s[36:39], s55 offen offset:2048 sc1
KA_NOQ1:
    v_mul_f32 v223, v207, v223
    v_cvt_pk_bf16_f32 v198, v220, v221
    v_mfma_f32_16x16x32_bf16 v[172:175], v[232:235], v[60:63], v[172:175]
    ds_read_b64_tr_b16 v[230:231], v2 offset:12544
    v_cvt_pk_bf16_f32 v199, v222, v223
    s_waitcnt lgkmcnt(4)
    v_mfma_f32_16x16x32_bf16 v[184:187], v[236:239], v[56:59], v[184:187]
    ds_read_b64_tr_b16 v[232:233], v2 offset:2048
    v_lshrrev_b32 v5, 4, v0
    v_and_b32 v5, 48, v5
    v_add_u32 v5, 157696, v5
    ds_read_b128 v[248:251], v5 offset:0
    ds_read_b128 v[244:247], v5 offset:256
    ds_read_b128 v[252:255], v5 offset:128
    ds_read_b128 v[8:11], v5 offset:384
    v_mfma_f32_16x16x32_bf16 v[188:191], v[236:239], v[60:63], v[188:191]
    ds_read_b64_tr_b16 v[234:235], v2 offset:2304
    s_waitcnt lgkmcnt(8)
    v_mfma_f32_16x16x32_bf16 v[168:171], v[224:227], v[64:67], v[168:171]
    ds_read_b64_tr_b16 v[236:237], v2 offset:14336
    v_mfma_f32_16x16x32_bf16 v[172:175], v[224:227], v[68:71], v[172:175]
    ds_read_b64_tr_b16 v[238:239], v2 offset:14592
    s_lshl_b32 s54, s44, 10
    s_add_u32 m0, s54, 106496
    s_add_u32 s59, s54, 29917184
    buffer_load_dwordx4 v0, s[36:39], s59 offen sc1 lds
    s_waitcnt lgkmcnt(8)
    v_mfma_f32_16x16x32_bf16 v[184:187], v[228:231], v[64:67], v[184:187]
    ds_read_b64_tr_b16 v[224:225], v2 offset:4096
    v_mfma_f32_16x16x32_bf16 v[188:191], v[228:231], v[68:71], v[188:191]
    ds_read_b64_tr_b16 v[226:227], v2 offset:4352
    s_waitcnt lgkmcnt(5)
    v_add_f32 v248, v248, v244
    v_add_f32 v249, v249, v245
    v_add_f32 v250, v250, v246
    v_add_f32 v251, v251, v247
    s_waitcnt lgkmcnt(4)
    v_mfma_f32_16x16x32_bf16 v[168:171], v[232:235], v[72:75], v[168:171]
    ds_read_b64_tr_b16 v[228:229], v2 offset:16384
    s_cmp_lt_u32 s44, 4
    s_cbranch_scc1 KA_NOQ2
    s_lshl_b32 s54, s5, 2
    s_and_b32 s55, s44, 3
    s_add_u32 s54, s54, s55
    s_mul_i32 s54, s54, 18
    s_add_u32 s54, s54, 8
    s_lshl_b32 s55, s4, 12
    s_add_u32 s55, s55, 27525120
    v_and_b32 v32, 0x1f0, v0
    v_lshlrev_b32 v32, 2, v32
    v_lshrrev_b32 v33, 6, v0
    v_and_b32 v33, 8, v33
    v_add_u32 v33, s54, v33
    v_lshrrev_b32 v34, 5, v33
    v_lshl_add_u32 v34, v34, 17, v32
    v_and_b32 v35, 12, v33
    v_lshl_add_u32 v34, v35, 2, v34
    v_bfe_u32 v35, v33, 4, 1
    v_lshl_add_u32 v34, v35, 3, v34
    buffer_load_dwordx2 v[20:21], v34, s[36:39], s55 offen sc1
    buffer_load_dwordx2 v[28:29], v34, s[36:39], s55 offen offset:2048 sc1
KA_NOQ2:
    v_add_f32 v252, v252, v8
    v_add_f32 v253, v253, v9
    v_add_f32 v254, v254, v10
    v_add_f32 v255, v255, v11
    v_mfma_f32_16x16x32_bf16 v[172:175], v[232:235], v[76:79], v[172:175]
    ds_read_b64_tr_b16 v[230:231], v2 offset:16640
    v_fma_f32 v160, v12, v248, v160
    v_fma_f32 v161, v12, v249, v161
    s_waitcnt lgkmcnt(4)
    v_mfma_f32_16x16x32_bf16 v[184:187], v[236:239], v[72:75], v[184:187]
    ds_read_b64_tr_b16 v[232:233], v2 offset:6144
    v_fma_f32 v162, v12, v250, v162
    v_fma_f32 v163, v12, v251, v163
    v_mfma_f32_16x16x32_bf16 v[188:191], v[236:239], v[76:79], v[188:191]
    ds_read_b64_tr_b16 v[234:235], v2 offset:6400
    v_fma_f32 v176, v12, v252, v176
    v_fma_f32 v177, v12, v253, v177
    s_waitcnt lgkmcnt(4)
    v_mfma_f32_16x16x32_bf16 v[168:171], v[224:227], v[80:83], v[168:171]
    ds_read_b64_tr_b16 v[236:237], v2 offset:18432
    v_fma_f32 v178, v12, v254, v178
    v_fma_f32 v179, v12, v255, v179
    v_mfma_f32_16x16x32_bf16 v[172:175], v[224:227], v[84:87], v[172:175]
    ds_read_b64_tr_b16 v[238:239], v2 offset:18688
    v_mul_f32 v176, v160, v176
    s_waitcnt lgkmcnt(4)
    v_mfma_f32_16x16x32_bf16 v[184:187], v[228:231], v[80:83], v[184:187]
    ds_read_b64_tr_b16 v[224:225], v2 offset:8192
    v_mul_f32 v177, v161, v177
    v_mul_f32 v178, v162, v178
    v_mfma_f32_16x16x32_bf16 v[188:191], v[228:231], v[84:87], v[188:191]
    ds_read_b64_tr_b16 v[226:227], v2 offset:8448
    v_mul_f32 v179, v163, v179
    v_mul_f32 v160, v14, v160
    s_waitcnt lgkmcnt(4)
    v_mfma_f32_16x16x32_bf16 v[168:171], v[232:235], v[88:91], v[168:171]
    ds_read_b64_tr_b16 v[228:229], v2 offset:20480
    s_add_u32 s54, s9, 8192
    buffer_store_dwordx4 v[192:195], v0, s[36:39], s54 offen sc1
    v_mul_f32 v161, v14, v161
    v_mul_f32 v162, v14, v162
    v_mfma_f32_16x16x32_bf16 v[172:175], v[232:235], v[92:95], v[172:175]
    ds_read_b64_tr_b16 v[230:231], v2 offset:20736
    v_mul_f32 v163, v14, v163
    s_waitcnt lgkmcnt(4)
    v_mfma_f32_16x16x32_bf16 v[184:187], v[236:239], v[88:91], v[184:187]
    ds_read_b64_tr_b16 v[232:233], v2 offset:10240
    v_exp_f32 v160, v160
    v_exp_f32 v161, v161
    v_mfma_f32_16x16x32_bf16 v[188:191], v[236:239], v[92:95], v[188:191]
    ds_read_b64_tr_b16 v[234:235], v2 offset:10496
    v_exp_f32 v162, v162
    v_exp_f32 v163, v163
    s_waitcnt lgkmcnt(4)
    v_mfma_f32_16x16x32_bf16 v[168:171], v[224:227], v[96:99], v[168:171]
    ds_read_b64_tr_b16 v[236:237], v2 offset:22528
    v_fma_f32 v160, v160, v6, v6
    v_fma_f32 v161, v161, v6, v6
    v_mfma_f32_16x16x32_bf16 v[172:175], v[224:227], v[100:103], v[172:175]
    ds_read_b64_tr_b16 v[238:239], v2 offset:22784
    v_fma_f32 v162, v162, v6, v6
    s_waitcnt lgkmcnt(4)
    v_mfma_f32_16x16x32_bf16 v[184:187], v[228:231], v[96:99], v[184:187]
    ds_read_b64_tr_b16 v[224:225], v2 offset:49152
    s_add_u32 s54, s9, 9216
    buffer_store_dwordx4 v[196:199], v0, s[36:39], s54 offen sc1
    v_fma_f32 v163, v163, v6, v6
    v_rcp_f32 v160, v160
    v_mfma_f32_16x16x32_bf16 v[188:191], v[228:231], v[100:103], v[188:191]
    ds_read_b64_tr_b16 v[226:227], v2 offset:49408
    v_rcp_f32 v161, v161
    v_rcp_f32 v162, v162
    s_waitcnt lgkmcnt(4)
    v_mfma_f32_16x16x32_bf16 v[168:171], v[232:235], v[104:107], v[168:171]
    ds_read_b64_tr_b16 v[228:229], v2 offset:61440
    s_cmp_lt_u32 s44, 4
    s_cbranch_scc1 KA_NOQ
    s_mul_i32 s54, s5, 9
    s_and_b32 s59, s44, 3
    s_lshl_b32 s55, s59, 1
    s_add_u32 s55, s55, s54
    v_lshrrev_b32 v34, 9, v0
    v_add_u32 v35, s55, v34
    v_lshrrev_b32 v36, 2, v35
    v_lshlrev_b32 v36, 12, v36
    v_and_b32 v35, 3, v35
    v_lshl_add_u32 v36, v35, 8, v36
    v_and_b32 v35, 0x100, v0
    v_lshlrev_b32 v35, 2, v35
    v_and_or_b32 v35, v0, s10, v35
    v_add_u32 v36, v36, v35
    v_lshl_add_u32 v37, v34, 28, v35
    s_mul_i32 s50, s4, 73728
    s_add_u32 s50, s50, 25165824
    s_add_u32 s54, s54, 8
    s_lshr_b32 s55, s54, 2
    s_lshl_b32 s55, s55, 12
    s_and_b32 s54, s54, 3
    s_lshl_b32 s54, s54, 8
    s_add_u32 s55, s55, s54
    s_lshl_b32 s54, s59, 2
    s_add_u32 s55, s55, s54
    s_add_u32 s51, s55, s50
KA_NOQ:
    v_mov_b32 v32, 0
    v_lshrrev_b32 v33, 2, v0
    v_add_u32 v33, 158464, v33
    s_mov_b64 exec, 0xfffffff
    ds_write_b32 v33, v32
    s_mov_b64 exec, -1
    v_rcp_f32 v163, v163
    v_mul_f32 v176, v160, v176
    v_mfma_f32_16x16x32_bf16 v[172:175], v[232:235], v[108:111], v[172:175]
    ds_read_b64_tr_b16 v[230:231], v2 offset:61696
    v_mul_f32 v177, v161, v177
    s_waitcnt lgkmcnt(5)
    v_mfma_f32_16x16x32_bf16 v[184:187], v[236:239], v[104:107], v[184:187]
    ds_read_b64_tr_b16 v[232:233], v2 offset:51200
    v_mul_f32 v178, v162, v178
    v_mul_f32 v179, v163, v179
    v_mfma_f32_16x16x32_bf16 v[188:191], v[236:239], v[108:111], v[188:191]
    ds_read_b64_tr_b16 v[234:235], v2 offset:51456
    v_cvt_pk_bf16_f32 v160, v176, v177
    v_cvt_pk_bf16_f32 v161, v178, v179
    s_waitcnt lgkmcnt(5)
    v_mfma_f32_16x16x32_bf16 v[168:171], v[224:227], v[112:115], v[168:171]
    ds_read_b64_tr_b16 v[236:237], v2 offset:63488
    v_fma_f32 v164, v13, v248, v164
    v_fma_f32 v165, v13, v249, v165
    v_mfma_f32_16x16x32_bf16 v[172:175], v[224:227], v[116:119], v[172:175]
    ds_read_b64_tr_b16 v[238:239], v2 offset:63744
    v_fma_f32 v166, v13, v250, v166
    s_waitcnt lgkmcnt(4)
    v_mfma_f32_16x16x32_bf16 v[184:187], v[228:231], v[112:115], v[184:187]
    ds_read_b64_tr_b16 v[224:225], v2 offset:53248
    v_fma_f32 v167, v13, v251, v167
    v_fma_f32 v180, v13, v252, v180
    v_mfma_f32_16x16x32_bf16 v[188:191], v[228:231], v[116:119], v[188:191]
    ds_read_b64_tr_b16 v[226:227], v2 offset:53504
    v_fma_f32 v181, v13, v253, v181
    v_fma_f32 v182, v13, v254, v182
    s_waitcnt lgkmcnt(4)
    v_mfma_f32_16x16x32_bf16 v[168:171], v[232:235], v[120:123], v[168:171]
    v_add_u32 v2, 0xc000, v2
    ds_read_b64_tr_b16 v[228:229], v2 offset:16384
    v_fma_f32 v183, v13, v255, v183
    v_mul_f32 v180, v164, v180
    v_mfma_f32_16x16x32_bf16 v[172:175], v[232:235], v[124:127], v[172:175]
    ds_read_b64_tr_b16 v[230:231], v2 offset:16640
    v_mul_f32 v181, v165, v181
    v_mul_f32 v182, v166, v182
    s_waitcnt lgkmcnt(4)
    v_mfma_f32_16x16x32_bf16 v[184:187], v[236:239], v[120:123], v[184:187]
    ds_read_b64_tr_b16 v[232:233], v2 offset:6144
    v_mul_f32 v183, v167, v183
    v_mfma_f32_16x16x32_bf16 v[188:191], v[236:239], v[124:127], v[188:191]
    ds_read_b64_tr_b16 v[234:235], v2 offset:6400
    v_mul_f32 v164, v15, v164
    v_mul_f32 v165, v15, v165
    s_waitcnt lgkmcnt(4)
    v_mfma_f32_16x16x32_bf16 v[168:171], v[224:227], v[128:131], v[168:171]
    ds_read_b64_tr_b16 v[236:237], v2 offset:18432
    v_mul_f32 v166, v15, v166
    v_mul_f32 v167, v15, v167
    v_mfma_f32_16x16x32_bf16 v[172:175], v[224:227], v[132:135], v[172:175]
    ds_read_b64_tr_b16 v[238:239], v2 offset:18688
    v_exp_f32 v164, v164
    v_exp_f32 v165, v165
    s_waitcnt lgkmcnt(4)
    v_mfma_f32_16x16x32_bf16 v[184:187], v[228:231], v[128:131], v[184:187]
    ds_read_b64_tr_b16 v[224:225], v2 offset:8192
    v_exp_f32 v166, v166
    v_mfma_f32_16x16x32_bf16 v[188:191], v[228:231], v[132:135], v[188:191]
    ds_read_b64_tr_b16 v[226:227], v2 offset:8448
    v_exp_f32 v167, v167
    v_fma_f32 v164, v164, v7, v7
    s_waitcnt lgkmcnt(4)
    v_mfma_f32_16x16x32_bf16 v[168:171], v[232:235], v[136:139], v[168:171]
    ds_read_b64_tr_b16 v[228:229], v2 offset:20480
    v_fma_f32 v165, v165, v7, v7
    v_fma_f32 v166, v166, v7, v7
    v_mfma_f32_16x16x32_bf16 v[172:175], v[232:235], v[140:143], v[172:175]
    ds_read_b64_tr_b16 v[230:231], v2 offset:20736
    v_fma_f32 v167, v167, v7, v7
    v_rcp_f32 v164, v164
    s_waitcnt lgkmcnt(4)
    v_mfma_f32_16x16x32_bf16 v[184:187], v[236:239], v[136:139], v[184:187]
    ds_read_b64_tr_b16 v[232:233], v2 offset:10240
    v_rcp_f32 v165, v165
    v_mfma_f32_16x16x32_bf16 v[188:191], v[236:239], v[140:143], v[188:191]
    ds_read_b64_tr_b16 v[234:235], v2 offset:10496
    v_rcp_f32 v166, v166
    v_rcp_f32 v167, v167
    s_waitcnt lgkmcnt(4)
    v_mfma_f32_16x16x32_bf16 v[168:171], v[224:227], v[144:147], v[168:171]
    ds_read_b64_tr_b16 v[236:237], v2 offset:22528
    v_mul_f32 v180, v164, v180
    v_mul_f32 v181, v165, v181
    v_mfma_f32_16x16x32_bf16 v[172:175], v[224:227], v[148:151], v[172:175]
    ds_read_b64_tr_b16 v[238:239], v2 offset:22784
    v_mul_f32 v182, v166, v182
    v_mul_f32 v183, v167, v183
    s_waitcnt lgkmcnt(4)
    v_mfma_f32_16x16x32_bf16 v[184:187], v[228:231], v[144:147], v[184:187]
    v_cvt_pk_bf16_f32 v164, v180, v181
    v_mfma_f32_16x16x32_bf16 v[188:191], v[228:231], v[148:151], v[188:191]
    v_cvt_pk_bf16_f32 v165, v182, v183
    v_lshrrev_b32 v5, 4, v0
    v_and_b32 v5, 48, v5
    v_add_u32 v5, 157696, v5
    ds_read_b128 v[248:251], v5 offset:64
    ds_read_b128 v[176:179], v5 offset:320
    ds_read_b128 v[252:255], v5 offset:192
    ds_read_b128 v[180:183], v5 offset:448
    s_waitcnt lgkmcnt(6)
    v_mfma_f32_16x16x32_bf16 v[168:171], v[232:235], v[152:155], v[168:171]
    v_mfma_f32_16x16x32_bf16 v[172:175], v[232:235], v[156:159], v[172:175]
    s_waitcnt lgkmcnt(0)
    v_add_f32 v248, v248, v176
    v_add_f32 v249, v249, v177
    v_add_f32 v250, v250, v178
    v_add_f32 v251, v251, v179
    v_mfma_f32_16x16x32_bf16 v[184:187], v[236:239], v[152:155], v[184:187]
    v_add_f32 v252, v252, v180
    v_add_f32 v253, v253, v181
    v_add_f32 v254, v254, v182
    v_add_f32 v255, v255, v183
    v_mfma_f32_16x16x32_bf16 v[188:191], v[236:239], v[156:159], v[188:191]
    s_waitcnt vmcnt(2)
    s_waitcnt vmcnt(2)
    s_waitcnt lgkmcnt(0)
    s_barrier
    s_cmp_lt_u32 s44, 4
    s_cbranch_scc1 KA_NOPR
    s_setprio 1
    s_branch KA_JN
KA_NOPR:
    s_mov_b32 s61, 30163968
    buffer_load_dwordx4 v[48:51], v0, s[36:39], s61 offen sc1
KA_JN:
    s_nop 2
    v_fma_f32 v168, v12, v248, v168
    v_fma_f32 v169, v12, v249, v169
    v_fma_f32 v170, v12, v250, v170
    v_fma_f32 v171, v12, v251, v171
    v_fma_f32 v184, v12, v252, v184
    v_fma_f32 v185, v12, v253, v185
    v_fma_f32 v186, v12, v254, v186
    v_fma_f32 v187, v12, v255, v187
    v_mul_f32 v184, v168, v184
    v_mul_f32 v185, v169, v185
    v_mul_f32 v186, v170, v186
    v_mul_f32 v187, v171, v187
    v_mul_f32 v168, v14, v168
    v_mul_f32 v169, v14, v169
    v_mul_f32 v170, v14, v170
    v_mul_f32 v171, v14, v171
    v_exp_f32 v168, v168
    v_exp_f32 v169, v169
    v_exp_f32 v170, v170
    v_exp_f32 v171, v171
    v_fma_f32 v168, v168, v6, v6
    v_fma_f32 v169, v169, v6, v6
    v_fma_f32 v170, v170, v6, v6
    v_fma_f32 v171, v171, v6, v6
    v_rcp_f32 v168, v168
    v_rcp_f32 v169, v169
    v_rcp_f32 v170, v170
    v_rcp_f32 v171, v171
    v_mul_f32 v184, v168, v184
    v_mul_f32 v185, v169, v185
    v_mul_f32 v186, v170, v186
    v_mul_f32 v187, v171, v187
    v_cvt_pk_bf16_f32 v162, v184, v185
    v_cvt_pk_bf16_f32 v163, v186, v187
    s_add_u32 s54, s9, 12288
    buffer_store_dwordx4 v[160:163], v0, s[36:39], s54 offen sc1
    v_fma_f32 v172, v13, v248, v172
    v_fma_f32 v173, v13, v249, v173
    v_fma_f32 v174, v13, v250, v174
    v_fma_f32 v175, v13, v251, v175
    v_fma_f32 v188, v13, v252, v188
    v_fma_f32 v189, v13, v253, v189
    v_fma_f32 v190, v13, v254, v190
    v_fma_f32 v191, v13, v255, v191
    v_mul_f32 v188, v172, v188
    v_mul_f32 v189, v173, v189
    v_mul_f32 v190, v174, v190
    v_mul_f32 v191, v175, v191
    v_mul_f32 v172, v15, v172
    v_mul_f32 v173, v15, v173
    v_mul_f32 v174, v15, v174
    v_mul_f32 v175, v15, v175
    v_exp_f32 v172, v172
    v_exp_f32 v173, v173
    v_exp_f32 v174, v174
    v_exp_f32 v175, v175
    v_fma_f32 v172, v172, v7, v7
    v_fma_f32 v173, v173, v7, v7
    v_fma_f32 v174, v174, v7, v7
    v_fma_f32 v175, v175, v7, v7
    v_rcp_f32 v172, v172
    v_rcp_f32 v173, v173
    v_rcp_f32 v174, v174
    v_rcp_f32 v175, v175
    v_mul_f32 v188, v172, v188
    v_mul_f32 v189, v173, v189
    v_mul_f32 v190, v174, v190
    v_mul_f32 v191, v175, v191
    v_cvt_pk_bf16_f32 v166, v188, v189
    v_cvt_pk_bf16_f32 v167, v190, v191
    s_add_u32 s54, s9, 13312
    buffer_store_dwordx4 v[164:167], v0, s[36:39], s54 offen sc1
    s_and_b32 s6, s5, 1
    s_and_b32 s7, s44, 3
    s_cmp_lt_u32 s44, 4
    s_cbranch_scc1 KB_GEMM
    s_setprio 1
    v_add_u32 v1, 73728, v0
    v_lshrrev_b32 v0, 4, v0
    v_and_b32 v4, 31, v0
    v_lshlrev_b32 v2, 2, v4
    v_add_u32 v2, 73728, v2
    ds_read_b128 v[104:107], v1
    ds_read_b32 v108, v2 offset:1024
    s_bitcmp1_b32 s44, 0
    s_cbranch_scc0 KB_QEV
    v_mov_b32 v16, v17
    v_mov_b32 v24, v25
    v_mov_b32 v17, v18
    v_mov_b32 v25, v26
    v_mov_b32 v18, v19
    v_mov_b32 v26, v27
    v_mov_b32 v19, v20
    v_mov_b32 v27, v28
    v_mov_b32 v20, v21
    v_mov_b32 v28, v29
KB_QEV:
    v_cmp_gt_u32 vcc, 32, v0
    v_mov_b32 v8, 0x3f803f80
    v_mov_b32 v109, v8
    v_cndmask_b32 v20, v20, 0, vcc
    v_cndmask_b32 v28, v28, 0, vcc
    v_mov_b32 v21, 0
    v_mov_b32 v29, 0
    v_mov_b32 v117, v8
    v_or_b32 v9, 4, v4
    v_cmp_eq_u32 vcc, 22, v9
    v_lshrrev_b32 v5, 5, v0
    v_mul_u32_u24 v3, 288, v5
    v_lshl_add_u32 v3, v4, 4, v3
    v_add_u32 v3, 73728, v3
    s_mov_b32 s54, 0x3ffff
    s_mov_b32 s55, 0x3ffff
    v_cndmask_b32 v120, 0, v8, vcc
    v_cndmask_b32 v121, 0, v8, vcc
    v_cndmask_b32 v122, 0, v8, vcc
    v_cndmask_b32 v123, 0, v8, vcc
    v_cndmask_b32 v124, 0, v8, vcc
    v_cndmask_b32 v125, 0, v8, vcc
    v_cndmask_b32 v126, 0, v8, vcc
    v_cndmask_b32 v127, 0, v8, vcc
    s_waitcnt lgkmcnt(0)
    v_mfma_f32_32x32x16_bf16 v[136:151], v[104:107], v[16:19], 0
    v_mfma_f32_32x32x8_bf16 v[136:151], v[108:109], v[20:21], v[136:151]
    s_mov_b64 exec, s[54:55]
    ds_read_b128 v[120:123], v3 offset:1152
    ds_read_b128 v[124:127], v3 offset:1728
    s_mov_b64 exec, -1
    v_mfma_f32_32x32x16_bf16 v[48:63], v[104:107], v[24:27], 0
    v_mfma_f32_32x32x8_bf16 v[48:63], v[108:109], v[28:29], v[48:63]
    v_cndmask_b32 v128, 0, v8, vcc
    v_cndmask_b32 v129, 0, v8, vcc
    v_cndmask_b32 v130, 0, v8, vcc
    v_cndmask_b32 v131, 0, v8, vcc
    v_cndmask_b32 v132, 0, v8, vcc
    v_cndmask_b32 v133, 0, v8, vcc
    v_cndmask_b32 v134, 0, v8, vcc
    v_cndmask_b32 v135, 0, v8, vcc
    v_mov_b32 v64, 0
    v_mov_b32 v65, 0
    v_mov_b32 v66, 0
    v_mov_b32 v67, 0
    v_mov_b32 v68, 0
    v_mov_b32 v69, 0
    v_mov_b32 v70, 0
    v_mov_b32 v71, 0
    v_mov_b32 v72, 0
    v_mov_b32 v73, 0
    v_mov_b32 v74, 0
    v_mov_b32 v75, 0
    v_mov_b32 v76, 0
    v_mov_b32 v77, 0
    v_mov_b32 v78, 0
    v_mov_b32 v79, 0
    v_max_f32 v10, v136, v137
    v_max3_f32 v10, v138, v139, v10
    v_mov_b32 v80, 0
    v_max3_f32 v10, v140, v141, v10
    v_mov_b32 v81, 0
    v_max3_f32 v10, v142, v143, v10
    v_mov_b32 v82, 0
    v_max3_f32 v10, v144, v145, v10
    v_mov_b32 v83, 0
    v_max3_f32 v10, v146, v147, v10
    v_mov_b32 v84, 0
    v_max3_f32 v10, v148, v149, v10
    v_mov_b32 v85, 0
    v_max3_f32 v10, v150, v151, v10
    v_mov_b32 v86, 0
    v_mov_b32 v87, 0
    v_mov_b32 v88, 0
    v_mov_b32 v89, 0
    v_mov_b32 v90, 0
    v_mov_b32 v91, 0
    v_max_f32 v11, v48, v49
    v_max3_f32 v11, v50, v51, v11
    v_mov_b32 v92, 0
    v_max3_f32 v11, v52, v53, v11
    v_mov_b32 v93, 0
    v_max3_f32 v11, v54, v55, v11
    v_mov_b32 v94, 0
    v_max3_f32 v11, v56, v57, v11
    v_mov_b32 v95, 0
    v_max3_f32 v11, v58, v59, v11
    v_mov_b32 v96, 0
    v_max3_f32 v11, v60, v61, v11
    v_mov_b32 v97, 0
    v_max3_f32 v11, v62, v63, v11
    v_mov_b32 v98, 0
    v_mov_b32 v99, 0
    v_mov_b32 v100, 0
    v_mov_b32 v101, 0
    v_mov_b32 v102, 0
    v_mov_b32 v103, 0
    v_mov_b32 v4, v10
    v_mov_b32 v5, v11
    s_nop 1
    v_permlane32_swap_b32 v4, v10
    v_permlane32_swap_b32 v5, v11
    s_nop 1
    v_max_f32 v10, v4, v10
    v_max_f32 v11, v5, v11
    v_sub_f32 v10, 0xc2c80000, v10
    v_sub_f32 v11, 0xc2c80000, v11
    v_cvt_pk_bf16_f32 v4, v10, 0
    v_cvt_pk_bf16_f32 v5, v11, 0
    v_lshlrev_b32 v4, 16, v4
    v_lshlrev_b32 v5, 16, v5
    v_sub_f32 v4, v10, v4
    v_sub_f32 v5, v11, v5
    v_cvt_pk_bf16_f32 v21, v10, v4
    v_cvt_pk_bf16_f32 v29, v11, v5
    v_and_b32 v6, 0xffff0000, v21
    v_and_b32 v7, 0xffff0000, v29
    v_sub_f32 v4, v4, v6
    v_sub_f32 v5, v5, v7
    v_cmp_gt_u32 vcc, 32, v0
    v_cvt_pk_bf16_f32 v4, v4, 0
    v_cvt_pk_bf16_f32 v5, v5, 0
    v_cndmask_b32 v21, v4, v21, vcc
    v_cndmask_b32 v29, v5, v29, vcc
    v_add_f32 v136, v10, v136
    v_add_f32 v137, v10, v137
    v_add_f32 v138, v10, v138
    v_add_f32 v139, v10, v139
    v_add_f32 v140, v10, v140
    v_add_f32 v141, v10, v141
    v_add_f32 v142, v10, v142
    v_add_f32 v143, v10, v143
    v_add_f32 v144, v10, v144
    v_add_f32 v145, v10, v145
    v_add_f32 v146, v10, v146
    v_add_f32 v147, v10, v147
    v_add_f32 v148, v10, v148
    v_add_f32 v149, v10, v149
    v_add_f32 v150, v10, v150
    v_add_f32 v151, v10, v151
    s_mov_b32 s49, 0
    s_mov_b32 s48, 0
    s_mov_b32 s57, 18432
    s_waitcnt lgkmcnt(0)
.p2align 6
KB_LOOP:
    s_cmp_eq_u32 s48, 3
    s_cselect_b32 s56, 0xfffe0800, s57
    v_mfma_f32_32x32x16_bf16 v[48:63], v[104:107], v[24:27], 0
    ds_read_b128 v[112:115], v1 offset:2304
    ds_read_b32 v116, v2 offset:3328
    v_exp_f32 v136, v136
    v_exp_f32 v137, v137
    v_exp_f32 v138, v138
    v_cvt_pk_bf16_f32 v64, v136, v137
    v_exp_f32 v139, v139
    v_mfma_f32_32x32x16_bf16 v[88:103], v[132:135], v[68:71], v[88:103]
    v_exp_f32 v140, v140
    v_cvt_pk_bf16_f32 v65, v138, v139
    v_exp_f32 v141, v141
    v_exp_f32 v142, v142
    v_cvt_pk_bf16_f32 v66, v140, v141
    v_exp_f32 v143, v143
    v_mfma_f32_32x32x8_bf16 v[48:63], v[108:109], v[28:29], v[48:63]
    v_exp_f32 v144, v144
    v_cvt_pk_bf16_f32 v67, v142, v143
    v_exp_f32 v145, v145
    v_exp_f32 v146, v146
    v_cvt_pk_bf16_f32 v68, v144, v145
    v_exp_f32 v147, v147
    s_waitcnt lgkmcnt(2)
    v_mfma_f32_32x32x16_bf16 v[72:87], v[120:123], v[64:67], v[72:87]
    v_exp_f32 v148, v148
    v_cvt_pk_bf16_f32 v69, v146, v147
    v_exp_f32 v149, v149
    v_exp_f32 v150, v150
    v_exp_f32 v151, v151
    v_cvt_pk_bf16_f32 v70, v148, v149
    v_cvt_pk_bf16_f32 v71, v150, v151
    s_waitcnt lgkmcnt(0)
    v_mfma_f32_32x32x16_bf16 v[136:151], v[112:115], v[16:19], 0
    s_mov_b64 exec, s[54:55]
    ds_read_b128 v[128:131], v3 offset:3456
    ds_read_b128 v[132:135], v3 offset:4032
    s_mov_b64 exec, -1
    v_exp_f32 v48, v48
    v_exp_f32 v49, v49
    v_exp_f32 v50, v50
    v_cvt_pk_bf16_f32 v64, v48, v49
    v_exp_f32 v51, v51
    v_mfma_f32_32x32x16_bf16 v[72:87], v[124:127], v[68:71], v[72:87]
    v_exp_f32 v52, v52
    v_cvt_pk_bf16_f32 v65, v50, v51
    v_exp_f32 v53, v53
    v_exp_f32 v54, v54
    v_cvt_pk_bf16_f32 v66, v52, v53
    v_exp_f32 v55, v55
    v_mfma_f32_32x32x8_bf16 v[136:151], v[116:117], v[20:21], v[136:151]
    v_exp_f32 v56, v56
    v_cvt_pk_bf16_f32 v67, v54, v55
    v_exp_f32 v57, v57
    v_exp_f32 v58, v58
    v_cvt_pk_bf16_f32 v68, v56, v57
    v_exp_f32 v59, v59
    v_mfma_f32_32x32x16_bf16 v[88:103], v[120:123], v[64:67], v[88:103]
    v_exp_f32 v60, v60
    v_cvt_pk_bf16_f32 v69, v58, v59
    v_exp_f32 v61, v61
    v_exp_f32 v62, v62
    v_exp_f32 v63, v63
    v_cvt_pk_bf16_f32 v70, v60, v61
    v_cvt_pk_bf16_f32 v71, v62, v63
    s_cmp_lg_u32 s48, 1
    s_cbranch_scc1 KB_NOHF
    s_waitcnt vmcnt(0)
    v_mov_b32 v4, 1
    v_mov_b32 v5, 0
    s_mov_b64 exec, 1
    buffer_store_dword v4, v5, s[36:39], s63 offen sc1
    s_mov_b64 exec, -1
KB_NOHF:
    v_mfma_f32_32x32x16_bf16 v[48:63], v[112:115], v[24:27], 0
    ds_read_b128 v[104:107], v1 offset:4608
    ds_read_b32 v108, v2 offset:5632
    v_exp_f32 v136, v136
    v_exp_f32 v137, v137
    v_exp_f32 v138, v138
    v_cvt_pk_bf16_f32 v64, v136, v137
    v_exp_f32 v139, v139
    v_mfma_f32_32x32x16_bf16 v[88:103], v[124:127], v[68:71], v[88:103]
    v_exp_f32 v140, v140
    v_cvt_pk_bf16_f32 v65, v138, v139
    v_exp_f32 v141, v141
    v_exp_f32 v142, v142
    v_cvt_pk_bf16_f32 v66, v140, v141
    v_exp_f32 v143, v143
    v_mfma_f32_32x32x8_bf16 v[48:63], v[116:117], v[28:29], v[48:63]
    v_exp_f32 v144, v144
    v_cvt_pk_bf16_f32 v67, v142, v143
    v_exp_f32 v145, v145
    v_exp_f32 v146, v146
    v_cvt_pk_bf16_f32 v68, v144, v145
    v_exp_f32 v147, v147
    s_waitcnt lgkmcnt(2)
    v_mfma_f32_32x32x16_bf16 v[72:87], v[128:131], v[64:67], v[72:87]
    v_exp_f32 v148, v148
    v_cvt_pk_bf16_f32 v69, v146, v147
    v_exp_f32 v149, v149
    v_exp_f32 v150, v150
    v_exp_f32 v151, v151
    v_cvt_pk_bf16_f32 v70, v148, v149
    v_cvt_pk_bf16_f32 v71, v150, v151
    s_waitcnt lgkmcnt(0)
    v_mfma_f32_32x32x16_bf16 v[136:151], v[104:107], v[16:19], 0
    s_mov_b64 exec, s[54:55]
    ds_read_b128 v[120:123], v3 offset:5760
    ds_read_b128 v[124:127], v3 offset:6336
    s_mov_b64 exec, -1
    v_exp_f32 v48, v48
    v_exp_f32 v49, v49
    v_exp_f32 v50, v50
    v_cvt_pk_bf16_f32 v64, v48, v49
    v_exp_f32 v51, v51
    v_mfma_f32_32x32x16_bf16 v[72:87], v[132:135], v[68:71], v[72:87]
    v_exp_f32 v52, v52
    v_cvt_pk_bf16_f32 v65, v50, v51
    v_exp_f32 v53, v53
    v_exp_f32 v54, v54
    v_cvt_pk_bf16_f32 v66, v52, v53
    v_exp_f32 v55, v55
    v_mfma_f32_32x32x8_bf16 v[136:151], v[108:109], v[20:21], v[136:151]
    v_exp_f32 v56, v56
    v_cvt_pk_bf16_f32 v67, v54, v55
    v_exp_f32 v57, v57
    v_exp_f32 v58, v58
    v_cvt_pk_bf16_f32 v68, v56, v57
    v_exp_f32 v59, v59
    v_mfma_f32_32x32x16_bf16 v[88:103], v[128:131], v[64:67], v[88:103]
    v_exp_f32 v60, v60
    v_cvt_pk_bf16_f32 v69, v58, v59
    v_exp_f32 v61, v61
    v_exp_f32 v62, v62
    v_exp_f32 v63, v63
    v_cvt_pk_bf16_f32 v70, v60, v61
    v_cvt_pk_bf16_f32 v71, v62, v63
    v_mfma_f32_32x32x16_bf16 v[48:63], v[104:107], v[24:27], 0
    ds_read_b128 v[112:115], v1 offset:6912
    ds_read_b32 v116, v2 offset:7936
    v_exp_f32 v136, v136
    v_exp_f32 v137, v137
    v_exp_f32 v138, v138
    v_cvt_pk_bf16_f32 v64, v136, v137
    v_exp_f32 v139, v139
    v_mfma_f32_32x32x16_bf16 v[88:103], v[132:135], v[68:71], v[88:103]
    v_exp_f32 v140, v140
    v_cvt_pk_bf16_f32 v65, v138, v139
    v_exp_f32 v141, v141
    v_exp_f32 v142, v142
    v_cvt_pk_bf16_f32 v66, v140, v141
    v_exp_f32 v143, v143
    v_mfma_f32_32x32x8_bf16 v[48:63], v[108:109], v[28:29], v[48:63]
    v_exp_f32 v144, v144
    v_cvt_pk_bf16_f32 v67, v142, v143
    v_exp_f32 v145, v145
    v_exp_f32 v146, v146
    v_cvt_pk_bf16_f32 v68, v144, v145
    v_exp_f32 v147, v147
    s_waitcnt lgkmcnt(2)
    v_mfma_f32_32x32x16_bf16 v[72:87], v[120:123], v[64:67], v[72:87]
    v_exp_f32 v148, v148
    v_cvt_pk_bf16_f32 v69, v146, v147
    v_exp_f32 v149, v149
    v_exp_f32 v150, v150
    v_exp_f32 v151, v151
    v_cvt_pk_bf16_f32 v70, v148, v149
    v_cvt_pk_bf16_f32 v71, v150, v151
    s_waitcnt lgkmcnt(0)
    v_mfma_f32_32x32x16_bf16 v[136:151], v[112:115], v[16:19], 0
    s_mov_b64 exec, s[54:55]
    ds_read_b128 v[128:131], v3 offset:8064
    ds_read_b128 v[132:135], v3 offset:8640
    s_mov_b64 exec, -1
    v_exp_f32 v48, v48
    v_exp_f32 v49, v49
    v_exp_f32 v50, v50
    v_cvt_pk_bf16_f32 v64, v48, v49
    v_exp_f32 v51, v51
    v_mfma_f32_32x32x16_bf16 v[72:87], v[124:127], v[68:71], v[72:87]
    v_exp_f32 v52, v52
    v_cvt_pk_bf16_f32 v65, v50, v51
    v_exp_f32 v53, v53
    v_exp_f32 v54, v54
    v_cvt_pk_bf16_f32 v66, v52, v53
    v_exp_f32 v55, v55
    v_mfma_f32_32x32x8_bf16 v[136:151], v[116:117], v[20:21], v[136:151]
    v_exp_f32 v56, v56
    v_cvt_pk_bf16_f32 v67, v54, v55
    v_exp_f32 v57, v57
    v_exp_f32 v58, v58
    v_cvt_pk_bf16_f32 v68, v56, v57
    v_exp_f32 v59, v59
    v_mfma_f32_32x32x16_bf16 v[88:103], v[120:123], v[64:67], v[88:103]
    v_exp_f32 v60, v60
    v_cvt_pk_bf16_f32 v69, v58, v59
    v_exp_f32 v61, v61
    v_exp_f32 v62, v62
    v_exp_f32 v63, v63
    v_cvt_pk_bf16_f32 v70, v60, v61
    v_cvt_pk_bf16_f32 v71, v62, v63
    v_mfma_f32_32x32x16_bf16 v[48:63], v[112:115], v[24:27], 0
    ds_read_b128 v[104:107], v1 offset:9216
    ds_read_b32 v108, v2 offset:10240
    v_exp_f32 v136, v136
    v_exp_f32 v137, v137
    v_exp_f32 v138, v138
    v_cvt_pk_bf16_f32 v64, v136, v137
    v_exp_f32 v139, v139
    v_mfma_f32_32x32x16_bf16 v[88:103], v[124:127], v[68:71], v[88:103]
    v_exp_f32 v140, v140
    v_cvt_pk_bf16_f32 v65, v138, v139
    v_exp_f32 v141, v141
    v_exp_f32 v142, v142
    v_cvt_pk_bf16_f32 v66, v140, v141
    v_exp_f32 v143, v143
    v_mfma_f32_32x32x8_bf16 v[48:63], v[116:117], v[28:29], v[48:63]
    v_exp_f32 v144, v144
    v_cvt_pk_bf16_f32 v67, v142, v143
    v_exp_f32 v145, v145
    v_exp_f32 v146, v146
    v_cvt_pk_bf16_f32 v68, v144, v145
    v_exp_f32 v147, v147
    s_waitcnt lgkmcnt(2)
    v_mfma_f32_32x32x16_bf16 v[72:87], v[128:131], v[64:67], v[72:87]
    v_exp_f32 v148, v148
    v_cvt_pk_bf16_f32 v69, v146, v147
    v_exp_f32 v149, v149
    v_exp_f32 v150, v150
    v_exp_f32 v151, v151
    v_cvt_pk_bf16_f32 v70, v148, v149
    v_cvt_pk_bf16_f32 v71, v150, v151
    s_waitcnt lgkmcnt(0)
    v_mfma_f32_32x32x16_bf16 v[136:151], v[104:107], v[16:19], 0
    s_mov_b64 exec, s[54:55]
    ds_read_b128 v[120:123], v3 offset:10368
    ds_read_b128 v[124:127], v3 offset:10944
    s_mov_b64 exec, -1
    v_exp_f32 v48, v48
    v_exp_f32 v49, v49
    v_exp_f32 v50, v50
    v_cvt_pk_bf16_f32 v64, v48, v49
    v_exp_f32 v51, v51
    v_mfma_f32_32x32x16_bf16 v[72:87], v[132:135], v[68:71], v[72:87]
    v_exp_f32 v52, v52
    v_cvt_pk_bf16_f32 v65, v50, v51
    v_exp_f32 v53, v53
    v_exp_f32 v54, v54
    v_cvt_pk_bf16_f32 v66, v52, v53
    v_exp_f32 v55, v55
    v_mfma_f32_32x32x8_bf16 v[136:151], v[108:109], v[20:21], v[136:151]
    v_exp_f32 v56, v56
    v_cvt_pk_bf16_f32 v67, v54, v55
    v_exp_f32 v57, v57
    v_exp_f32 v58, v58
    v_cvt_pk_bf16_f32 v68, v56, v57
    v_exp_f32 v59, v59
    v_mfma_f32_32x32x16_bf16 v[88:103], v[128:131], v[64:67], v[88:103]
    v_exp_f32 v60, v60
    v_cvt_pk_bf16_f32 v69, v58, v59
    v_exp_f32 v61, v61
    v_exp_f32 v62, v62
    v_exp_f32 v63, v63
    v_cvt_pk_bf16_f32 v70, v60, v61
    v_cvt_pk_bf16_f32 v71, v62, v63
    s_cmp_lg_u32 s48, 4
    s_cbranch_scc1 KB_NOAP
    s_lshl_b32 s35, s7, 2
    s_add_u32 s35, s35, 158496
    v_mov_b32 v12, s35
    v_mov_b32 v13, 1
    s_mov_b64 exec, 1
    ds_write_b32 v12, v13
    s_mov_b64 exec, -1
    s_waitcnt lgkmcnt(0)
KB_NOAP:
    v_mfma_f32_32x32x16_bf16 v[48:63], v[104:107], v[24:27], 0
    ds_read_b128 v[112:115], v1 offset:11520
    ds_read_b32 v116, v2 offset:12544
    v_exp_f32 v136, v136
    v_exp_f32 v137, v137
    v_exp_f32 v138, v138
    v_cvt_pk_bf16_f32 v64, v136, v137
    v_exp_f32 v139, v139
    v_mfma_f32_32x32x16_bf16 v[88:103], v[132:135], v[68:71], v[88:103]
    v_exp_f32 v140, v140
    v_cvt_pk_bf16_f32 v65, v138, v139
    v_exp_f32 v141, v141
    v_exp_f32 v142, v142
    v_cvt_pk_bf16_f32 v66, v140, v141
    v_exp_f32 v143, v143
    v_mfma_f32_32x32x8_bf16 v[48:63], v[108:109], v[28:29], v[48:63]
    v_exp_f32 v144, v144
    v_cvt_pk_bf16_f32 v67, v142, v143
    v_exp_f32 v145, v145
    v_exp_f32 v146, v146
    v_cvt_pk_bf16_f32 v68, v144, v145
    v_exp_f32 v147, v147
    s_waitcnt lgkmcnt(2)
    v_mfma_f32_32x32x16_bf16 v[72:87], v[120:123], v[64:67], v[72:87]
    v_exp_f32 v148, v148
    v_cvt_pk_bf16_f32 v69, v146, v147
    v_exp_f32 v149, v149
    v_exp_f32 v150, v150
    v_exp_f32 v151, v151
    v_cvt_pk_bf16_f32 v70, v148, v149
    v_cvt_pk_bf16_f32 v71, v150, v151
    s_waitcnt lgkmcnt(0)
    v_mfma_f32_32x32x16_bf16 v[136:151], v[112:115], v[16:19], 0
    s_mov_b64 exec, s[54:55]
    ds_read_b128 v[128:131], v3 offset:12672
    ds_read_b128 v[132:135], v3 offset:13248
    s_mov_b64 exec, -1
    v_exp_f32 v48, v48
    v_exp_f32 v49, v49
    v_exp_f32 v50, v50
    v_cvt_pk_bf16_f32 v64, v48, v49
    v_exp_f32 v51, v51
    v_mfma_f32_32x32x16_bf16 v[72:87], v[124:127], v[68:71], v[72:87]
    v_exp_f32 v52, v52
    v_cvt_pk_bf16_f32 v65, v50, v51
    v_exp_f32 v53, v53
    v_exp_f32 v54, v54
    v_cvt_pk_bf16_f32 v66, v52, v53
    v_exp_f32 v55, v55
    v_mfma_f32_32x32x8_bf16 v[136:151], v[116:117], v[20:21], v[136:151]
    v_exp_f32 v56, v56
    v_cvt_pk_bf16_f32 v67, v54, v55
    v_exp_f32 v57, v57
    v_exp_f32 v58, v58
    v_cvt_pk_bf16_f32 v68, v56, v57
    v_exp_f32 v59, v59
    v_mfma_f32_32x32x16_bf16 v[88:103], v[120:123], v[64:67], v[88:103]
    v_exp_f32 v60, v60
    v_cvt_pk_bf16_f32 v69, v58, v59
    v_exp_f32 v61, v61
    v_exp_f32 v62, v62
    v_exp_f32 v63, v63
    v_cvt_pk_bf16_f32 v70, v60, v61
    v_cvt_pk_bf16_f32 v71, v62, v63
    v_mfma_f32_32x32x16_bf16 v[48:63], v[112:115], v[24:27], 0
    ds_read_b128 v[104:107], v1 offset:13824
    ds_read_b32 v108, v2 offset:14848
    v_exp_f32 v136, v136
    v_exp_f32 v137, v137
    v_exp_f32 v138, v138
    v_cvt_pk_bf16_f32 v64, v136, v137
    v_exp_f32 v139, v139
    v_mfma_f32_32x32x16_bf16 v[88:103], v[124:127], v[68:71], v[88:103]
    v_exp_f32 v140, v140
    v_cvt_pk_bf16_f32 v65, v138, v139
    v_exp_f32 v141, v141
    v_exp_f32 v142, v142
    v_cvt_pk_bf16_f32 v66, v140, v141
    v_exp_f32 v143, v143
    v_mfma_f32_32x32x8_bf16 v[48:63], v[116:117], v[28:29], v[48:63]
    v_exp_f32 v144, v144
    v_cvt_pk_bf16_f32 v67, v142, v143
    v_exp_f32 v145, v145
    v_exp_f32 v146, v146
    v_cvt_pk_bf16_f32 v68, v144, v145
    v_exp_f32 v147, v147
    s_waitcnt lgkmcnt(2)
    v_mfma_f32_32x32x16_bf16 v[72:87], v[128:131], v[64:67], v[72:87]
    v_exp_f32 v148, v148
    v_cvt_pk_bf16_f32 v69, v146, v147
    v_exp_f32 v149, v149
    v_exp_f32 v150, v150
    v_exp_f32 v151, v151
    v_cvt_pk_bf16_f32 v70, v148, v149
    v_cvt_pk_bf16_f32 v71, v150, v151
    s_waitcnt lgkmcnt(0)
    v_mfma_f32_32x32x16_bf16 v[136:151], v[104:107], v[16:19], 0
    s_mov_b64 exec, s[54:55]
    ds_read_b128 v[120:123], v3 offset:14976
    ds_read_b128 v[124:127], v3 offset:15552
    s_mov_b64 exec, -1
    v_exp_f32 v48, v48
    v_exp_f32 v49, v49
    v_exp_f32 v50, v50
    v_cvt_pk_bf16_f32 v64, v48, v49
    v_exp_f32 v51, v51
    v_mfma_f32_32x32x16_bf16 v[72:87], v[132:135], v[68:71], v[72:87]
    v_exp_f32 v52, v52
    v_cvt_pk_bf16_f32 v65, v50, v51
    v_exp_f32 v53, v53
    v_exp_f32 v54, v54
    v_cvt_pk_bf16_f32 v66, v52, v53
    v_exp_f32 v55, v55
    v_mfma_f32_32x32x8_bf16 v[136:151], v[108:109], v[20:21], v[136:151]
    v_exp_f32 v56, v56
    v_cvt_pk_bf16_f32 v67, v54, v55
    v_exp_f32 v57, v57
    v_exp_f32 v58, v58
    v_cvt_pk_bf16_f32 v68, v56, v57
    v_exp_f32 v59, v59
    v_mfma_f32_32x32x16_bf16 v[88:103], v[128:131], v[64:67], v[88:103]
    v_exp_f32 v60, v60
    v_cvt_pk_bf16_f32 v69, v58, v59
    v_exp_f32 v61, v61
    v_exp_f32 v62, v62
    v_exp_f32 v63, v63
    v_cvt_pk_bf16_f32 v70, v60, v61
    v_cvt_pk_bf16_f32 v71, v62, v63
    s_cmp_lg_u32 s48, 3
    s_cbranch_scc1 KB_KVW_OK
    v_mov_b32 v4, 158464
    s_mov_b32 s34, 0x400000
KB_KVW:
    ds_read_b128 v[12:15], v4
    s_waitcnt lgkmcnt(0)
    v_min_u32 v12, v12, v13
    v_min3_u32 v12, v12, v14, v15
    s_nop 0
    v_readfirstlane_b32 s35, v12
    s_cmp_lg_u32 s35, 0
    s_cbranch_scc1 KB_KVW_OK
    s_sleep 1
    s_sub_u32 s34, s34, 1
    s_cmp_lg_u32 s34, 0
    s_cbranch_scc1 KB_KVW
KB_KVW_OK:
    v_mfma_f32_32x32x16_bf16 v[48:63], v[104:107], v[24:27], 0
    ds_read_b128 v[112:115], v1 offset:16128
    ds_read_b32 v116, v2 offset:17152
    v_exp_f32 v136, v136
    v_exp_f32 v137, v137
    v_exp_f32 v138, v138
    v_cvt_pk_bf16_f32 v64, v136, v137
    v_exp_f32 v139, v139
    v_mfma_f32_32x32x16_bf16 v[88:103], v[132:135], v[68:71], v[88:103]
    v_exp_f32 v140, v140
    v_cvt_pk_bf16_f32 v65, v138, v139
    v_exp_f32 v141, v141
    v_exp_f32 v142, v142
    v_cvt_pk_bf16_f32 v66, v140, v141
    v_exp_f32 v143, v143
    v_mfma_f32_32x32x8_bf16 v[48:63], v[108:109], v[28:29], v[48:63]
    v_exp_f32 v144, v144
    v_cvt_pk_bf16_f32 v67, v142, v143
    v_exp_f32 v145, v145
    v_exp_f32 v146, v146
    v_cvt_pk_bf16_f32 v68, v144, v145
    v_exp_f32 v147, v147
    s_waitcnt lgkmcnt(2)
    v_mfma_f32_32x32x16_bf16 v[72:87], v[120:123], v[64:67], v[72:87]
    v_exp_f32 v148, v148
    v_cvt_pk_bf16_f32 v69, v146, v147
    v_exp_f32 v149, v149
    v_exp_f32 v150, v150
    v_exp_f32 v151, v151
    v_cvt_pk_bf16_f32 v70, v148, v149
    v_cvt_pk_bf16_f32 v71, v150, v151
    s_waitcnt lgkmcnt(0)
    v_mfma_f32_32x32x16_bf16 v[136:151], v[112:115], v[16:19], 0
    s_mov_b64 exec, s[54:55]
    ds_read_b128 v[128:131], v3 offset:17280
    ds_read_b128 v[132:135], v3 offset:17856
    s_mov_b64 exec, -1
    v_exp_f32 v48, v48
    v_exp_f32 v49, v49
    v_exp_f32 v50, v50
    v_cvt_pk_bf16_f32 v64, v48, v49
    v_exp_f32 v51, v51
    v_mfma_f32_32x32x16_bf16 v[72:87], v[124:127], v[68:71], v[72:87]
    v_exp_f32 v52, v52
    v_cvt_pk_bf16_f32 v65, v50, v51
    v_exp_f32 v53, v53
    v_exp_f32 v54, v54
    v_cvt_pk_bf16_f32 v66, v52, v53
    v_exp_f32 v55, v55
    v_mfma_f32_32x32x8_bf16 v[136:151], v[116:117], v[20:21], v[136:151]
    v_exp_f32 v56, v56
    v_cvt_pk_bf16_f32 v67, v54, v55
    v_exp_f32 v57, v57
    v_exp_f32 v58, v58
    v_cvt_pk_bf16_f32 v68, v56, v57
    v_exp_f32 v59, v59
    v_mfma_f32_32x32x16_bf16 v[88:103], v[120:123], v[64:67], v[88:103]
    v_exp_f32 v60, v60
    v_cvt_pk_bf16_f32 v69, v58, v59
    v_exp_f32 v61, v61
    v_exp_f32 v62, v62
    v_exp_f32 v63, v63
    v_cvt_pk_bf16_f32 v70, v60, v61
    v_cvt_pk_bf16_f32 v71, v62, v63
    v_add_u32 v1, s56, v1
    v_add_u32 v2, s56, v2
    v_mfma_f32_32x32x16_bf16 v[48:63], v[112:115], v[24:27], 0
    ds_read_b128 v[104:107], v1 offset:0
    ds_read_b32 v108, v2 offset:1024
    v_exp_f32 v136, v136
    v_exp_f32 v137, v137
    v_exp_f32 v138, v138
    v_cvt_pk_bf16_f32 v64, v136, v137
    v_exp_f32 v139, v139
    v_mfma_f32_32x32x16_bf16 v[88:103], v[124:127], v[68:71], v[88:103]
    v_exp_f32 v140, v140
    v_cvt_pk_bf16_f32 v65, v138, v139
    v_exp_f32 v141, v141
    v_exp_f32 v142, v142
    v_cvt_pk_bf16_f32 v66, v140, v141
    v_exp_f32 v143, v143
    v_mfma_f32_32x32x8_bf16 v[48:63], v[116:117], v[28:29], v[48:63]
    v_exp_f32 v144, v144
    v_cvt_pk_bf16_f32 v67, v142, v143
    v_exp_f32 v145, v145
    v_exp_f32 v146, v146
    v_cvt_pk_bf16_f32 v68, v144, v145
    v_exp_f32 v147, v147
    s_waitcnt lgkmcnt(2)
    v_mfma_f32_32x32x16_bf16 v[72:87], v[128:131], v[64:67], v[72:87]
    v_exp_f32 v148, v148
    v_cvt_pk_bf16_f32 v69, v146, v147
    v_exp_f32 v149, v149
    v_exp_f32 v150, v150
    v_exp_f32 v151, v151
    v_cvt_pk_bf16_f32 v70, v148, v149
    v_cvt_pk_bf16_f32 v71, v150, v151
    v_add_u32 v3, s56, v3
    s_waitcnt lgkmcnt(0)
    v_mfma_f32_32x32x16_bf16 v[136:151], v[104:107], v[16:19], 0
    s_mov_b64 exec, s[54:55]
    ds_read_b128 v[120:123], v3 offset:1152
    ds_read_b128 v[124:127], v3 offset:1728
    s_mov_b64 exec, -1
    v_exp_f32 v48, v48
    v_exp_f32 v49, v49
    v_exp_f32 v50, v50
    v_cvt_pk_bf16_f32 v64, v48, v49
    v_exp_f32 v51, v51
    v_mfma_f32_32x32x16_bf16 v[72:87], v[132:135], v[68:71], v[72:87]
    v_exp_f32 v52, v52
    v_cvt_pk_bf16_f32 v65, v50, v51
    v_exp_f32 v53, v53
    v_exp_f32 v54, v54
    v_cvt_pk_bf16_f32 v66, v52, v53
    v_exp_f32 v55, v55
    v_mfma_f32_32x32x8_bf16 v[136:151], v[108:109], v[20:21], v[136:151]
    v_exp_f32 v56, v56
    v_cvt_pk_bf16_f32 v67, v54, v55
    v_exp_f32 v57, v57
    v_exp_f32 v58, v58
    v_cvt_pk_bf16_f32 v68, v56, v57
    v_exp_f32 v59, v59
    v_mfma_f32_32x32x16_bf16 v[88:103], v[128:131], v[64:67], v[88:103]
    v_exp_f32 v60, v60
    v_cvt_pk_bf16_f32 v69, v58, v59
    v_exp_f32 v61, v61
    v_exp_f32 v62, v62
    v_exp_f32 v63, v63
    v_cvt_pk_bf16_f32 v70, v60, v61
    v_cvt_pk_bf16_f32 v71, v62, v63
    s_cmp_lg_u32 s48, 1
    s_cbranch_scc1 KB_KV1_OK
    v_mov_b32 v4, 158528
    s_mov_b32 s34, 0x400000
KB_KV1:
    ds_read_b128 v[12:15], v4
    s_waitcnt lgkmcnt(0)
    v_min_u32 v12, v12, v13
    v_min3_u32 v12, v12, v14, v15
    s_nop 0
    v_readfirstlane_b32 s35, v12
    s_cmp_lg_u32 s35, 0
    s_cbranch_scc1 KB_KV1_OK
    s_sleep 1
    s_sub_u32 s34, s34, 1
    s_cmp_lg_u32 s34, 0
    s_cbranch_scc1 KB_KV1
KB_KV1_OK:
    s_add_u32 s48, s48, 1
    s_cmp_lt_u32 s48, 7
    s_cbranch_scc1 KB_LOOP
    ds_read_b128 v[112:115], v1 offset:2304
    ds_read_b32 v116, v2 offset:3328
    v_exp_f32 v136, v136
    v_exp_f32 v137, v137
    v_mfma_f32_32x32x16_bf16 v[88:103], v[132:135], v[68:71], v[88:103]
    v_exp_f32 v138, v138
    v_cvt_pk_bf16_f32 v64, v136, v137
    v_exp_f32 v139, v139
    v_exp_f32 v140, v140
    v_cvt_pk_bf16_f32 v65, v138, v139
    s_waitcnt lgkmcnt(0)
    v_mfma_f32_32x32x16_bf16 v[48:63], v[112:115], v[16:19], 0
    ds_read_b128 v[104:107], v1 offset:4608
    ds_read_b32 v108, v2 offset:5632
    s_mov_b64 exec, s[54:55]
    ds_read_b128 v[128:131], v3 offset:3456
    ds_read_b128 v[132:135], v3 offset:4032
    s_mov_b64 exec, -1
    v_exp_f32 v141, v141
    v_exp_f32 v142, v142
    v_cvt_pk_bf16_f32 v66, v140, v141
    v_exp_f32 v143, v143
    v_mfma_f32_32x32x8_bf16 v[48:63], v[116:117], v[20:21], v[48:63]
    v_exp_f32 v144, v144
    v_cvt_pk_bf16_f32 v67, v142, v143
    v_exp_f32 v145, v145
    v_exp_f32 v146, v146
    v_cvt_pk_bf16_f32 v68, v144, v145
    v_exp_f32 v147, v147
    v_mfma_f32_32x32x16_bf16 v[72:87], v[120:123], v[64:67], v[72:87]
    v_exp_f32 v148, v148
    v_cvt_pk_bf16_f32 v69, v146, v147
    v_exp_f32 v149, v149
    v_exp_f32 v150, v150
    v_exp_f32 v151, v151
    v_cvt_pk_bf16_f32 v70, v148, v149
    v_cvt_pk_bf16_f32 v71, v150, v151
    v_exp_f32 v48, v48
    v_exp_f32 v49, v49
    v_mfma_f32_32x32x16_bf16 v[72:87], v[124:127], v[68:71], v[72:87]
    v_exp_f32 v50, v50
    v_cvt_pk_bf16_f32 v64, v48, v49
    v_exp_f32 v51, v51
    v_exp_f32 v52, v52
    v_cvt_pk_bf16_f32 v65, v50, v51
    s_waitcnt lgkmcnt(0)
    v_mfma_f32_32x32x16_bf16 v[136:151], v[104:107], v[16:19], 0
    ds_read_b128 v[112:115], v1 offset:6912
    ds_read_b32 v116, v2 offset:7936
    s_mov_b64 exec, s[54:55]
    ds_read_b128 v[120:123], v3 offset:5760
    ds_read_b128 v[124:127], v3 offset:6336
    s_mov_b64 exec, -1
    v_exp_f32 v53, v53
    v_exp_f32 v54, v54
    v_cvt_pk_bf16_f32 v66, v52, v53
    v_exp_f32 v55, v55
    v_mfma_f32_32x32x8_bf16 v[136:151], v[108:109], v[20:21], v[136:151]
    v_exp_f32 v56, v56
    v_cvt_pk_bf16_f32 v67, v54, v55
    v_exp_f32 v57, v57
    v_exp_f32 v58, v58
    v_cvt_pk_bf16_f32 v68, v56, v57
    v_exp_f32 v59, v59
    v_mfma_f32_32x32x16_bf16 v[72:87], v[128:131], v[64:67], v[72:87]
    v_exp_f32 v60, v60
    v_cvt_pk_bf16_f32 v69, v58, v59
    v_exp_f32 v61, v61
    v_exp_f32 v62, v62
    v_exp_f32 v63, v63
    v_cvt_pk_bf16_f32 v70, v60, v61
    v_cvt_pk_bf16_f32 v71, v62, v63
    v_exp_f32 v136, v136
    v_exp_f32 v137, v137
    v_mfma_f32_32x32x16_bf16 v[72:87], v[132:135], v[68:71], v[72:87]
    v_exp_f32 v138, v138
    v_cvt_pk_bf16_f32 v64, v136, v137
    v_exp_f32 v139, v139
    v_exp_f32 v140, v140
    v_cvt_pk_bf16_f32 v65, v138, v139
    s_waitcnt lgkmcnt(0)
    v_mfma_f32_32x32x16_bf16 v[48:63], v[112:115], v[16:19], 0
    ds_read_b128 v[104:107], v1 offset:9216
    ds_read_b32 v108, v2 offset:10240
    s_mov_b64 exec, s[54:55]
    ds_read_b128 v[128:131], v3 offset:8064
    ds_read_b128 v[132:135], v3 offset:8640
    s_mov_b64 exec, -1
    v_exp_f32 v141, v141
    v_exp_f32 v142, v142
    v_cvt_pk_bf16_f32 v66, v140, v141
    v_exp_f32 v143, v143
    v_mfma_f32_32x32x8_bf16 v[48:63], v[116:117], v[20:21], v[48:63]
    v_exp_f32 v144, v144
    v_cvt_pk_bf16_f32 v67, v142, v143
    v_exp_f32 v145, v145
    v_exp_f32 v146, v146
    v_cvt_pk_bf16_f32 v68, v144, v145
    v_exp_f32 v147, v147
    v_mfma_f32_32x32x16_bf16 v[72:87], v[120:123], v[64:67], v[72:87]
    v_exp_f32 v148, v148
    v_cvt_pk_bf16_f32 v69, v146, v147
    v_exp_f32 v149, v149
    v_exp_f32 v150, v150
    v_exp_f32 v151, v151
    v_cvt_pk_bf16_f32 v70, v148, v149
    v_cvt_pk_bf16_f32 v71, v150, v151
    v_exp_f32 v48, v48
    v_exp_f32 v49, v49
    v_mfma_f32_32x32x16_bf16 v[72:87], v[124:127], v[68:71], v[72:87]
    v_exp_f32 v50, v50
    v_cvt_pk_bf16_f32 v64, v48, v49
    v_exp_f32 v51, v51
    v_exp_f32 v52, v52
    v_cvt_pk_bf16_f32 v65, v50, v51
    s_waitcnt lgkmcnt(0)
    v_mfma_f32_32x32x16_bf16 v[136:151], v[104:107], v[16:19], 0
    ds_read_b128 v[112:115], v1 offset:11520
    ds_read_b32 v116, v2 offset:12544
    s_mov_b64 exec, s[54:55]
    ds_read_b128 v[120:123], v3 offset:10368
    ds_read_b128 v[124:127], v3 offset:10944
    s_mov_b64 exec, -1
    v_exp_f32 v53, v53
    v_exp_f32 v54, v54
    v_cvt_pk_bf16_f32 v66, v52, v53
    v_exp_f32 v55, v55
    v_mfma_f32_32x32x8_bf16 v[136:151], v[108:109], v[20:21], v[136:151]
    v_exp_f32 v56, v56
    v_cvt_pk_bf16_f32 v67, v54, v55
    v_exp_f32 v57, v57
    v_exp_f32 v58, v58
    v_cvt_pk_bf16_f32 v68, v56, v57
    v_exp_f32 v59, v59
    v_mfma_f32_32x32x16_bf16 v[72:87], v[128:131], v[64:67], v[72:87]
    v_exp_f32 v60, v60
    v_cvt_pk_bf16_f32 v69, v58, v59
    v_exp_f32 v61, v61
    v_exp_f32 v62, v62
    v_exp_f32 v63, v63
    v_cvt_pk_bf16_f32 v70, v60, v61
    v_cvt_pk_bf16_f32 v71, v62, v63
    v_exp_f32 v136, v136
    v_exp_f32 v137, v137
    v_mfma_f32_32x32x16_bf16 v[72:87], v[132:135], v[68:71], v[72:87]
    v_exp_f32 v138, v138
    v_cvt_pk_bf16_f32 v64, v136, v137
    v_exp_f32 v139, v139
    v_exp_f32 v140, v140
    v_cvt_pk_bf16_f32 v65, v138, v139
    s_waitcnt lgkmcnt(0)
    v_mfma_f32_32x32x16_bf16 v[48:63], v[112:115], v[16:19], 0
    ds_read_b128 v[104:107], v1 offset:13824
    ds_read_b32 v108, v2 offset:14848
    s_mov_b64 exec, s[54:55]
    ds_read_b128 v[128:131], v3 offset:12672
    ds_read_b128 v[132:135], v3 offset:13248
    s_mov_b64 exec, -1
    v_exp_f32 v141, v141
    v_exp_f32 v142, v142
    v_cvt_pk_bf16_f32 v66, v140, v141
    v_exp_f32 v143, v143
    v_mfma_f32_32x32x8_bf16 v[48:63], v[116:117], v[20:21], v[48:63]
    v_exp_f32 v144, v144
    v_cvt_pk_bf16_f32 v67, v142, v143
    v_exp_f32 v145, v145
    v_exp_f32 v146, v146
    v_cvt_pk_bf16_f32 v68, v144, v145
    v_exp_f32 v147, v147
    v_mfma_f32_32x32x16_bf16 v[72:87], v[120:123], v[64:67], v[72:87]
    v_exp_f32 v148, v148
    v_cvt_pk_bf16_f32 v69, v146, v147
    v_exp_f32 v149, v149
    v_exp_f32 v150, v150
    v_exp_f32 v151, v151
    v_cvt_pk_bf16_f32 v70, v148, v149
    v_cvt_pk_bf16_f32 v71, v150, v151
    v_exp_f32 v48, v48
    v_exp_f32 v49, v49
    v_mfma_f32_32x32x16_bf16 v[72:87], v[124:127], v[68:71], v[72:87]
    v_exp_f32 v50, v50
    v_cvt_pk_bf16_f32 v64, v48, v49
    v_exp_f32 v51, v51
    v_exp_f32 v52, v52
    v_cvt_pk_bf16_f32 v65, v50, v51
    s_waitcnt lgkmcnt(0)
    v_mfma_f32_32x32x16_bf16 v[136:151], v[104:107], v[16:19], 0
    ds_read_b128 v[112:115], v1 offset:16128
    ds_read_b32 v116, v2 offset:17152
    s_mov_b64 exec, s[54:55]
    ds_read_b128 v[120:123], v3 offset:14976
    ds_read_b128 v[124:127], v3 offset:15552
    s_mov_b64 exec, -1
    v_exp_f32 v53, v53
    v_exp_f32 v54, v54
    v_cvt_pk_bf16_f32 v66, v52, v53
    v_exp_f32 v55, v55
    v_mfma_f32_32x32x8_bf16 v[136:151], v[108:109], v[20:21], v[136:151]
    v_exp_f32 v56, v56
    v_cvt_pk_bf16_f32 v67, v54, v55
    v_exp_f32 v57, v57
    v_exp_f32 v58, v58
    v_cvt_pk_bf16_f32 v68, v56, v57
    v_exp_f32 v59, v59
    v_mfma_f32_32x32x16_bf16 v[72:87], v[128:131], v[64:67], v[72:87]
    v_exp_f32 v60, v60
    v_cvt_pk_bf16_f32 v69, v58, v59
    v_exp_f32 v61, v61
    v_exp_f32 v62, v62
    v_exp_f32 v63, v63
    v_cvt_pk_bf16_f32 v70, v60, v61
    v_cvt_pk_bf16_f32 v71, v62, v63
    v_exp_f32 v136, v136
    v_exp_f32 v137, v137
    v_mfma_f32_32x32x16_bf16 v[72:87], v[132:135], v[68:71], v[72:87]
    v_exp_f32 v138, v138
    v_cvt_pk_bf16_f32 v64, v136, v137
    v_exp_f32 v139, v139
    v_exp_f32 v140, v140
    v_cvt_pk_bf16_f32 v65, v138, v139
    s_waitcnt lgkmcnt(0)
    v_mfma_f32_32x32x16_bf16 v[48:63], v[112:115], v[16:19], 0
    ds_read_b128 v[104:107], v1 offset:0
    ds_read_b32 v108, v2 offset:1024
    s_mov_b64 exec, s[54:55]
    ds_read_b128 v[128:131], v3 offset:17280
    ds_read_b128 v[132:135], v3 offset:17856
    s_mov_b64 exec, -1
    v_exp_f32 v141, v141
    v_exp_f32 v142, v142
    v_cvt_pk_bf16_f32 v66, v140, v141
    v_exp_f32 v143, v143
    v_mfma_f32_32x32x8_bf16 v[48:63], v[116:117], v[20:21], v[48:63]
    v_exp_f32 v144, v144
    v_cvt_pk_bf16_f32 v67, v142, v143
    v_exp_f32 v145, v145
    v_exp_f32 v146, v146
    v_cvt_pk_bf16_f32 v68, v144, v145
    v_exp_f32 v147, v147
    v_mfma_f32_32x32x16_bf16 v[72:87], v[120:123], v[64:67], v[72:87]
    v_exp_f32 v148, v148
    v_cvt_pk_bf16_f32 v69, v146, v147
    v_exp_f32 v149, v149
    v_exp_f32 v150, v150
    v_exp_f32 v151, v151
    v_cvt_pk_bf16_f32 v70, v148, v149
    v_cvt_pk_bf16_f32 v71, v150, v151
    v_exp_f32 v48, v48
    v_exp_f32 v49, v49
    v_mfma_f32_32x32x16_bf16 v[72:87], v[124:127], v[68:71], v[72:87]
    v_exp_f32 v50, v50
    v_cvt_pk_bf16_f32 v64, v48, v49
    v_exp_f32 v51, v51
    v_exp_f32 v52, v52
    v_cvt_pk_bf16_f32 v65, v50, v51
    s_waitcnt lgkmcnt(0)
    v_mfma_f32_32x32x16_bf16 v[136:151], v[104:107], v[24:27], 0
    ds_read_b128 v[112:115], v1 offset:2304
    ds_read_b32 v116, v2 offset:3328
    s_mov_b64 exec, s[54:55]
    ds_read_b128 v[120:123], v3 offset:1152
    ds_read_b128 v[124:127], v3 offset:1728
    s_mov_b64 exec, -1
    v_exp_f32 v53, v53
    v_exp_f32 v54, v54
    v_cvt_pk_bf16_f32 v66, v52, v53
    v_exp_f32 v55, v55
    v_mfma_f32_32x32x8_bf16 v[136:151], v[108:109], v[28:29], v[136:151]
    v_exp_f32 v56, v56
    v_cvt_pk_bf16_f32 v67, v54, v55
    v_exp_f32 v57, v57
    v_exp_f32 v58, v58
    v_cvt_pk_bf16_f32 v68, v56, v57
    v_exp_f32 v59, v59
    v_mfma_f32_32x32x16_bf16 v[72:87], v[128:131], v[64:67], v[72:87]
    v_exp_f32 v60, v60
    v_cvt_pk_bf16_f32 v69, v58, v59
    v_exp_f32 v61, v61
    v_exp_f32 v62, v62
    v_exp_f32 v63, v63
    v_cvt_pk_bf16_f32 v70, v60, v61
    v_cvt_pk_bf16_f32 v71, v62, v63
    v_exp_f32 v136, v136
    v_exp_f32 v137, v137
    v_mfma_f32_32x32x16_bf16 v[72:87], v[132:135], v[68:71], v[72:87]
    v_exp_f32 v138, v138
    v_cvt_pk_bf16_f32 v64, v136, v137
    v_exp_f32 v139, v139
    v_exp_f32 v140, v140
    v_cvt_pk_bf16_f32 v65, v138, v139
    s_waitcnt lgkmcnt(0)
    v_mfma_f32_32x32x16_bf16 v[48:63], v[112:115], v[24:27], 0
    ds_read_b128 v[104:107], v1 offset:4608
    ds_read_b32 v108, v2 offset:5632
    s_mov_b64 exec, s[54:55]
    ds_read_b128 v[128:131], v3 offset:3456
    ds_read_b128 v[132:135], v3 offset:4032
    s_mov_b64 exec, -1
    v_exp_f32 v141, v141
    v_exp_f32 v142, v142
    v_cvt_pk_bf16_f32 v66, v140, v141
    v_exp_f32 v143, v143
    v_mfma_f32_32x32x8_bf16 v[48:63], v[116:117], v[28:29], v[48:63]
    v_exp_f32 v144, v144
    v_cvt_pk_bf16_f32 v67, v142, v143
    v_exp_f32 v145, v145
    v_exp_f32 v146, v146
    v_cvt_pk_bf16_f32 v68, v144, v145
    v_exp_f32 v147, v147
    v_mfma_f32_32x32x16_bf16 v[88:103], v[120:123], v[64:67], v[88:103]
    v_exp_f32 v148, v148
    v_cvt_pk_bf16_f32 v69, v146, v147
    v_exp_f32 v149, v149
    v_exp_f32 v150, v150
    v_exp_f32 v151, v151
    v_cvt_pk_bf16_f32 v70, v148, v149
    v_cvt_pk_bf16_f32 v71, v150, v151
    v_mul_f32 v4, 0, v72
    v_mul_f32 v5, 0, v73
    v_rcp_f32 v8, v82
    v_fma_f32 v4, v74, 0, v4
    v_fma_f32 v5, v75, 0, v5
    v_fma_f32 v4, v76, 0, v4
    v_fma_f32 v5, v77, 0, v5
    v_fma_f32 v4, v78, 0, v4
    v_fma_f32 v5, v79, 0, v5
    v_fma_f32 v4, v80, 0, v4
    v_fma_f32 v5, v81, 0, v5
    v_fma_f32 v4, v82, 0, v4
    v_cmp_lt_f32 vcc, 0x76800000, v82
    v_add_f32 v4, v4, v5
    s_mov_b64 s[32:33], vcc
    v_cmp_gt_f32 vcc, 0x0b800000, v82
    s_or_b64 s[32:33], s[32:33], vcc
    v_cmp_neq_f32 vcc, 0, v4
    s_or_b64 s[32:33], s[32:33], vcc
    s_cselect_b32 s58, 1, 0
    s_cbranch_scc1 KB_NOPA
    v_mul_f32 v72, v8, v72
    v_mul_f32 v73, v8, v73
    v_mul_f32 v74, v8, v74
    v_mul_f32 v75, v8, v75
    v_mul_f32 v76, v8, v76
    v_mul_f32 v77, v8, v77
    v_mul_f32 v78, v8, v78
    v_mul_f32 v79, v8, v79
    v_mul_f32 v80, v8, v80
    v_mul_f32 v81, v8, v81
    v_cvt_pk_bf16_f32 v152, v72, v73
    v_cvt_pk_bf16_f32 v153, v74, v75
    v_cvt_pk_bf16_f32 v154, v76, v77
    v_cvt_pk_bf16_f32 v155, v78, v79
    v_cvt_pk_bf16_f32 v156, v80, v81
    v_min_u32 v152, -2, v152
    v_min_u32 v153, -2, v153
    v_min_u32 v154, -2, v154
    v_min_u32 v155, -2, v155
    v_min_u32 v156, -2, v156
    buffer_store_dwordx4 v[152:155], v36, s[36:39], s50 offen offset:0 sc1
    buffer_store_dword v156, v37, s[36:39], s51 offen offset:0 sc1
KB_NOPA:
    v_exp_f32 v48, v48
    v_exp_f32 v49, v49
    v_mfma_f32_32x32x16_bf16 v[88:103], v[124:127], v[68:71], v[88:103]
    v_exp_f32 v50, v50
    v_cvt_pk_bf16_f32 v64, v48, v49
    v_exp_f32 v51, v51
    v_exp_f32 v52, v52
    v_cvt_pk_bf16_f32 v65, v50, v51
    s_waitcnt lgkmcnt(0)
    v_mfma_f32_32x32x16_bf16 v[136:151], v[104:107], v[24:27], 0
    ds_read_b128 v[112:115], v1 offset:6912
    ds_read_b32 v116, v2 offset:7936
    s_mov_b64 exec, s[54:55]
    ds_read_b128 v[120:123], v3 offset:5760
    ds_read_b128 v[124:127], v3 offset:6336
    s_mov_b64 exec, -1
    v_exp_f32 v53, v53
    v_exp_f32 v54, v54
    v_cvt_pk_bf16_f32 v66, v52, v53
    v_exp_f32 v55, v55
    v_mfma_f32_32x32x8_bf16 v[136:151], v[108:109], v[28:29], v[136:151]
    v_exp_f32 v56, v56
    v_cvt_pk_bf16_f32 v67, v54, v55
    v_exp_f32 v57, v57
    v_exp_f32 v58, v58
    v_cvt_pk_bf16_f32 v68, v56, v57
    v_exp_f32 v59, v59
    v_mfma_f32_32x32x16_bf16 v[88:103], v[128:131], v[64:67], v[88:103]
    v_exp_f32 v60, v60
    v_cvt_pk_bf16_f32 v69, v58, v59
    v_exp_f32 v61, v61
    v_exp_f32 v62, v62
    v_exp_f32 v63, v63
    v_cvt_pk_bf16_f32 v70, v60, v61
    v_cvt_pk_bf16_f32 v71, v62, v63
    v_exp_f32 v136, v136
    v_exp_f32 v137, v137
    v_mfma_f32_32x32x16_bf16 v[88:103], v[132:135], v[68:71], v[88:103]
    v_exp_f32 v138, v138
    v_cvt_pk_bf16_f32 v64, v136, v137
    v_exp_f32 v139, v139
    v_exp_f32 v140, v140
    v_cvt_pk_bf16_f32 v65, v138, v139
    s_waitcnt lgkmcnt(0)
    v_mfma_f32_32x32x16_bf16 v[48:63], v[112:115], v[24:27], 0
    ds_read_b128 v[104:107], v1 offset:9216
    ds_read_b32 v108, v2 offset:10240
    s_mov_b64 exec, s[54:55]
    ds_read_b128 v[128:131], v3 offset:8064
    ds_read_b128 v[132:135], v3 offset:8640
    s_mov_b64 exec, -1
    v_exp_f32 v141, v141
    v_exp_f32 v142, v142
    v_cvt_pk_bf16_f32 v66, v140, v141
    v_exp_f32 v143, v143
    v_mfma_f32_32x32x8_bf16 v[48:63], v[116:117], v[28:29], v[48:63]
    v_exp_f32 v144, v144
    v_cvt_pk_bf16_f32 v67, v142, v143
    v_exp_f32 v145, v145
    v_exp_f32 v146, v146
    v_cvt_pk_bf16_f32 v68, v144, v145
    v_exp_f32 v147, v147
    v_mfma_f32_32x32x16_bf16 v[88:103], v[120:123], v[64:67], v[88:103]
    v_exp_f32 v148, v148
    v_cvt_pk_bf16_f32 v69, v146, v147
    v_exp_f32 v149, v149
    v_exp_f32 v150, v150
    v_exp_f32 v151, v151
    v_cvt_pk_bf16_f32 v70, v148, v149
    v_cvt_pk_bf16_f32 v71, v150, v151
    v_exp_f32 v48, v48
    v_exp_f32 v49, v49
    v_mfma_f32_32x32x16_bf16 v[88:103], v[124:127], v[68:71], v[88:103]
    v_exp_f32 v50, v50
    v_cvt_pk_bf16_f32 v64, v48, v49
    v_exp_f32 v51, v51
    v_exp_f32 v52, v52
    v_cvt_pk_bf16_f32 v65, v50, v51
    s_waitcnt lgkmcnt(0)
    v_mfma_f32_32x32x16_bf16 v[136:151], v[104:107], v[24:27], 0
    ds_read_b128 v[112:115], v1 offset:11520
    ds_read_b32 v116, v2 offset:12544
    s_mov_b64 exec, s[54:55]
    ds_read_b128 v[120:123], v3 offset:10368
    ds_read_b128 v[124:127], v3 offset:10944
    s_mov_b64 exec, -1
    v_exp_f32 v53, v53
    v_exp_f32 v54, v54
    v_cvt_pk_bf16_f32 v66, v52, v53
    v_exp_f32 v55, v55
    v_mfma_f32_32x32x8_bf16 v[136:151], v[108:109], v[28:29], v[136:151]
    v_exp_f32 v56, v56
    v_cvt_pk_bf16_f32 v67, v54, v55
    v_exp_f32 v57, v57
    v_exp_f32 v58, v58
    v_cvt_pk_bf16_f32 v68, v56, v57
    v_exp_f32 v59, v59
    v_mfma_f32_32x32x16_bf16 v[88:103], v[128:131], v[64:67], v[88:103]
    v_exp_f32 v60, v60
    v_cvt_pk_bf16_f32 v69, v58, v59
    v_exp_f32 v61, v61
    v_exp_f32 v62, v62
    v_exp_f32 v63, v63
    v_cvt_pk_bf16_f32 v70, v60, v61
    v_cvt_pk_bf16_f32 v71, v62, v63
    v_exp_f32 v136, v136
    v_exp_f32 v137, v137
    v_mfma_f32_32x32x16_bf16 v[88:103], v[132:135], v[68:71], v[88:103]
    v_exp_f32 v138, v138
    v_cvt_pk_bf16_f32 v64, v136, v137
    v_exp_f32 v139, v139
    v_exp_f32 v140, v140
    v_cvt_pk_bf16_f32 v65, v138, v139
    s_waitcnt lgkmcnt(0)
    v_mfma_f32_32x32x16_bf16 v[48:63], v[112:115], v[24:27], 0
    ds_read_b128 v[104:107], v1 offset:13824
    ds_read_b32 v108, v2 offset:14848
    s_mov_b64 exec, s[54:55]
    ds_read_b128 v[128:131], v3 offset:12672
    ds_read_b128 v[132:135], v3 offset:13248
    s_mov_b64 exec, -1
    v_exp_f32 v141, v141
    v_exp_f32 v142, v142
    v_cvt_pk_bf16_f32 v66, v140, v141
    v_exp_f32 v143, v143
    v_mfma_f32_32x32x8_bf16 v[48:63], v[116:117], v[28:29], v[48:63]
    v_exp_f32 v144, v144
    v_cvt_pk_bf16_f32 v67, v142, v143
    v_exp_f32 v145, v145
    v_exp_f32 v146, v146
    v_cvt_pk_bf16_f32 v68, v144, v145
    v_exp_f32 v147, v147
    v_mfma_f32_32x32x16_bf16 v[88:103], v[120:123], v[64:67], v[88:103]
    v_exp_f32 v148, v148
    v_cvt_pk_bf16_f32 v69, v146, v147
    v_exp_f32 v149, v149
    v_exp_f32 v150, v150
    v_exp_f32 v151, v151
    v_cvt_pk_bf16_f32 v70, v148, v149
    v_cvt_pk_bf16_f32 v71, v150, v151
    s_waitcnt vmcnt(0)
    s_lshl_b32 s35, s7, 2
    s_add_u32 s35, s35, 158544
    v_mov_b32 v12, s35
    v_mov_b32 v13, 1
    s_mov_b64 exec, 1
    ds_write_b32 v12, v13
    s_mov_b64 exec, -1
    v_exp_f32 v48, v48
    v_exp_f32 v49, v49
    v_mfma_f32_32x32x16_bf16 v[88:103], v[124:127], v[68:71], v[88:103]
    v_exp_f32 v50, v50
    v_cvt_pk_bf16_f32 v64, v48, v49
    v_exp_f32 v51, v51
    v_exp_f32 v52, v52
    v_cvt_pk_bf16_f32 v65, v50, v51
    s_waitcnt lgkmcnt(0)
    v_mfma_f32_32x32x16_bf16 v[136:151], v[104:107], v[24:27], 0
    ds_read_b128 v[112:115], v1 offset:16128
    ds_read_b32 v116, v2 offset:17152
    s_mov_b64 exec, s[54:55]
    ds_read_b128 v[120:123], v3 offset:14976
    ds_read_b128 v[124:127], v3 offset:15552
    s_mov_b64 exec, -1
    v_exp_f32 v53, v53
    v_exp_f32 v54, v54
    v_cvt_pk_bf16_f32 v66, v52, v53
    v_exp_f32 v55, v55
    v_mfma_f32_32x32x8_bf16 v[136:151], v[108:109], v[28:29], v[136:151]
    v_exp_f32 v56, v56
    v_cvt_pk_bf16_f32 v67, v54, v55
    v_exp_f32 v57, v57
    v_exp_f32 v58, v58
    v_cvt_pk_bf16_f32 v68, v56, v57
    v_exp_f32 v59, v59
    v_mfma_f32_32x32x16_bf16 v[88:103], v[128:131], v[64:67], v[88:103]
    v_exp_f32 v60, v60
    v_cvt_pk_bf16_f32 v69, v58, v59
    v_exp_f32 v61, v61
    v_exp_f32 v62, v62
    v_exp_f32 v63, v63
    v_cvt_pk_bf16_f32 v70, v60, v61
    v_cvt_pk_bf16_f32 v71, v62, v63
    v_exp_f32 v136, v136
    v_exp_f32 v137, v137
    v_mfma_f32_32x32x16_bf16 v[88:103], v[132:135], v[68:71], v[88:103]
    v_exp_f32 v138, v138
    v_cvt_pk_bf16_f32 v64, v136, v137
    v_exp_f32 v139, v139
    v_exp_f32 v140, v140
    v_cvt_pk_bf16_f32 v65, v138, v139
    s_waitcnt lgkmcnt(0)
    v_mfma_f32_32x32x16_bf16 v[48:63], v[112:115], v[24:27], 0
    s_mov_b64 exec, s[54:55]
    ds_read_b128 v[128:131], v3 offset:17280
    ds_read_b128 v[132:135], v3 offset:17856
    s_mov_b64 exec, -1
    v_exp_f32 v141, v141
    v_exp_f32 v142, v142
    v_cvt_pk_bf16_f32 v66, v140, v141
    v_exp_f32 v143, v143
    v_mfma_f32_32x32x8_bf16 v[48:63], v[116:117], v[28:29], v[48:63]
    v_exp_f32 v144, v144
    v_cvt_pk_bf16_f32 v67, v142, v143
    v_exp_f32 v145, v145
    v_exp_f32 v146, v146
    v_cvt_pk_bf16_f32 v68, v144, v145
    v_exp_f32 v147, v147
    v_mfma_f32_32x32x16_bf16 v[88:103], v[120:123], v[64:67], v[88:103]
    v_exp_f32 v148, v148
    v_cvt_pk_bf16_f32 v69, v146, v147
    v_exp_f32 v149, v149
    v_exp_f32 v150, v150
    v_exp_f32 v151, v151
    v_cvt_pk_bf16_f32 v70, v148, v149
    v_cvt_pk_bf16_f32 v71, v150, v151
    v_exp_f32 v48, v48
    v_exp_f32 v49, v49
    v_mfma_f32_32x32x16_bf16 v[88:103], v[124:127], v[68:71], v[88:103]
    v_exp_f32 v50, v50
    v_cvt_pk_bf16_f32 v64, v48, v49
    v_exp_f32 v51, v51
    v_exp_f32 v52, v52
    v_cvt_pk_bf16_f32 v65, v50, v51
    s_waitcnt lgkmcnt(0)
    v_exp_f32 v53, v53
    v_exp_f32 v54, v54
    v_cvt_pk_bf16_f32 v66, v52, v53
    v_exp_f32 v55, v55
    v_exp_f32 v56, v56
    v_cvt_pk_bf16_f32 v67, v54, v55
    v_exp_f32 v57, v57
    v_exp_f32 v58, v58
    v_cvt_pk_bf16_f32 v68, v56, v57
    v_exp_f32 v59, v59
    v_mfma_f32_32x32x16_bf16 v[88:103], v[128:131], v[64:67], v[88:103]
    v_exp_f32 v60, v60
    v_cvt_pk_bf16_f32 v69, v58, v59
    v_exp_f32 v61, v61
    v_exp_f32 v62, v62
    v_exp_f32 v63, v63
    v_cvt_pk_bf16_f32 v70, v60, v61
    v_cvt_pk_bf16_f32 v71, v62, v63
    s_nop 1
    v_mfma_f32_32x32x16_bf16 v[88:103], v[132:135], v[68:71], v[88:103]
    s_waitcnt lgkmcnt(0)
    v_and_b32 v7, 15, v0
    s_mov_b32 s28, s64
    s_mov_b32 s29, s65
    s_mov_b32 s30, 2359296
    s_mov_b32 s31, 0x00020000
    v_mul_u32_u24 v38, 1152, v7
    v_lshrrev_b32 v7, 4, v0
    v_lshl_add_u32 v38, v7, 3, v38
    s_nop 2
    v_mul_f32 v4, 0, v88
    v_mul_f32 v5, 0, v89
    v_rcp_f32 v9, v98
    v_fma_f32 v4, v90, 0, v4
    v_fma_f32 v5, v91, 0, v5
    v_fma_f32 v4, v92, 0, v4
    v_fma_f32 v5, v93, 0, v5
    v_fma_f32 v4, v94, 0, v4
    v_fma_f32 v5, v95, 0, v5
    v_fma_f32 v4, v96, 0, v4
    v_fma_f32 v5, v97, 0, v5
    v_fma_f32 v4, v98, 0, v4
    v_cmp_lt_f32 vcc, 0x76800000, v98
    v_add_f32 v4, v4, v5
    s_mov_b64 s[32:33], vcc
    v_cmp_gt_f32 vcc, 0x0b800000, v98
    s_or_b64 s[32:33], s[32:33], vcc
    v_cmp_neq_f32 vcc, 0, v4
    s_or_b64 s[32:33], s[32:33], vcc
    s_cbranch_scc1 KB_REDO
    s_cmp_lg_u32 s58, 0
    s_cbranch_scc1 KB_REDO
KB_SAFE:
    v_mul_f32 v88, v9, v88
    v_mul_f32 v89, v9, v89
    v_mul_f32 v90, v9, v90
    v_mul_f32 v91, v9, v91
    v_mul_f32 v92, v9, v92
    v_mul_f32 v93, v9, v93
    v_mul_f32 v94, v9, v94
    v_mul_f32 v95, v9, v95
    v_mul_f32 v96, v9, v96
    v_mul_f32 v97, v9, v97
    v_cvt_pk_bf16_f32 v160, v88, v89
    v_cvt_pk_bf16_f32 v161, v90, v91
    v_cvt_pk_bf16_f32 v162, v92, v93
    v_cvt_pk_bf16_f32 v163, v94, v95
    v_cvt_pk_bf16_f32 v164, v96, v97
    v_min_u32 v160, -2, v160
    v_min_u32 v161, -2, v161
    v_min_u32 v162, -2, v162
    v_min_u32 v163, -2, v163
    v_min_u32 v164, -2, v164
    buffer_store_dwordx4 v[160:163], v36, s[36:39], s50 offen offset:2048 sc1
    buffer_store_dword v164, v37, s[36:39], s51 offen offset:2048 sc1
    s_and_b32 s34, s7, 1
    s_xor_b32 s32, s34, s6
    s_lshl_b32 s33, s4, 2
    s_add_u32 s32, s32, s33
    s_mul_i32 s52, s32, 18432
    s_lshr_b32 s33, s5, 1
    s_mul_i32 s33, s33, 288
    s_add_u32 s52, s52, s33
    s_add_u32 s53, s52, 128
    s_cmp_lg_u32 s7, 0
    s_cselect_b32 s53, 0x7f000000, s53
    s_mul_i32 s33, s6, 160
    s_add_u32 s52, s52, s33
    s_lshr_b32 s33, s7, 1
    s_lshl_b32 s32, s33, 6
    s_add_u32 s52, s52, s32
    s_add_u32 s59, s52, 36864
    s_add_u32 s60, s53, 36864
    s_lshl_b32 s33, s33, 2
    s_add_u32 s33, s33, s34
    s_lshl_b32 s33, s33, 10
    s_add_u32 s33, s33, 73728
    v_lshl_add_u32 v39, v0, 4, s33
    v_add_u32 v40, 36864, v39
    v_lshlrev_b32 v41, 4, v0
    v_add_u32 v41, 81920, v41
    buffer_load_dwordx2 v[16:17], v38, s[24:27], s52 offen offset:0
    buffer_load_dwordx2 v[18:19], v38, s[24:27], s52 offen offset:32
    buffer_load_dwordx2 v[20:21], v38, s[24:27], s53 offen
    buffer_load_dwordx2 v[22:23], v38, s[24:27], s59 offen offset:0
    buffer_load_dwordx2 v[24:25], v38, s[24:27], s59 offen offset:32
    buffer_load_dwordx2 v[26:27], v38, s[24:27], s60 offen
    v_mov_b32 v4, 158480
    s_mov_b32 s34, 0x400000
KB_FW:
    ds_read_b128 v[12:15], v4
    s_waitcnt lgkmcnt(0)
    v_min_u32 v12, v12, v13
    v_min3_u32 v12, v12, v14, v15
    s_nop 0
    v_readfirstlane_b32 s35, v12
    s_cmp_lg_u32 s35, 0
    s_cbranch_scc1 KB_FW_OK
    s_sleep 2
    s_sub_u32 s34, s34, 1
    s_cmp_lg_u32 s34, 0
    s_cbranch_scc1 KB_FW
KB_FW_OK:
    ds_read_b128 v[200:203], v40 offset:0
    ds_read_b128 v[204:207], v40 offset:9216
    ds_read_b128 v[208:211], v40 offset:18432
    ds_read_b128 v[212:215], v40 offset:27648
    ds_read_b128 v[216:219], v40 offset:2048
    ds_read_b128 v[220:223], v40 offset:11264
    ds_read_b128 v[224:227], v40 offset:20480
    ds_read_b128 v[228:231], v40 offset:29696
    ds_read_b128 v[232:235], v41 offset:36864
    ds_read_b128 v[236:239], v41 offset:46080
    ds_read_b128 v[240:243], v41 offset:55296
    ds_read_b128 v[244:247], v41 offset:64512
    ds_read_b128 v[152:155], v39 offset:0
    ds_read_b128 v[156:159], v39 offset:9216
    ds_read_b128 v[160:163], v39 offset:18432
    ds_read_b128 v[164:167], v39 offset:27648
    ds_read_b128 v[168:171], v39 offset:2048
    ds_read_b128 v[172:175], v39 offset:11264
    ds_read_b128 v[176:179], v39 offset:20480
    ds_read_b128 v[180:183], v39 offset:29696
    ds_read_b128 v[184:187], v41 offset:0
    ds_read_b128 v[188:191], v41 offset:9216
    ds_read_b128 v[192:195], v41 offset:18432
    ds_read_b128 v[196:199], v41 offset:27648
    s_waitcnt lgkmcnt(15)
    v_add_f32 v200, v200, v204
    v_add_f32 v201, v201, v205
    v_add_f32 v202, v202, v206
    v_add_f32 v203, v203, v207
    v_add_f32 v208, v208, v212
    v_add_f32 v209, v209, v213
    v_add_f32 v210, v210, v214
    v_add_f32 v211, v211, v215
    v_add_f32 v200, v200, v208
    v_add_f32 v201, v201, v209
    v_add_f32 v202, v202, v210
    v_add_f32 v203, v203, v211
    v_mul_f32 v204, 0xbfb8aa3b, v200
    v_mul_f32 v205, 0xbfb8aa3b, v201
    v_mul_f32 v206, 0xbfb8aa3b, v202
    v_mul_f32 v207, 0xbfb8aa3b, v203
    v_exp_f32 v204, v204
    v_exp_f32 v205, v205
    v_exp_f32 v206, v206
    v_exp_f32 v207, v207
    v_add_f32 v204, 1.0, v204
    v_add_f32 v205, 1.0, v205
    v_add_f32 v206, 1.0, v206
    v_add_f32 v207, 1.0, v207
    v_rcp_f32 v204, v204
    v_rcp_f32 v205, v205
    v_rcp_f32 v206, v206
    v_rcp_f32 v207, v207
    v_mul_f32 v200, v200, v204
    v_mul_f32 v201, v201, v205
    v_mul_f32 v202, v202, v206
    v_mul_f32 v203, v203, v207
    v_add_f32 v216, v216, v220
    v_add_f32 v217, v217, v221
    v_add_f32 v218, v218, v222
    v_add_f32 v219, v219, v223
    v_add_f32 v224, v224, v228
    v_add_f32 v225, v225, v229
    v_add_f32 v226, v226, v230
    v_add_f32 v227, v227, v231
    v_add_f32 v216, v216, v224
    v_add_f32 v217, v217, v225
    v_add_f32 v218, v218, v226
    v_add_f32 v219, v219, v227
    v_mul_f32 v220, 0xbfb8aa3b, v216
    v_mul_f32 v221, 0xbfb8aa3b, v217
    v_mul_f32 v222, 0xbfb8aa3b, v218
    v_mul_f32 v223, 0xbfb8aa3b, v219
    v_exp_f32 v220, v220
    v_exp_f32 v221, v221
    v_exp_f32 v222, v222
    v_exp_f32 v223, v223
    v_add_f32 v220, 1.0, v220
    v_add_f32 v221, 1.0, v221
    v_add_f32 v222, 1.0, v222
    v_add_f32 v223, 1.0, v223
    v_rcp_f32 v220, v220
    v_rcp_f32 v221, v221
    v_rcp_f32 v222, v222
    v_rcp_f32 v223, v223
    v_mul_f32 v216, v216, v220
    v_mul_f32 v217, v217, v221
    v_mul_f32 v218, v218, v222
    v_mul_f32 v219, v219, v223
    s_waitcnt lgkmcnt(12)
    v_add_f32 v232, v232, v236
    v_add_f32 v233, v233, v237
    v_add_f32 v234, v234, v238
    v_add_f32 v235, v235, v239
    v_add_f32 v240, v240, v244
    v_add_f32 v241, v241, v245
    v_add_f32 v242, v242, v246
    v_add_f32 v243, v243, v247
    v_add_f32 v232, v232, v240
    v_add_f32 v233, v233, v241
    v_add_f32 v234, v234, v242
    v_add_f32 v235, v235, v243
    v_mul_f32 v236, 0xbfb8aa3b, v232
    v_mul_f32 v237, 0xbfb8aa3b, v233
    v_mul_f32 v238, 0xbfb8aa3b, v234
    v_mul_f32 v239, 0xbfb8aa3b, v235
    v_exp_f32 v236, v236
    v_exp_f32 v237, v237
    v_exp_f32 v238, v238
    v_exp_f32 v239, v239
    v_add_f32 v236, 1.0, v236
    v_add_f32 v237, 1.0, v237
    v_add_f32 v238, 1.0, v238
    v_add_f32 v239, 1.0, v239
    v_rcp_f32 v236, v236
    v_rcp_f32 v237, v237
    v_rcp_f32 v238, v238
    v_rcp_f32 v239, v239
    v_mul_f32 v232, v232, v236
    v_mul_f32 v233, v233, v237
    v_mul_f32 v234, v234, v238
    v_mul_f32 v235, v235, v239
    s_waitcnt vmcnt(6)
    s_lshl_b32 s35, s7, 2
    s_add_u32 s35, s35, 158512
    v_mov_b32 v12, s35
    v_mov_b32 v13, 1
    s_mov_b64 exec, 1
    ds_write_b32 v12, v13
    s_mov_b64 exec, -1
    s_waitcnt lgkmcnt(9)
    v_add_f32 v152, v152, v156
    v_add_f32 v153, v153, v157
    v_add_f32 v154, v154, v158
    v_add_f32 v155, v155, v159
    v_add_f32 v160, v160, v164
    v_add_f32 v161, v161, v165
    v_add_f32 v162, v162, v166
    v_add_f32 v163, v163, v167
    v_add_f32 v152, v152, v160
    v_add_f32 v153, v153, v161
    v_add_f32 v154, v154, v162
    v_add_f32 v155, v155, v163
    v_mul_f32 v156, 0xbfb8aa3b, v152
    v_mul_f32 v157, 0xbfb8aa3b, v153
    v_mul_f32 v158, 0xbfb8aa3b, v154
    v_mul_f32 v159, 0xbfb8aa3b, v155
    v_exp_f32 v156, v156
    v_exp_f32 v157, v157
    v_exp_f32 v158, v158
    v_exp_f32 v159, v159
    v_add_f32 v156, 1.0, v156
    v_add_f32 v157, 1.0, v157
    v_add_f32 v158, 1.0, v158
    v_add_f32 v159, 1.0, v159
    v_rcp_f32 v156, v156
    v_rcp_f32 v157, v157
    v_rcp_f32 v158, v158
    v_rcp_f32 v159, v159
    v_mul_f32 v152, v152, v156
    v_mul_f32 v153, v153, v157
    v_mul_f32 v154, v154, v158
    v_mul_f32 v155, v155, v159
    s_waitcnt lgkmcnt(5)
    v_add_f32 v168, v168, v172
    v_add_f32 v169, v169, v173
    v_add_f32 v170, v170, v174
    v_add_f32 v171, v171, v175
    v_add_f32 v176, v176, v180
    v_add_f32 v177, v177, v181
    v_add_f32 v178, v178, v182
    v_add_f32 v179, v179, v183
    v_add_f32 v168, v168, v176
    v_add_f32 v169, v169, v177
    v_add_f32 v170, v170, v178
    v_add_f32 v171, v171, v179
    v_mul_f32 v172, 0xbfb8aa3b, v168
    v_mul_f32 v173, 0xbfb8aa3b, v169
    v_mul_f32 v174, 0xbfb8aa3b, v170
    v_mul_f32 v175, 0xbfb8aa3b, v171
    v_exp_f32 v172, v172
    v_exp_f32 v173, v173
    v_exp_f32 v174, v174
    v_exp_f32 v175, v175
    v_add_f32 v172, 1.0, v172
    v_add_f32 v173, 1.0, v173
    v_add_f32 v174, 1.0, v174
    v_add_f32 v175, 1.0, v175
    v_rcp_f32 v172, v172
    v_rcp_f32 v173, v173
    v_rcp_f32 v174, v174
    v_rcp_f32 v175, v175
    v_mul_f32 v168, v168, v172
    v_mul_f32 v169, v169, v173
    v_mul_f32 v170, v170, v174
    v_mul_f32 v171, v171, v175
    s_waitcnt lgkmcnt(1)
    v_add_f32 v184, v184, v188
    v_add_f32 v185, v185, v189
    v_add_f32 v186, v186, v190
    v_add_f32 v187, v187, v191
    v_add_f32 v192, v192, v196
    v_add_f32 v193, v193, v197
    v_add_f32 v194, v194, v198
    v_add_f32 v195, v195, v199
    v_add_f32 v184, v184, v192
    v_add_f32 v185, v185, v193
    v_add_f32 v186, v186, v194
    v_add_f32 v187, v187, v195
    v_mul_f32 v188, 0xbfb8aa3b, v184
    v_mul_f32 v189, 0xbfb8aa3b, v185
    v_mul_f32 v190, 0xbfb8aa3b, v186
    v_mul_f32 v191, 0xbfb8aa3b, v187
    v_exp_f32 v188, v188
    v_exp_f32 v189, v189
    v_exp_f32 v190, v190
    v_exp_f32 v191, v191
    v_add_f32 v188, 1.0, v188
    v_add_f32 v189, 1.0, v189
    v_add_f32 v190, 1.0, v190
    v_add_f32 v191, 1.0, v191
    v_rcp_f32 v188, v188
    v_rcp_f32 v189, v189
    v_rcp_f32 v190, v190
    v_rcp_f32 v191, v191
    v_mul_f32 v184, v184, v188
    v_mul_f32 v185, v185, v189
    v_mul_f32 v186, v186, v190
    v_mul_f32 v187, v187, v191
    s_waitcnt vmcnt(0)
    v_lshlrev_b32 v156, 16, v16
    v_and_b32 v157, 0xffff0000, v16
    v_lshlrev_b32 v158, 16, v17
    v_and_b32 v159, 0xffff0000, v17
    v_lshlrev_b32 v172, 16, v18
    v_and_b32 v173, 0xffff0000, v18
    v_lshlrev_b32 v174, 16, v19
    v_and_b32 v175, 0xffff0000, v19
    v_lshlrev_b32 v188, 16, v20
    v_and_b32 v189, 0xffff0000, v20
    v_lshlrev_b32 v190, 16, v21
    v_and_b32 v191, 0xffff0000, v21
    v_lshlrev_b32 v204, 16, v22
    v_and_b32 v205, 0xffff0000, v22
    v_lshlrev_b32 v206, 16, v23
    v_and_b32 v207, 0xffff0000, v23
    v_lshlrev_b32 v220, 16, v24
    v_and_b32 v221, 0xffff0000, v24
    v_lshlrev_b32 v222, 16, v25
    v_and_b32 v223, 0xffff0000, v25
    v_lshlrev_b32 v236, 16, v26
    v_and_b32 v237, 0xffff0000, v26
    v_lshlrev_b32 v238, 16, v27
    v_and_b32 v239, 0xffff0000, v27
    v_add_u32 v39, 0xfffee000, v39
    v_add_u32 v40, 0xfffee000, v40
    v_add_u32 v41, 0xfffee000, v41
    v_mov_b32 v4, 158560
    s_mov_b32 s34, 0x400000
KB_SW:
    ds_read_b128 v[12:15], v4
    s_waitcnt lgkmcnt(0)
    v_min_u32 v12, v12, v13
    v_min3_u32 v12, v12, v14, v15
    s_nop 0
    v_readfirstlane_b32 s35, v12
    s_cmp_lg_u32 s35, 0
    s_cbranch_scc1 KB_SW_OK
    s_sleep 1
    s_sub_u32 s34, s34, 1
    s_cmp_lg_u32 s34, 0
    s_cbranch_scc1 KB_SW
KB_SW_OK:
    ds_read_b128 v[56:59], v39 offset:0
    ds_read_b128 v[60:63], v39 offset:9216
    ds_read_b128 v[64:67], v39 offset:18432
    ds_read_b128 v[68:71], v39 offset:27648
    ds_read_b128 v[72:75], v39 offset:2048
    ds_read_b128 v[76:79], v39 offset:11264
    ds_read_b128 v[80:83], v39 offset:20480
    ds_read_b128 v[84:87], v39 offset:29696
    ds_read_b128 v[88:91], v41 offset:0
    ds_read_b128 v[92:95], v41 offset:9216
    ds_read_b128 v[96:99], v41 offset:18432
    ds_read_b128 v[100:103], v41 offset:27648
    s_waitcnt lgkmcnt(8)
    v_add_f32 v56, v56, v60
    v_add_f32 v57, v57, v61
    v_add_f32 v58, v58, v62
    v_add_f32 v59, v59, v63
    v_add_f32 v64, v64, v68
    v_add_f32 v65, v65, v69
    v_add_f32 v66, v66, v70
    v_add_f32 v67, v67, v71
    v_add_f32 v56, v56, v64
    v_add_f32 v57, v57, v65
    v_add_f32 v58, v58, v66
    v_add_f32 v59, v59, v67
    v_fma_f32 v156, v56, v152, v156
    v_fma_f32 v157, v57, v153, v157
    v_fma_f32 v158, v58, v154, v158
    v_fma_f32 v159, v59, v155, v159
    v_cvt_pk_bf16_f32 v160, v156, v157
    v_cvt_pk_bf16_f32 v161, v158, v159
    buffer_store_dwordx2 v[160:161], v38, s[28:31], s52 offen offset:0 nt
    s_waitcnt lgkmcnt(4)
    v_add_f32 v72, v72, v76
    v_add_f32 v73, v73, v77
    v_add_f32 v74, v74, v78
    v_add_f32 v75, v75, v79
    v_add_f32 v80, v80, v84
    v_add_f32 v81, v81, v85
    v_add_f32 v82, v82, v86
    v_add_f32 v83, v83, v87
    v_add_f32 v72, v72, v80
    v_add_f32 v73, v73, v81
    v_add_f32 v74, v74, v82
    v_add_f32 v75, v75, v83
    v_fma_f32 v172, v72, v168, v172
    v_fma_f32 v173, v73, v169, v173
    v_fma_f32 v174, v74, v170, v174
    v_fma_f32 v175, v75, v171, v175
    v_cvt_pk_bf16_f32 v176, v172, v173
    v_cvt_pk_bf16_f32 v177, v174, v175
    buffer_store_dwordx2 v[176:177], v38, s[28:31], s52 offen offset:32 nt
    s_waitcnt lgkmcnt(0)
    v_add_f32 v88, v88, v92
    v_add_f32 v89, v89, v93
    v_add_f32 v90, v90, v94
    v_add_f32 v91, v91, v95
    v_add_f32 v96, v96, v100
    v_add_f32 v97, v97, v101
    v_add_f32 v98, v98, v102
    v_add_f32 v99, v99, v103
    v_add_f32 v88, v88, v96
    v_add_f32 v89, v89, v97
    v_add_f32 v90, v90, v98
    v_add_f32 v91, v91, v99
    v_fma_f32 v188, v88, v184, v188
    v_fma_f32 v189, v89, v185, v189
    v_fma_f32 v190, v90, v186, v190
    v_fma_f32 v191, v91, v187, v191
    v_cvt_pk_bf16_f32 v192, v188, v189
    v_cvt_pk_bf16_f32 v193, v190, v191
    buffer_store_dwordx2 v[192:193], v38, s[28:31], s53 offen nt
    s_barrier
    ds_read_b128 v[56:59], v40 offset:0
    ds_read_b128 v[60:63], v40 offset:9216
    ds_read_b128 v[64:67], v40 offset:18432
    ds_read_b128 v[68:71], v40 offset:27648
    ds_read_b128 v[72:75], v40 offset:2048
    ds_read_b128 v[76:79], v40 offset:11264
    ds_read_b128 v[80:83], v40 offset:20480
    ds_read_b128 v[84:87], v40 offset:29696
    ds_read_b128 v[88:91], v41 offset:36864
    ds_read_b128 v[92:95], v41 offset:46080
    ds_read_b128 v[96:99], v41 offset:55296
    ds_read_b128 v[100:103], v41 offset:64512
    s_waitcnt lgkmcnt(8)
    v_add_f32 v56, v56, v60
    v_add_f32 v57, v57, v61
    v_add_f32 v58, v58, v62
    v_add_f32 v59, v59, v63
    v_add_f32 v64, v64, v68
    v_add_f32 v65, v65, v69
    v_add_f32 v66, v66, v70
    v_add_f32 v67, v67, v71
    v_add_f32 v56, v56, v64
    v_add_f32 v57, v57, v65
    v_add_f32 v58, v58, v66
    v_add_f32 v59, v59, v67
    v_fma_f32 v204, v56, v200, v204
    v_fma_f32 v205, v57, v201, v205
    v_fma_f32 v206, v58, v202, v206
    v_fma_f32 v207, v59, v203, v207
    v_cvt_pk_bf16_f32 v208, v204, v205
    v_cvt_pk_bf16_f32 v209, v206, v207
    buffer_store_dwordx2 v[208:209], v38, s[28:31], s59 offen offset:0 nt
    s_waitcnt lgkmcnt(4)
    v_add_f32 v72, v72, v76
    v_add_f32 v73, v73, v77
    v_add_f32 v74, v74, v78
    v_add_f32 v75, v75, v79
    v_add_f32 v80, v80, v84
    v_add_f32 v81, v81, v85
    v_add_f32 v82, v82, v86
    v_add_f32 v83, v83, v87
    v_add_f32 v72, v72, v80
    v_add_f32 v73, v73, v81
    v_add_f32 v74, v74, v82
    v_add_f32 v75, v75, v83
    v_fma_f32 v220, v72, v216, v220
    v_fma_f32 v221, v73, v217, v221
    v_fma_f32 v222, v74, v218, v222
    v_fma_f32 v223, v75, v219, v223
    v_cvt_pk_bf16_f32 v224, v220, v221
    v_cvt_pk_bf16_f32 v225, v222, v223
    buffer_store_dwordx2 v[224:225], v38, s[28:31], s59 offen offset:32 nt
    s_waitcnt lgkmcnt(0)
    v_add_f32 v88, v88, v92
    v_add_f32 v89, v89, v93
    v_add_f32 v90, v90, v94
    v_add_f32 v91, v91, v95
    v_add_f32 v96, v96, v100
    v_add_f32 v97, v97, v101
    v_add_f32 v98, v98, v102
    v_add_f32 v99, v99, v103
    v_add_f32 v88, v88, v96
    v_add_f32 v89, v89, v97
    v_add_f32 v90, v90, v98
    v_add_f32 v91, v91, v99
    v_fma_f32 v236, v88, v232, v236
    v_fma_f32 v237, v89, v233, v237
    v_fma_f32 v238, v90, v234, v238
    v_fma_f32 v239, v91, v235, v239
    v_cvt_pk_bf16_f32 v240, v236, v237
    v_cvt_pk_bf16_f32 v241, v238, v239
    buffer_store_dwordx2 v[240:241], v38, s[28:31], s60 offen nt
KB_END:
    s_endpgm
KB_REDO:
    v_lshlrev_b32 v1, 4, v0
    v_and_b32 v4, 31, v0
    v_lshlrev_b32 v2, 2, v4
    v_lshrrev_b32 v5, 5, v0
    v_mul_u32_u24 v3, 288, v5
    v_lshl_add_u32 v3, v4, 4, v3
    s_mov_b32 s32, 29884416
    v_mov_b32 v21, 0
    v_mov_b32 v10, 0xff800000
    v_mov_b32 v29, 0
    v_mov_b32 v11, 0xff800000
KB_RM:
    buffer_load_dwordx4 v[104:107], v1, s[36:39], s32 offen sc1
    buffer_load_dword v108, v2, s[36:39], s32 offen offset:1024 sc1
    s_waitcnt vmcnt(0)
    v_mfma_f32_32x32x16_bf16 v[136:151], v[104:107], v[16:19], 0
    v_mfma_f32_32x32x8_bf16 v[136:151], v[108:109], v[20:21], v[136:151]
    v_mfma_f32_32x32x16_bf16 v[48:63], v[104:107], v[24:27], 0
    v_mfma_f32_32x32x8_bf16 v[48:63], v[108:109], v[28:29], v[48:63]
    s_nop 11
    v_max3_f32 v10, v136, v137, v10
    v_max3_f32 v10, v138, v139, v10
    v_max3_f32 v10, v140, v141, v10
    v_max3_f32 v10, v142, v143, v10
    v_max3_f32 v10, v144, v145, v10
    v_max3_f32 v10, v146, v147, v10
    v_max3_f32 v10, v148, v149, v10
    v_max3_f32 v10, v150, v151, v10
    v_max3_f32 v11, v48, v49, v11
    v_max3_f32 v11, v50, v51, v11
    v_max3_f32 v11, v52, v53, v11
    v_max3_f32 v11, v54, v55, v11
    v_max3_f32 v11, v56, v57, v11
    v_max3_f32 v11, v58, v59, v11
    v_max3_f32 v11, v60, v61, v11
    v_max3_f32 v11, v62, v63, v11
    s_add_u32 s32, s32, 2304
    s_cmp_lt_u32 s32, 30031872
    s_cbranch_scc1 KB_RM
    s_mov_b32 s32, 29884416
    v_mov_b32 v4, v10
    v_mov_b32 v5, v11
    s_nop 1
    v_permlane32_swap_b32 v4, v10
    v_permlane32_swap_b32 v5, v11
    s_nop 1
    v_max_f32 v10, v4, v10
    v_max_f32 v11, v5, v11
    v_sub_f32 v10, 0x80000000, v10
    v_sub_f32 v11, 0x80000000, v11
    v_cvt_pk_bf16_f32 v4, v10, 0
    v_cvt_pk_bf16_f32 v5, v11, 0
    v_lshlrev_b32 v4, 16, v4
    v_lshlrev_b32 v5, 16, v5
    v_sub_f32 v4, v10, v4
    v_sub_f32 v5, v11, v5
    v_cvt_pk_bf16_f32 v21, v10, v4
    v_cvt_pk_bf16_f32 v29, v11, v5
    v_and_b32 v6, 0xffff0000, v21
    v_and_b32 v7, 0xffff0000, v29
    v_sub_f32 v4, v4, v6
    v_sub_f32 v5, v5, v7
    v_cmp_gt_u32 vcc, 32, v0
    v_cvt_pk_bf16_f32 v4, v4, 0
    v_cvt_pk_bf16_f32 v5, v5, 0
    v_cndmask_b32 v21, v4, v21, vcc
    v_cndmask_b32 v29, v5, v29, vcc
    v_mov_b32 v72, 0
    v_mov_b32 v73, 0
    v_mov_b32 v74, 0
    v_mov_b32 v75, 0
    v_mov_b32 v76, 0
    v_mov_b32 v77, 0
    v_mov_b32 v78, 0
    v_mov_b32 v79, 0
    v_mov_b32 v80, 0
    v_mov_b32 v81, 0
    v_mov_b32 v82, 0
    v_mov_b32 v83, 0
    v_mov_b32 v84, 0
    v_mov_b32 v85, 0
    v_mov_b32 v86, 0
    v_mov_b32 v87, 0
    v_mov_b32 v88, 0
    v_mov_b32 v89, 0
    v_mov_b32 v90, 0
    v_mov_b32 v91, 0
    v_mov_b32 v92, 0
    v_mov_b32 v93, 0
    v_mov_b32 v94, 0
    v_mov_b32 v95, 0
    v_mov_b32 v96, 0
    v_mov_b32 v97, 0
    v_mov_b32 v98, 0
    v_mov_b32 v99, 0
    v_mov_b32 v100, 0
    v_mov_b32 v101, 0
    v_mov_b32 v102, 0
    v_mov_b32 v103, 0
KB_RP:
    buffer_load_dwordx4 v[104:107], v1, s[36:39], s32 offen sc1
    buffer_load_dword v108, v2, s[36:39], s32 offen offset:1024 sc1
    s_mov_b64 exec, s[54:55]
    buffer_load_dwordx4 v[120:123], v3, s[36:39], s32 offen offset:1152 sc1
    buffer_load_dwordx4 v[124:127], v3, s[36:39], s32 offen offset:1728 sc1
    s_mov_b64 exec, -1
    s_waitcnt vmcnt(0)
    v_mfma_f32_32x32x16_bf16 v[136:151], v[104:107], v[16:19], 0
    v_mfma_f32_32x32x8_bf16 v[136:151], v[108:109], v[20:21], v[136:151]
    v_mfma_f32_32x32x16_bf16 v[48:63], v[104:107], v[24:27], 0
    v_mfma_f32_32x32x8_bf16 v[48:63], v[108:109], v[28:29], v[48:63]
    s_nop 11
    v_exp_f32 v136, v136
    v_exp_f32 v137, v137
    v_exp_f32 v138, v138
    v_exp_f32 v139, v139
    v_exp_f32 v140, v140
    v_exp_f32 v141, v141
    v_exp_f32 v142, v142
    v_exp_f32 v143, v143
    v_exp_f32 v144, v144
    v_exp_f32 v145, v145
    v_exp_f32 v146, v146
    v_exp_f32 v147, v147
    v_exp_f32 v148, v148
    v_exp_f32 v149, v149
    v_exp_f32 v150, v150
    v_exp_f32 v151, v151
    v_cvt_pk_bf16_f32 v64, v136, v137
    v_cvt_pk_bf16_f32 v65, v138, v139
    v_cvt_pk_bf16_f32 v66, v140, v141
    v_cvt_pk_bf16_f32 v67, v142, v143
    v_cvt_pk_bf16_f32 v68, v144, v145
    v_cvt_pk_bf16_f32 v69, v146, v147
    v_cvt_pk_bf16_f32 v70, v148, v149
    v_cvt_pk_bf16_f32 v71, v150, v151
    s_nop 1
    v_mfma_f32_32x32x16_bf16 v[72:87], v[120:123], v[64:67], v[72:87]
    v_mfma_f32_32x32x16_bf16 v[72:87], v[124:127], v[68:71], v[72:87]
    v_exp_f32 v48, v48
    v_exp_f32 v49, v49
    v_exp_f32 v50, v50
    v_exp_f32 v51, v51
    v_exp_f32 v52, v52
    v_exp_f32 v53, v53
    v_exp_f32 v54, v54
    v_exp_f32 v55, v55
    v_exp_f32 v56, v56
    v_exp_f32 v57, v57
    v_exp_f32 v58, v58
    v_exp_f32 v59, v59
    v_exp_f32 v60, v60
    v_exp_f32 v61, v61
    v_exp_f32 v62, v62
    v_exp_f32 v63, v63
    v_cvt_pk_bf16_f32 v64, v48, v49
    v_cvt_pk_bf16_f32 v65, v50, v51
    v_cvt_pk_bf16_f32 v66, v52, v53
    v_cvt_pk_bf16_f32 v67, v54, v55
    v_cvt_pk_bf16_f32 v68, v56, v57
    v_cvt_pk_bf16_f32 v69, v58, v59
    v_cvt_pk_bf16_f32 v70, v60, v61
    v_cvt_pk_bf16_f32 v71, v62, v63
    s_nop 1
    v_mfma_f32_32x32x16_bf16 v[88:103], v[120:123], v[64:67], v[88:103]
    v_mfma_f32_32x32x16_bf16 v[88:103], v[124:127], v[68:71], v[88:103]
    s_add_u32 s32, s32, 2304
    s_cmp_lt_u32 s32, 30031872
    s_cbranch_scc1 KB_RP
    s_nop 11
    v_rcp_f32 v8, v82
    v_rcp_f32 v9, v98
    s_cmp_eq_u32 s58, 0
    s_cbranch_scc1 KB_SAFE
    v_mul_f32 v72, v8, v72
    v_mul_f32 v73, v8, v73
    v_mul_f32 v74, v8, v74
    v_mul_f32 v75, v8, v75
    v_mul_f32 v76, v8, v76
    v_mul_f32 v77, v8, v77
    v_mul_f32 v78, v8, v78
    v_mul_f32 v79, v8, v79
    v_mul_f32 v80, v8, v80
    v_mul_f32 v81, v8, v81
    v_cvt_pk_bf16_f32 v152, v72, v73
    v_cvt_pk_bf16_f32 v153, v74, v75
    v_cvt_pk_bf16_f32 v154, v76, v77
    v_cvt_pk_bf16_f32 v155, v78, v79
    v_cvt_pk_bf16_f32 v156, v80, v81
    v_min_u32 v152, -2, v152
    v_min_u32 v153, -2, v153
    v_min_u32 v154, -2, v154
    v_min_u32 v155, -2, v155
    v_min_u32 v156, -2, v156
    buffer_store_dwordx4 v[152:155], v36, s[36:39], s50 offen offset:0 sc1
    buffer_store_dword v156, v37, s[36:39], s51 offen offset:0 sc1
    s_branch KB_SAFE
KB_GEMM:
    s_setprio 0
    s_mov_b32 s32, 30163968
    s_lshl_b32 s34, s6, 10
    v_add_u32 v1, s34, v0
    v_xor_b32 v2, 0x400, v1
    s_mul_i32 s59, s4, 589824
    s_lshr_b32 s34, s5, 1
    s_mul_i32 s60, s34, 9216
    s_add_u32 s60, s60, 18874368
    s_lshl_b32 s58, s44, 10
    s_lshl_b32 s35, s44, 1
    s_and_b32 s35, s35, 4
    s_add_u32 s35, s35, s44
    s_lshl_b32 s45, s35, 12
    s_add_u32 s45, s45, s59
    s_mul_i32 s47, s35, 36864
    s_add_u32 s47, s47, s60
    s_mul_i32 s35, s6, 5120
    s_add_u32 s46, s47, s35
    s_add_u32 s47, s47, 4096
    s_waitcnt vmcnt(2)
    v_and_b32 v48, v48, v49
    v_and_b32 v50, v50, v51
    v_and_b32 v48, v48, v50
    v_cmp_ne_u32 vcc, 1, v48
    s_cmp_eq_u64 vcc, 0
    s_cbranch_scc1 KB_RP2_OK
    buffer_load_dwordx4 v[48:51], v0, s[36:39], s32 offen sc1
    s_mov_b32 s48, 0x40000
KB_RP2:
    s_waitcnt vmcnt(0)
    v_and_b32 v48, v48, v49
    v_and_b32 v50, v50, v51
    v_and_b32 v48, v48, v50
    v_cmp_ne_u32 vcc, 1, v48
    s_cmp_eq_u64 vcc, 0
    s_cbranch_scc1 KB_RP2_OK
    s_sleep 6
    buffer_load_dwordx4 v[48:51], v0, s[36:39], s32 offen sc1
    s_sub_u32 s48, s48, 1
    s_cmp_lg_u32 s48, 0
    s_cbranch_scc1 KB_RP2
    s_waitcnt vmcnt(0)
KB_RP2_OK:
    s_add_u32 m0, s58, 114688
    s_add_u32 s34, s58, 29925376
    buffer_load_dwordx4 v0, s[36:39], s34 offen sc1 lds
    s_add_u32 m0, s58, 118784
    s_add_u32 s34, s58, 29929472
    buffer_load_dwordx4 v0, s[36:39], s34 offen sc1 lds
    s_add_u32 m0, s58, 122880
    s_add_u32 s34, s58, 29933568
    buffer_load_dwordx4 v0, s[36:39], s34 offen sc1 lds
    s_add_u32 m0, s58, 126976
    s_add_u32 s34, s58, 29937664
    buffer_load_dwordx4 v0, s[36:39], s34 offen sc1 lds
    s_add_u32 m0, s58, 131072
    s_add_u32 s34, s58, 29941760
    buffer_load_dwordx4 v0, s[36:39], s34 offen sc1 lds
    s_add_u32 m0, s58, 135168
    s_add_u32 s34, s58, 29945856
    buffer_load_dwordx4 v0, s[36:39], s34 offen sc1 lds
    s_add_u32 m0, s58, 139264
    s_add_u32 s34, s58, 29949952
    buffer_load_dwordx4 v0, s[36:39], s34 offen sc1 lds
    s_add_u32 m0, s58, 143360
    s_add_u32 s34, s58, 29954048
    buffer_load_dwordx4 v0, s[36:39], s34 offen sc1 lds
    buffer_load_dwordx4 v[112:115], v1, s[36:39], s45 offen offset:0 sc1
    buffer_load_dwordx4 v[116:119], v2, s[36:39], s45 offen offset:0 sc1
    buffer_load_dwordx4 v[120:123], v1, s[36:39], s45 offen offset:2048 sc1
    buffer_load_dwordx4 v[124:127], v2, s[36:39], s45 offen offset:2048 sc1
    buffer_load_dwordx4 v[128:131], v0, s[36:39], s46 offen offset:0 sc1
    buffer_load_dwordx4 v[132:135], v0, s[36:39], s46 offen offset:1024 sc1
    buffer_load_dwordx4 v[136:139], v0, s[36:39], s46 offen offset:2048 sc1
    buffer_load_dwordx4 v[140:143], v0, s[36:39], s46 offen offset:3072 sc1
    buffer_load_dwordx4 v[144:147], v0, s[36:39], s47 offen sc1
    s_add_u32 s45, s45, 32768
    s_add_u32 s46, s46, 294912
    s_add_u32 s47, s47, 294912
    buffer_load_dwordx4 v[148:151], v1, s[36:39], s45 offen offset:0 sc1
    buffer_load_dwordx4 v[152:155], v2, s[36:39], s45 offen offset:0 sc1
    buffer_load_dwordx4 v[156:159], v1, s[36:39], s45 offen offset:2048 sc1
    buffer_load_dwordx4 v[160:163], v2, s[36:39], s45 offen offset:2048 sc1
    buffer_load_dwordx4 v[164:167], v0, s[36:39], s46 offen offset:0 sc1
    buffer_load_dwordx4 v[168:171], v0, s[36:39], s46 offen offset:1024 sc1
    buffer_load_dwordx4 v[172:175], v0, s[36:39], s46 offen offset:2048 sc1
    buffer_load_dwordx4 v[176:179], v0, s[36:39], s46 offen offset:3072 sc1
    buffer_load_dwordx4 v[180:183], v0, s[36:39], s47 offen sc1
    s_add_u32 s45, s45, 32768
    s_add_u32 s46, s46, 294912
    s_add_u32 s47, s47, 294912
    buffer_load_dwordx4 v[184:187], v1, s[36:39], s45 offen offset:0 sc1
    buffer_load_dwordx4 v[188:191], v2, s[36:39], s45 offen offset:0 sc1
    buffer_load_dwordx4 v[192:195], v1, s[36:39], s45 offen offset:2048 sc1
    buffer_load_dwordx4 v[196:199], v2, s[36:39], s45 offen offset:2048 sc1
    buffer_load_dwordx4 v[200:203], v0, s[36:39], s46 offen offset:0 sc1
    buffer_load_dwordx4 v[204:207], v0, s[36:39], s46 offen offset:1024 sc1
    buffer_load_dwordx4 v[208:211], v0, s[36:39], s46 offen offset:2048 sc1
    buffer_load_dwordx4 v[212:215], v0, s[36:39], s46 offen offset:3072 sc1
    buffer_load_dwordx4 v[216:219], v0, s[36:39], s47 offen sc1
    s_add_u32 s45, s45, 32768
    s_add_u32 s46, s46, 294912
    s_add_u32 s47, s47, 294912
    buffer_load_dwordx4 v[220:223], v1, s[36:39], s45 offen offset:0 sc1
    buffer_load_dwordx4 v[224:227], v2, s[36:39], s45 offen offset:0 sc1
    buffer_load_dwordx4 v[228:231], v1, s[36:39], s45 offen offset:2048 sc1
    buffer_load_dwordx4 v[232:235], v2, s[36:39], s45 offen offset:2048 sc1
    buffer_load_dwordx4 v[236:239], v0, s[36:39], s46 offen offset:0 sc1
    buffer_load_dwordx4 v[240:243], v0, s[36:39], s46 offen offset:1024 sc1
    buffer_load_dwordx4 v[244:247], v0, s[36:39], s46 offen offset:2048 sc1
    buffer_load_dwordx4 v[248:251], v0, s[36:39], s46 offen offset:3072 sc1
    buffer_load_dwordx4 v[252:255], v0, s[36:39], s47 offen sc1
    s_add_u32 s45, s45, 32768
    s_add_u32 s46, s46, 294912
    s_add_u32 s47, s47, 294912
    buffer_load_dwordx4 v[76:79], v1, s[36:39], s45 offen offset:0 sc1
    buffer_load_dwordx4 v[80:83], v2, s[36:39], s45 offen offset:0 sc1
    buffer_load_dwordx4 v[84:87], v1, s[36:39], s45 offen offset:2048 sc1
    buffer_load_dwordx4 v[88:91], v2, s[36:39], s45 offen offset:2048 sc1
    buffer_load_dwordx4 v[92:95], v0, s[36:39], s46 offen offset:0 sc1
    buffer_load_dwordx4 v[96:99], v0, s[36:39], s46 offen offset:1024 sc1
    buffer_load_dwordx4 v[100:103], v0, s[36:39], s46 offen offset:2048 sc1
    buffer_load_dwordx4 v[104:107], v0, s[36:39], s46 offen offset:3072 sc1
    buffer_load_dwordx4 v[108:111], v0, s[36:39], s47 offen sc1
    s_add_u32 s45, s45, 32768
    s_add_u32 s46, s46, 294912
    s_add_u32 s47, s47, 294912
    s_add_u32 m0, s58, 0
    s_add_u32 s34, s58, 29958144
    buffer_load_dwordx4 v0, s[36:39], s34 offen sc1 lds
    s_add_u32 m0, s58, 4096
    s_add_u32 s34, s58, 29962240
    buffer_load_dwordx4 v0, s[36:39], s34 offen sc1 lds
    s_add_u32 m0, s58, 8192
    s_add_u32 s34, s58, 29966336
    buffer_load_dwordx4 v0, s[36:39], s34 offen sc1 lds
    s_waitcnt vmcnt(43)
    v_mfma_f32_16x16x32_bf16 v[4:7], v[128:131], v[112:115], 0
    v_mfma_f32_16x16x32_bf16 v[8:11], v[128:131], v[116:119], 0
    v_mfma_f32_16x16x32_bf16 v[40:43], v[128:131], v[120:123], 0
    v_mfma_f32_16x16x32_bf16 v[44:47], v[128:131], v[124:127], 0
    s_waitcnt vmcnt(42)
    v_mfma_f32_16x16x32_bf16 v[12:15], v[132:135], v[112:115], 0
    v_mfma_f32_16x16x32_bf16 v[16:19], v[132:135], v[116:119], 0
    v_mfma_f32_16x16x32_bf16 v[48:51], v[132:135], v[120:123], 0
    v_mfma_f32_16x16x32_bf16 v[52:55], v[132:135], v[124:127], 0
    s_waitcnt vmcnt(41)
    v_mfma_f32_16x16x32_bf16 v[20:23], v[136:139], v[112:115], 0
    v_mfma_f32_16x16x32_bf16 v[24:27], v[136:139], v[116:119], 0
    v_mfma_f32_16x16x32_bf16 v[56:59], v[136:139], v[120:123], 0
    v_mfma_f32_16x16x32_bf16 v[60:63], v[136:139], v[124:127], 0
    s_waitcnt vmcnt(40)
    v_mfma_f32_16x16x32_bf16 v[28:31], v[140:143], v[112:115], 0
    v_mfma_f32_16x16x32_bf16 v[32:35], v[140:143], v[116:119], 0
    v_mfma_f32_16x16x32_bf16 v[64:67], v[140:143], v[120:123], 0
    v_mfma_f32_16x16x32_bf16 v[68:71], v[140:143], v[124:127], 0
    s_waitcnt vmcnt(39)
    v_mfma_f32_16x16x32_bf16 v[36:39], v[144:147], v[112:115], 0
    v_mfma_f32_16x16x32_bf16 v[72:75], v[144:147], v[120:123], 0
    s_lshl_b32 s35, s7, 2
    s_add_u32 s35, s35, 158528
    v_mov_b32 v3, s35
    s_mov_b64 exec, 1
    ds_write_b32 v3, v3
    s_mov_b64 exec, -1
    v_mov_b32 v3, 1
    s_mov_b64 exec, 1
    buffer_store_dword v3, v0, s[36:39], s63 offen sc1
    s_mov_b64 exec, -1
    buffer_load_dwordx4 v[112:115], v1, s[36:39], s45 offen offset:0 sc1
    buffer_load_dwordx4 v[116:119], v2, s[36:39], s45 offen offset:0 sc1
    buffer_load_dwordx4 v[120:123], v1, s[36:39], s45 offen offset:2048 sc1
    buffer_load_dwordx4 v[124:127], v2, s[36:39], s45 offen offset:2048 sc1
    buffer_load_dwordx4 v[128:131], v0, s[36:39], s46 offen offset:0 sc1
    buffer_load_dwordx4 v[132:135], v0, s[36:39], s46 offen offset:1024 sc1
    buffer_load_dwordx4 v[136:139], v0, s[36:39], s46 offen offset:2048 sc1
    buffer_load_dwordx4 v[140:143], v0, s[36:39], s46 offen offset:3072 sc1
    buffer_load_dwordx4 v[144:147], v0, s[36:39], s47 offen sc1
    s_add_u32 s45, s45, 32768
    s_add_u32 s46, s46, 294912
    s_add_u32 s47, s47, 294912
    s_add_u32 m0, s58, 12288
    s_add_u32 s34, s58, 29970432
    buffer_load_dwordx4 v0, s[36:39], s34 offen sc1 lds
    s_add_u32 m0, s58, 16384
    s_add_u32 s34, s58, 29974528
    buffer_load_dwordx4 v0, s[36:39], s34 offen sc1 lds
    s_add_u32 m0, s58, 20480
    s_add_u32 s34, s58, 29978624
    buffer_load_dwordx4 v0, s[36:39], s34 offen sc1 lds
    s_waitcnt vmcnt(46)
    v_mfma_f32_16x16x32_bf16 v[4:7], v[164:167], v[148:151], v[4:7]
    v_mfma_f32_16x16x32_bf16 v[8:11], v[164:167], v[152:155], v[8:11]
    v_mfma_f32_16x16x32_bf16 v[40:43], v[164:167], v[156:159], v[40:43]
    v_mfma_f32_16x16x32_bf16 v[44:47], v[164:167], v[160:163], v[44:47]
    s_waitcnt vmcnt(45)
    v_mfma_f32_16x16x32_bf16 v[12:15], v[168:171], v[148:151], v[12:15]
    v_mfma_f32_16x16x32_bf16 v[16:19], v[168:171], v[152:155], v[16:19]
    v_mfma_f32_16x16x32_bf16 v[48:51], v[168:171], v[156:159], v[48:51]
    v_mfma_f32_16x16x32_bf16 v[52:55], v[168:171], v[160:163], v[52:55]
    s_waitcnt vmcnt(44)
    v_mfma_f32_16x16x32_bf16 v[20:23], v[172:175], v[148:151], v[20:23]
    v_mfma_f32_16x16x32_bf16 v[24:27], v[172:175], v[152:155], v[24:27]
    v_mfma_f32_16x16x32_bf16 v[56:59], v[172:175], v[156:159], v[56:59]
    v_mfma_f32_16x16x32_bf16 v[60:63], v[172:175], v[160:163], v[60:63]
    s_waitcnt vmcnt(43)
    v_mfma_f32_16x16x32_bf16 v[28:31], v[176:179], v[148:151], v[28:31]
    v_mfma_f32_16x16x32_bf16 v[32:35], v[176:179], v[152:155], v[32:35]
    v_mfma_f32_16x16x32_bf16 v[64:67], v[176:179], v[156:159], v[64:67]
    v_mfma_f32_16x16x32_bf16 v[68:71], v[176:179], v[160:163], v[68:71]
    s_waitcnt vmcnt(42)
    v_mfma_f32_16x16x32_bf16 v[36:39], v[180:183], v[148:151], v[36:39]
    v_mfma_f32_16x16x32_bf16 v[72:75], v[180:183], v[156:159], v[72:75]
    buffer_load_dwordx4 v[148:151], v1, s[36:39], s45 offen offset:0 sc1
    buffer_load_dwordx4 v[152:155], v2, s[36:39], s45 offen offset:0 sc1
    buffer_load_dwordx4 v[156:159], v1, s[36:39], s45 offen offset:2048 sc1
    buffer_load_dwordx4 v[160:163], v2, s[36:39], s45 offen offset:2048 sc1
    buffer_load_dwordx4 v[164:167], v0, s[36:39], s46 offen offset:0 sc1
    buffer_load_dwordx4 v[168:171], v0, s[36:39], s46 offen offset:1024 sc1
    buffer_load_dwordx4 v[172:175], v0, s[36:39], s46 offen offset:2048 sc1
    buffer_load_dwordx4 v[176:179], v0, s[36:39], s46 offen offset:3072 sc1
    buffer_load_dwordx4 v[180:183], v0, s[36:39], s47 offen sc1
    s_add_u32 s45, s45, 32768
    s_add_u32 s46, s46, 294912
    s_add_u32 s47, s47, 294912
    s_add_u32 m0, s58, 24576
    s_add_u32 s34, s58, 29982720
    buffer_load_dwordx4 v0, s[36:39], s34 offen sc1 lds
    s_add_u32 m0, s58, 28672
    s_add_u32 s34, s58, 29986816
    buffer_load_dwordx4 v0, s[36:39], s34 offen sc1 lds
    s_add_u32 m0, s58, 32768
    s_add_u32 s34, s58, 29990912
    buffer_load_dwordx4 v0, s[36:39], s34 offen sc1 lds
    s_waitcnt vmcnt(49)
    v_mfma_f32_16x16x32_bf16 v[4:7], v[200:203], v[184:187], v[4:7]
    v_mfma_f32_16x16x32_bf16 v[8:11], v[200:203], v[188:191], v[8:11]
    v_mfma_f32_16x16x32_bf16 v[40:43], v[200:203], v[192:195], v[40:43]
    v_mfma_f32_16x16x32_bf16 v[44:47], v[200:203], v[196:199], v[44:47]
    s_waitcnt vmcnt(48)
    v_mfma_f32_16x16x32_bf16 v[12:15], v[204:207], v[184:187], v[12:15]
    v_mfma_f32_16x16x32_bf16 v[16:19], v[204:207], v[188:191], v[16:19]
    v_mfma_f32_16x16x32_bf16 v[48:51], v[204:207], v[192:195], v[48:51]
    v_mfma_f32_16x16x32_bf16 v[52:55], v[204:207], v[196:199], v[52:55]
    s_waitcnt vmcnt(47)
    v_mfma_f32_16x16x32_bf16 v[20:23], v[208:211], v[184:187], v[20:23]
    v_mfma_f32_16x16x32_bf16 v[24:27], v[208:211], v[188:191], v[24:27]
    v_mfma_f32_16x16x32_bf16 v[56:59], v[208:211], v[192:195], v[56:59]
    v_mfma_f32_16x16x32_bf16 v[60:63], v[208:211], v[196:199], v[60:63]
    s_waitcnt vmcnt(46)
    v_mfma_f32_16x16x32_bf16 v[28:31], v[212:215], v[184:187], v[28:31]
    v_mfma_f32_16x16x32_bf16 v[32:35], v[212:215], v[188:191], v[32:35]
    v_mfma_f32_16x16x32_bf16 v[64:67], v[212:215], v[192:195], v[64:67]
    v_mfma_f32_16x16x32_bf16 v[68:71], v[212:215], v[196:199], v[68:71]
    s_waitcnt vmcnt(45)
    v_mfma_f32_16x16x32_bf16 v[36:39], v[216:219], v[184:187], v[36:39]
    v_mfma_f32_16x16x32_bf16 v[72:75], v[216:219], v[192:195], v[72:75]
    buffer_load_dwordx4 v[184:187], v1, s[36:39], s45 offen offset:0 sc1
    buffer_load_dwordx4 v[188:191], v2, s[36:39], s45 offen offset:0 sc1
    buffer_load_dwordx4 v[192:195], v1, s[36:39], s45 offen offset:2048 sc1
    buffer_load_dwordx4 v[196:199], v2, s[36:39], s45 offen offset:2048 sc1
    buffer_load_dwordx4 v[200:203], v0, s[36:39], s46 offen offset:0 sc1
    buffer_load_dwordx4 v[204:207], v0, s[36:39], s46 offen offset:1024 sc1
    buffer_load_dwordx4 v[208:211], v0, s[36:39], s46 offen offset:2048 sc1
    buffer_load_dwordx4 v[212:215], v0, s[36:39], s46 offen offset:3072 sc1
    buffer_load_dwordx4 v[216:219], v0, s[36:39], s47 offen sc1
    s_add_u32 s45, s45, 32768
    s_add_u32 s46, s46, 294912
    s_add_u32 s47, s47, 294912
    s_add_u32 m0, s58, 36864
    s_add_u32 s34, s58, 29995008
    buffer_load_dwordx4 v0, s[36:39], s34 offen sc1 lds
    s_add_u32 m0, s58, 40960
    s_add_u32 s34, s58, 29999104
    buffer_load_dwordx4 v0, s[36:39], s34 offen sc1 lds
    s_add_u32 m0, s58, 45056
    s_add_u32 s34, s58, 30003200
    buffer_load_dwordx4 v0, s[36:39], s34 offen sc1 lds
    s_waitcnt vmcnt(52)
    v_mfma_f32_16x16x32_bf16 v[4:7], v[236:239], v[220:223], v[4:7]
    v_mfma_f32_16x16x32_bf16 v[8:11], v[236:239], v[224:227], v[8:11]
    v_mfma_f32_16x16x32_bf16 v[40:43], v[236:239], v[228:231], v[40:43]
    v_mfma_f32_16x16x32_bf16 v[44:47], v[236:239], v[232:235], v[44:47]
    s_waitcnt vmcnt(51)
    v_mfma_f32_16x16x32_bf16 v[12:15], v[240:243], v[220:223], v[12:15]
    v_mfma_f32_16x16x32_bf16 v[16:19], v[240:243], v[224:227], v[16:19]
    v_mfma_f32_16x16x32_bf16 v[48:51], v[240:243], v[228:231], v[48:51]
    v_mfma_f32_16x16x32_bf16 v[52:55], v[240:243], v[232:235], v[52:55]
    s_waitcnt vmcnt(50)
    v_mfma_f32_16x16x32_bf16 v[20:23], v[244:247], v[220:223], v[20:23]
    v_mfma_f32_16x16x32_bf16 v[24:27], v[244:247], v[224:227], v[24:27]
    v_mfma_f32_16x16x32_bf16 v[56:59], v[244:247], v[228:231], v[56:59]
    v_mfma_f32_16x16x32_bf16 v[60:63], v[244:247], v[232:235], v[60:63]
    s_waitcnt vmcnt(49)
    v_mfma_f32_16x16x32_bf16 v[28:31], v[248:251], v[220:223], v[28:31]
    v_mfma_f32_16x16x32_bf16 v[32:35], v[248:251], v[224:227], v[32:35]
    v_mfma_f32_16x16x32_bf16 v[64:67], v[248:251], v[228:231], v[64:67]
    v_mfma_f32_16x16x32_bf16 v[68:71], v[248:251], v[232:235], v[68:71]
    s_waitcnt vmcnt(48)
    v_mfma_f32_16x16x32_bf16 v[36:39], v[252:255], v[220:223], v[36:39]
    v_mfma_f32_16x16x32_bf16 v[72:75], v[252:255], v[228:231], v[72:75]
    buffer_load_dwordx4 v[220:223], v1, s[36:39], s45 offen offset:0 sc1
    buffer_load_dwordx4 v[224:227], v2, s[36:39], s45 offen offset:0 sc1
    buffer_load_dwordx4 v[228:231], v1, s[36:39], s45 offen offset:2048 sc1
    buffer_load_dwordx4 v[232:235], v2, s[36:39], s45 offen offset:2048 sc1
    buffer_load_dwordx4 v[236:239], v0, s[36:39], s46 offen offset:0 sc1
    buffer_load_dwordx4 v[240:243], v0, s[36:39], s46 offen offset:1024 sc1
    buffer_load_dwordx4 v[244:247], v0, s[36:39], s46 offen offset:2048 sc1
    buffer_load_dwordx4 v[248:251], v0, s[36:39], s46 offen offset:3072 sc1
    buffer_load_dwordx4 v[252:255], v0, s[36:39], s47 offen sc1
    s_add_u32 s45, s45, 32768
    s_add_u32 s46, s46, 294912
    s_add_u32 s47, s47, 294912
    s_add_u32 m0, s58, 49152
    s_add_u32 s34, s58, 30007296
    buffer_load_dwordx4 v0, s[36:39], s34 offen sc1 lds
    s_add_u32 m0, s58, 53248
    s_add_u32 s34, s58, 30011392
    buffer_load_dwordx4 v0, s[36:39], s34 offen sc1 lds
    s_add_u32 m0, s58, 57344
    s_add_u32 s34, s58, 30015488
    buffer_load_dwordx4 v0, s[36:39], s34 offen sc1 lds
    s_waitcnt vmcnt(55)
    v_mfma_f32_16x16x32_bf16 v[4:7], v[92:95], v[76:79], v[4:7]
    v_mfma_f32_16x16x32_bf16 v[8:11], v[92:95], v[80:83], v[8:11]
    v_mfma_f32_16x16x32_bf16 v[40:43], v[92:95], v[84:87], v[40:43]
    v_mfma_f32_16x16x32_bf16 v[44:47], v[92:95], v[88:91], v[44:47]
    s_waitcnt vmcnt(54)
    v_mfma_f32_16x16x32_bf16 v[12:15], v[96:99], v[76:79], v[12:15]
    v_mfma_f32_16x16x32_bf16 v[16:19], v[96:99], v[80:83], v[16:19]
    v_mfma_f32_16x16x32_bf16 v[48:51], v[96:99], v[84:87], v[48:51]
    v_mfma_f32_16x16x32_bf16 v[52:55], v[96:99], v[88:91], v[52:55]
    s_waitcnt vmcnt(53)
    v_mfma_f32_16x16x32_bf16 v[20:23], v[100:103], v[76:79], v[20:23]
    v_mfma_f32_16x16x32_bf16 v[24:27], v[100:103], v[80:83], v[24:27]
    v_mfma_f32_16x16x32_bf16 v[56:59], v[100:103], v[84:87], v[56:59]
    v_mfma_f32_16x16x32_bf16 v[60:63], v[100:103], v[88:91], v[60:63]
    s_waitcnt vmcnt(52)
    v_mfma_f32_16x16x32_bf16 v[28:31], v[104:107], v[76:79], v[28:31]
    v_mfma_f32_16x16x32_bf16 v[32:35], v[104:107], v[80:83], v[32:35]
    v_mfma_f32_16x16x32_bf16 v[64:67], v[104:107], v[84:87], v[64:67]
    v_mfma_f32_16x16x32_bf16 v[68:71], v[104:107], v[88:91], v[68:71]
    s_waitcnt vmcnt(51)
    v_mfma_f32_16x16x32_bf16 v[36:39], v[108:111], v[76:79], v[36:39]
    v_mfma_f32_16x16x32_bf16 v[72:75], v[108:111], v[84:87], v[72:75]
    buffer_load_dwordx4 v[76:79], v1, s[36:39], s45 offen offset:0 sc1
    buffer_load_dwordx4 v[80:83], v2, s[36:39], s45 offen offset:0 sc1
    buffer_load_dwordx4 v[84:87], v1, s[36:39], s45 offen offset:2048 sc1
    buffer_load_dwordx4 v[88:91], v2, s[36:39], s45 offen offset:2048 sc1
    buffer_load_dwordx4 v[92:95], v0, s[36:39], s46 offen offset:0 sc1
    buffer_load_dwordx4 v[96:99], v0, s[36:39], s46 offen offset:1024 sc1
    buffer_load_dwordx4 v[100:103], v0, s[36:39], s46 offen offset:2048 sc1
    buffer_load_dwordx4 v[104:107], v0, s[36:39], s46 offen offset:3072 sc1
    buffer_load_dwordx4 v[108:111], v0, s[36:39], s47 offen sc1
    s_add_u32 s45, s45, 32768
    s_add_u32 s46, s46, 294912
    s_add_u32 s47, s47, 294912
    s_add_u32 m0, s58, 61440
    s_add_u32 s34, s58, 30019584
    buffer_load_dwordx4 v0, s[36:39], s34 offen sc1 lds
    s_add_u32 m0, s58, 65536
    s_add_u32 s34, s58, 30023680
    buffer_load_dwordx4 v0, s[36:39], s34 offen sc1 lds
    s_add_u32 m0, s58, 69632
    s_add_u32 s34, s58, 30027776
    buffer_load_dwordx4 v0, s[36:39], s34 offen sc1 lds
    s_waitcnt vmcnt(55)
    v_mfma_f32_16x16x32_bf16 v[4:7], v[128:131], v[112:115], v[4:7]
    v_mfma_f32_16x16x32_bf16 v[8:11], v[128:131], v[116:119], v[8:11]
    v_mfma_f32_16x16x32_bf16 v[40:43], v[128:131], v[120:123], v[40:43]
    v_mfma_f32_16x16x32_bf16 v[44:47], v[128:131], v[124:127], v[44:47]
    s_waitcnt vmcnt(54)
    v_mfma_f32_16x16x32_bf16 v[12:15], v[132:135], v[112:115], v[12:15]
    v_mfma_f32_16x16x32_bf16 v[16:19], v[132:135], v[116:119], v[16:19]
    v_mfma_f32_16x16x32_bf16 v[48:51], v[132:135], v[120:123], v[48:51]
    v_mfma_f32_16x16x32_bf16 v[52:55], v[132:135], v[124:127], v[52:55]
    s_waitcnt vmcnt(53)
    v_mfma_f32_16x16x32_bf16 v[20:23], v[136:139], v[112:115], v[20:23]
    v_mfma_f32_16x16x32_bf16 v[24:27], v[136:139], v[116:119], v[24:27]
    v_mfma_f32_16x16x32_bf16 v[56:59], v[136:139], v[120:123], v[56:59]
    v_mfma_f32_16x16x32_bf16 v[60:63], v[136:139], v[124:127], v[60:63]
    s_waitcnt vmcnt(52)
    v_mfma_f32_16x16x32_bf16 v[28:31], v[140:143], v[112:115], v[28:31]
    v_mfma_f32_16x16x32_bf16 v[32:35], v[140:143], v[116:119], v[32:35]
    v_mfma_f32_16x16x32_bf16 v[64:67], v[140:143], v[120:123], v[64:67]
    v_mfma_f32_16x16x32_bf16 v[68:71], v[140:143], v[124:127], v[68:71]
    s_waitcnt vmcnt(51)
    v_mfma_f32_16x16x32_bf16 v[36:39], v[144:147], v[112:115], v[36:39]
    v_mfma_f32_16x16x32_bf16 v[72:75], v[144:147], v[120:123], v[72:75]
    buffer_load_dwordx4 v[112:115], v1, s[36:39], s45 offen offset:0 sc1
    buffer_load_dwordx4 v[116:119], v2, s[36:39], s45 offen offset:0 sc1
    buffer_load_dwordx4 v[120:123], v1, s[36:39], s45 offen offset:2048 sc1
    buffer_load_dwordx4 v[124:127], v2, s[36:39], s45 offen offset:2048 sc1
    buffer_load_dwordx4 v[128:131], v0, s[36:39], s46 offen offset:0 sc1
    buffer_load_dwordx4 v[132:135], v0, s[36:39], s46 offen offset:1024 sc1
    buffer_load_dwordx4 v[136:139], v0, s[36:39], s46 offen offset:2048 sc1
    buffer_load_dwordx4 v[140:143], v0, s[36:39], s46 offen offset:3072 sc1
    buffer_load_dwordx4 v[144:147], v0, s[36:39], s47 offen sc1
    s_add_u32 s45, s45, 32768
    s_add_u32 s46, s46, 294912
    s_add_u32 s47, s47, 294912
    s_waitcnt vmcnt(52)
    v_mfma_f32_16x16x32_bf16 v[4:7], v[164:167], v[148:151], v[4:7]
    v_mfma_f32_16x16x32_bf16 v[8:11], v[164:167], v[152:155], v[8:11]
    v_mfma_f32_16x16x32_bf16 v[40:43], v[164:167], v[156:159], v[40:43]
    v_mfma_f32_16x16x32_bf16 v[44:47], v[164:167], v[160:163], v[44:47]
    s_waitcnt vmcnt(51)
    v_mfma_f32_16x16x32_bf16 v[12:15], v[168:171], v[148:151], v[12:15]
    v_mfma_f32_16x16x32_bf16 v[16:19], v[168:171], v[152:155], v[16:19]
    v_mfma_f32_16x16x32_bf16 v[48:51], v[168:171], v[156:159], v[48:51]
    v_mfma_f32_16x16x32_bf16 v[52:55], v[168:171], v[160:163], v[52:55]
    s_waitcnt vmcnt(50)
    v_mfma_f32_16x16x32_bf16 v[20:23], v[172:175], v[148:151], v[20:23]
    v_mfma_f32_16x16x32_bf16 v[24:27], v[172:175], v[152:155], v[24:27]
    v_mfma_f32_16x16x32_bf16 v[56:59], v[172:175], v[156:159], v[56:59]
    v_mfma_f32_16x16x32_bf16 v[60:63], v[172:175], v[160:163], v[60:63]
    s_waitcnt vmcnt(49)
    v_mfma_f32_16x16x32_bf16 v[28:31], v[176:179], v[148:151], v[28:31]
    v_mfma_f32_16x16x32_bf16 v[32:35], v[176:179], v[152:155], v[32:35]
    v_mfma_f32_16x16x32_bf16 v[64:67], v[176:179], v[156:159], v[64:67]
    v_mfma_f32_16x16x32_bf16 v[68:71], v[176:179], v[160:163], v[68:71]
    s_waitcnt vmcnt(48)
    v_mfma_f32_16x16x32_bf16 v[36:39], v[180:183], v[148:151], v[36:39]
    v_mfma_f32_16x16x32_bf16 v[72:75], v[180:183], v[156:159], v[72:75]
    buffer_load_dwordx4 v[148:151], v1, s[36:39], s45 offen offset:0 sc1
    buffer_load_dwordx4 v[152:155], v2, s[36:39], s45 offen offset:0 sc1
    buffer_load_dwordx4 v[156:159], v1, s[36:39], s45 offen offset:2048 sc1
    buffer_load_dwordx4 v[160:163], v2, s[36:39], s45 offen offset:2048 sc1
    buffer_load_dwordx4 v[164:167], v0, s[36:39], s46 offen offset:0 sc1
    buffer_load_dwordx4 v[168:171], v0, s[36:39], s46 offen offset:1024 sc1
    buffer_load_dwordx4 v[172:175], v0, s[36:39], s46 offen offset:2048 sc1
    buffer_load_dwordx4 v[176:179], v0, s[36:39], s46 offen offset:3072 sc1
    buffer_load_dwordx4 v[180:183], v0, s[36:39], s47 offen sc1
    s_add_u32 s45, s45, 32768
    s_add_u32 s46, s46, 294912
    s_add_u32 s47, s47, 294912
    s_waitcnt vmcnt(49)
    v_mfma_f32_16x16x32_bf16 v[4:7], v[200:203], v[184:187], v[4:7]
    v_mfma_f32_16x16x32_bf16 v[8:11], v[200:203], v[188:191], v[8:11]
    v_mfma_f32_16x16x32_bf16 v[40:43], v[200:203], v[192:195], v[40:43]
    v_mfma_f32_16x16x32_bf16 v[44:47], v[200:203], v[196:199], v[44:47]
    s_waitcnt vmcnt(48)
    v_mfma_f32_16x16x32_bf16 v[12:15], v[204:207], v[184:187], v[12:15]
    v_mfma_f32_16x16x32_bf16 v[16:19], v[204:207], v[188:191], v[16:19]
    v_mfma_f32_16x16x32_bf16 v[48:51], v[204:207], v[192:195], v[48:51]
    v_mfma_f32_16x16x32_bf16 v[52:55], v[204:207], v[196:199], v[52:55]
    s_waitcnt vmcnt(47)
    v_mfma_f32_16x16x32_bf16 v[20:23], v[208:211], v[184:187], v[20:23]
    v_mfma_f32_16x16x32_bf16 v[24:27], v[208:211], v[188:191], v[24:27]
    v_mfma_f32_16x16x32_bf16 v[56:59], v[208:211], v[192:195], v[56:59]
    v_mfma_f32_16x16x32_bf16 v[60:63], v[208:211], v[196:199], v[60:63]
    s_waitcnt vmcnt(46)
    v_mfma_f32_16x16x32_bf16 v[28:31], v[212:215], v[184:187], v[28:31]
    v_mfma_f32_16x16x32_bf16 v[32:35], v[212:215], v[188:191], v[32:35]
    v_mfma_f32_16x16x32_bf16 v[64:67], v[212:215], v[192:195], v[64:67]
    v_mfma_f32_16x16x32_bf16 v[68:71], v[212:215], v[196:199], v[68:71]
    s_waitcnt vmcnt(45)
    v_mfma_f32_16x16x32_bf16 v[36:39], v[216:219], v[184:187], v[36:39]
    v_mfma_f32_16x16x32_bf16 v[72:75], v[216:219], v[192:195], v[72:75]
    buffer_load_dwordx4 v[184:187], v1, s[36:39], s45 offen offset:0 sc1
    buffer_load_dwordx4 v[188:191], v2, s[36:39], s45 offen offset:0 sc1
    buffer_load_dwordx4 v[192:195], v1, s[36:39], s45 offen offset:2048 sc1
    buffer_load_dwordx4 v[196:199], v2, s[36:39], s45 offen offset:2048 sc1
    buffer_load_dwordx4 v[200:203], v0, s[36:39], s46 offen offset:0 sc1
    buffer_load_dwordx4 v[204:207], v0, s[36:39], s46 offen offset:1024 sc1
    buffer_load_dwordx4 v[208:211], v0, s[36:39], s46 offen offset:2048 sc1
    buffer_load_dwordx4 v[212:215], v0, s[36:39], s46 offen offset:3072 sc1
    buffer_load_dwordx4 v[216:219], v0, s[36:39], s47 offen sc1
    s_add_u32 s45, s45, 32768
    s_add_u32 s46, s46, 294912
    s_add_u32 s47, s47, 294912
    s_waitcnt vmcnt(46)
    v_mfma_f32_16x16x32_bf16 v[4:7], v[236:239], v[220:223], v[4:7]
    v_mfma_f32_16x16x32_bf16 v[8:11], v[236:239], v[224:227], v[8:11]
    v_mfma_f32_16x16x32_bf16 v[40:43], v[236:239], v[228:231], v[40:43]
    v_mfma_f32_16x16x32_bf16 v[44:47], v[236:239], v[232:235], v[44:47]
    s_waitcnt vmcnt(45)
    v_mfma_f32_16x16x32_bf16 v[12:15], v[240:243], v[220:223], v[12:15]
    v_mfma_f32_16x16x32_bf16 v[16:19], v[240:243], v[224:227], v[16:19]
    v_mfma_f32_16x16x32_bf16 v[48:51], v[240:243], v[228:231], v[48:51]
    v_mfma_f32_16x16x32_bf16 v[52:55], v[240:243], v[232:235], v[52:55]
    s_waitcnt vmcnt(44)
    v_mfma_f32_16x16x32_bf16 v[20:23], v[244:247], v[220:223], v[20:23]
    v_mfma_f32_16x16x32_bf16 v[24:27], v[244:247], v[224:227], v[24:27]
    v_mfma_f32_16x16x32_bf16 v[56:59], v[244:247], v[228:231], v[56:59]
    v_mfma_f32_16x16x32_bf16 v[60:63], v[244:247], v[232:235], v[60:63]
    s_waitcnt vmcnt(43)
    v_mfma_f32_16x16x32_bf16 v[28:31], v[248:251], v[220:223], v[28:31]
    v_mfma_f32_16x16x32_bf16 v[32:35], v[248:251], v[224:227], v[32:35]
    v_mfma_f32_16x16x32_bf16 v[64:67], v[248:251], v[228:231], v[64:67]
    v_mfma_f32_16x16x32_bf16 v[68:71], v[248:251], v[232:235], v[68:71]
    s_waitcnt vmcnt(42)
    v_mfma_f32_16x16x32_bf16 v[36:39], v[252:255], v[220:223], v[36:39]
    v_mfma_f32_16x16x32_bf16 v[72:75], v[252:255], v[228:231], v[72:75]
    buffer_load_dwordx4 v[220:223], v1, s[36:39], s45 offen offset:0 sc1
    buffer_load_dwordx4 v[224:227], v2, s[36:39], s45 offen offset:0 sc1
    buffer_load_dwordx4 v[228:231], v1, s[36:39], s45 offen offset:2048 sc1
    buffer_load_dwordx4 v[232:235], v2, s[36:39], s45 offen offset:2048 sc1
    buffer_load_dwordx4 v[236:239], v0, s[36:39], s46 offen offset:0 sc1
    buffer_load_dwordx4 v[240:243], v0, s[36:39], s46 offen offset:1024 sc1
    buffer_load_dwordx4 v[244:247], v0, s[36:39], s46 offen offset:2048 sc1
    buffer_load_dwordx4 v[248:251], v0, s[36:39], s46 offen offset:3072 sc1
    buffer_load_dwordx4 v[252:255], v0, s[36:39], s47 offen sc1
    s_add_u32 s45, s45, 32768
    s_add_u32 s46, s46, 294912
    s_add_u32 s47, s47, 294912
    s_waitcnt vmcnt(43)
    v_mfma_f32_16x16x32_bf16 v[4:7], v[92:95], v[76:79], v[4:7]
    v_mfma_f32_16x16x32_bf16 v[8:11], v[92:95], v[80:83], v[8:11]
    v_mfma_f32_16x16x32_bf16 v[40:43], v[92:95], v[84:87], v[40:43]
    v_mfma_f32_16x16x32_bf16 v[44:47], v[92:95], v[88:91], v[44:47]
    s_waitcnt vmcnt(42)
    v_mfma_f32_16x16x32_bf16 v[12:15], v[96:99], v[76:79], v[12:15]
    v_mfma_f32_16x16x32_bf16 v[16:19], v[96:99], v[80:83], v[16:19]
    v_mfma_f32_16x16x32_bf16 v[48:51], v[96:99], v[84:87], v[48:51]
    v_mfma_f32_16x16x32_bf16 v[52:55], v[96:99], v[88:91], v[52:55]
    s_waitcnt vmcnt(41)
    v_mfma_f32_16x16x32_bf16 v[20:23], v[100:103], v[76:79], v[20:23]
    v_mfma_f32_16x16x32_bf16 v[24:27], v[100:103], v[80:83], v[24:27]
    v_mfma_f32_16x16x32_bf16 v[56:59], v[100:103], v[84:87], v[56:59]
    v_mfma_f32_16x16x32_bf16 v[60:63], v[100:103], v[88:91], v[60:63]
    s_waitcnt vmcnt(40)
    v_mfma_f32_16x16x32_bf16 v[28:31], v[104:107], v[76:79], v[28:31]
    v_mfma_f32_16x16x32_bf16 v[32:35], v[104:107], v[80:83], v[32:35]
    v_mfma_f32_16x16x32_bf16 v[64:67], v[104:107], v[84:87], v[64:67]
    v_mfma_f32_16x16x32_bf16 v[68:71], v[104:107], v[88:91], v[68:71]
    s_waitcnt vmcnt(39)
    v_mfma_f32_16x16x32_bf16 v[36:39], v[108:111], v[76:79], v[36:39]
    v_mfma_f32_16x16x32_bf16 v[72:75], v[108:111], v[84:87], v[72:75]
    buffer_load_dwordx4 v[76:79], v1, s[36:39], s45 offen offset:0 sc1
    buffer_load_dwordx4 v[80:83], v2, s[36:39], s45 offen offset:0 sc1
    buffer_load_dwordx4 v[84:87], v1, s[36:39], s45 offen offset:2048 sc1
    buffer_load_dwordx4 v[88:91], v2, s[36:39], s45 offen offset:2048 sc1
    buffer_load_dwordx4 v[92:95], v0, s[36:39], s46 offen offset:0 sc1
    buffer_load_dwordx4 v[96:99], v0, s[36:39], s46 offen offset:1024 sc1
    buffer_load_dwordx4 v[100:103], v0, s[36:39], s46 offen offset:2048 sc1
    buffer_load_dwordx4 v[104:107], v0, s[36:39], s46 offen offset:3072 sc1
    buffer_load_dwordx4 v[108:111], v0, s[36:39], s47 offen sc1
    s_add_u32 s45, s45, 32768
    s_add_u32 s46, s46, 294912
    s_add_u32 s47, s47, 294912
    s_waitcnt vmcnt(40)
    v_mfma_f32_16x16x32_bf16 v[4:7], v[128:131], v[112:115], v[4:7]
    v_mfma_f32_16x16x32_bf16 v[8:11], v[128:131], v[116:119], v[8:11]
    v_mfma_f32_16x16x32_bf16 v[40:43], v[128:131], v[120:123], v[40:43]
    v_mfma_f32_16x16x32_bf16 v[44:47], v[128:131], v[124:127], v[44:47]
    s_waitcnt vmcnt(39)
    v_mfma_f32_16x16x32_bf16 v[12:15], v[132:135], v[112:115], v[12:15]
    v_mfma_f32_16x16x32_bf16 v[16:19], v[132:135], v[116:119], v[16:19]
    v_mfma_f32_16x16x32_bf16 v[48:51], v[132:135], v[120:123], v[48:51]
    v_mfma_f32_16x16x32_bf16 v[52:55], v[132:135], v[124:127], v[52:55]
    s_waitcnt vmcnt(38)
    v_mfma_f32_16x16x32_bf16 v[20:23], v[136:139], v[112:115], v[20:23]
    v_mfma_f32_16x16x32_bf16 v[24:27], v[136:139], v[116:119], v[24:27]
    v_mfma_f32_16x16x32_bf16 v[56:59], v[136:139], v[120:123], v[56:59]
    v_mfma_f32_16x16x32_bf16 v[60:63], v[136:139], v[124:127], v[60:63]
    s_waitcnt vmcnt(37)
    v_mfma_f32_16x16x32_bf16 v[28:31], v[140:143], v[112:115], v[28:31]
    v_mfma_f32_16x16x32_bf16 v[32:35], v[140:143], v[116:119], v[32:35]
    v_mfma_f32_16x16x32_bf16 v[64:67], v[140:143], v[120:123], v[64:67]
    v_mfma_f32_16x16x32_bf16 v[68:71], v[140:143], v[124:127], v[68:71]
    s_waitcnt vmcnt(36)
    v_mfma_f32_16x16x32_bf16 v[36:39], v[144:147], v[112:115], v[36:39]
    v_mfma_f32_16x16x32_bf16 v[72:75], v[144:147], v[120:123], v[72:75]
    s_lshl_b32 s35, s7, 2
    s_add_u32 s35, s35, 158464
    v_mov_b32 v3, s35
    s_mov_b64 exec, 1
    ds_write_b32 v3, v3
    s_mov_b64 exec, -1
    buffer_load_dwordx4 v[112:115], v1, s[36:39], s45 offen offset:0 sc1
    buffer_load_dwordx4 v[116:119], v2, s[36:39], s45 offen offset:0 sc1
    buffer_load_dwordx4 v[120:123], v1, s[36:39], s45 offen offset:2048 sc1
    buffer_load_dwordx4 v[124:127], v2, s[36:39], s45 offen offset:2048 sc1
    buffer_load_dwordx4 v[128:131], v0, s[36:39], s46 offen offset:0 sc1
    buffer_load_dwordx4 v[132:135], v0, s[36:39], s46 offen offset:1024 sc1
    buffer_load_dwordx4 v[136:139], v0, s[36:39], s46 offen offset:2048 sc1
    buffer_load_dwordx4 v[140:143], v0, s[36:39], s46 offen offset:3072 sc1
    buffer_load_dwordx4 v[144:147], v0, s[36:39], s47 offen sc1
    s_add_u32 s35, s44, 128
    s_lshl_b32 s45, s35, 12
    s_add_u32 s45, s45, s59
    s_mul_i32 s47, s35, 36864
    s_add_u32 s47, s47, s60
    s_mul_i32 s35, s6, 5120
    s_add_u32 s46, s47, s35
    s_add_u32 s47, s47, 4096
    s_waitcnt vmcnt(40)
    v_mfma_f32_16x16x32_bf16 v[4:7], v[164:167], v[148:151], v[4:7]
    v_mfma_f32_16x16x32_bf16 v[8:11], v[164:167], v[152:155], v[8:11]
    v_mfma_f32_16x16x32_bf16 v[40:43], v[164:167], v[156:159], v[40:43]
    v_mfma_f32_16x16x32_bf16 v[44:47], v[164:167], v[160:163], v[44:47]
    s_waitcnt vmcnt(39)
    v_mfma_f32_16x16x32_bf16 v[12:15], v[168:171], v[148:151], v[12:15]
    v_mfma_f32_16x16x32_bf16 v[16:19], v[168:171], v[152:155], v[16:19]
    v_mfma_f32_16x16x32_bf16 v[48:51], v[168:171], v[156:159], v[48:51]
    v_mfma_f32_16x16x32_bf16 v[52:55], v[168:171], v[160:163], v[52:55]
    s_waitcnt vmcnt(38)
    v_mfma_f32_16x16x32_bf16 v[20:23], v[172:175], v[148:151], v[20:23]
    v_mfma_f32_16x16x32_bf16 v[24:27], v[172:175], v[152:155], v[24:27]
    v_mfma_f32_16x16x32_bf16 v[56:59], v[172:175], v[156:159], v[56:59]
    v_mfma_f32_16x16x32_bf16 v[60:63], v[172:175], v[160:163], v[60:63]
    s_waitcnt vmcnt(37)
    v_mfma_f32_16x16x32_bf16 v[28:31], v[176:179], v[148:151], v[28:31]
    v_mfma_f32_16x16x32_bf16 v[32:35], v[176:179], v[152:155], v[32:35]
    v_mfma_f32_16x16x32_bf16 v[64:67], v[176:179], v[156:159], v[64:67]
    v_mfma_f32_16x16x32_bf16 v[68:71], v[176:179], v[160:163], v[68:71]
    s_waitcnt vmcnt(36)
    v_mfma_f32_16x16x32_bf16 v[36:39], v[180:183], v[148:151], v[36:39]
    v_mfma_f32_16x16x32_bf16 v[72:75], v[180:183], v[156:159], v[72:75]
    buffer_load_dwordx4 v[148:151], v1, s[36:39], s45 offen offset:0 sc1
    buffer_load_dwordx4 v[152:155], v2, s[36:39], s45 offen offset:0 sc1
    buffer_load_dwordx4 v[156:159], v1, s[36:39], s45 offen offset:2048 sc1
    buffer_load_dwordx4 v[160:163], v2, s[36:39], s45 offen offset:2048 sc1
    buffer_load_dwordx4 v[164:167], v0, s[36:39], s46 offen offset:0 sc1
    buffer_load_dwordx4 v[168:171], v0, s[36:39], s46 offen offset:1024 sc1
    buffer_load_dwordx4 v[172:175], v0, s[36:39], s46 offen offset:2048 sc1
    buffer_load_dwordx4 v[176:179], v0, s[36:39], s46 offen offset:3072 sc1
    buffer_load_dwordx4 v[180:183], v0, s[36:39], s47 offen sc1
    s_add_u32 s45, s45, 16384
    s_add_u32 s46, s46, 147456
    s_add_u32 s47, s47, 147456
    s_waitcnt vmcnt(40)
    v_mfma_f32_16x16x32_bf16 v[4:7], v[200:203], v[184:187], v[4:7]
    v_mfma_f32_16x16x32_bf16 v[8:11], v[200:203], v[188:191], v[8:11]
    v_mfma_f32_16x16x32_bf16 v[40:43], v[200:203], v[192:195], v[40:43]
    v_mfma_f32_16x16x32_bf16 v[44:47], v[200:203], v[196:199], v[44:47]
    s_waitcnt vmcnt(39)
    v_mfma_f32_16x16x32_bf16 v[12:15], v[204:207], v[184:187], v[12:15]
    v_mfma_f32_16x16x32_bf16 v[16:19], v[204:207], v[188:191], v[16:19]
    v_mfma_f32_16x16x32_bf16 v[48:51], v[204:207], v[192:195], v[48:51]
    v_mfma_f32_16x16x32_bf16 v[52:55], v[204:207], v[196:199], v[52:55]
    s_waitcnt vmcnt(38)
    v_mfma_f32_16x16x32_bf16 v[20:23], v[208:211], v[184:187], v[20:23]
    v_mfma_f32_16x16x32_bf16 v[24:27], v[208:211], v[188:191], v[24:27]
    v_mfma_f32_16x16x32_bf16 v[56:59], v[208:211], v[192:195], v[56:59]
    v_mfma_f32_16x16x32_bf16 v[60:63], v[208:211], v[196:199], v[60:63]
    s_waitcnt vmcnt(37)
    v_mfma_f32_16x16x32_bf16 v[28:31], v[212:215], v[184:187], v[28:31]
    v_mfma_f32_16x16x32_bf16 v[32:35], v[212:215], v[188:191], v[32:35]
    v_mfma_f32_16x16x32_bf16 v[64:67], v[212:215], v[192:195], v[64:67]
    v_mfma_f32_16x16x32_bf16 v[68:71], v[212:215], v[196:199], v[68:71]
    s_waitcnt vmcnt(36)
    v_mfma_f32_16x16x32_bf16 v[36:39], v[216:219], v[184:187], v[36:39]
    v_mfma_f32_16x16x32_bf16 v[72:75], v[216:219], v[192:195], v[72:75]
    s_lshl_b32 s33, s4, 8
    s_add_u32 s33, s33, 30154752
    v_lshrrev_b32 v3, 2, v0
    buffer_load_dword v3, v3, s[36:39], s33 offen sc1
    buffer_load_dwordx4 v[184:187], v1, s[36:39], s45 offen offset:0 sc1
    buffer_load_dwordx4 v[188:191], v2, s[36:39], s45 offen offset:0 sc1
    buffer_load_dwordx4 v[192:195], v1, s[36:39], s45 offen offset:2048 sc1
    buffer_load_dwordx4 v[196:199], v2, s[36:39], s45 offen offset:2048 sc1
    buffer_load_dwordx4 v[200:203], v0, s[36:39], s46 offen offset:0 sc1
    buffer_load_dwordx4 v[204:207], v0, s[36:39], s46 offen offset:1024 sc1
    buffer_load_dwordx4 v[208:211], v0, s[36:39], s46 offen offset:2048 sc1
    buffer_load_dwordx4 v[212:215], v0, s[36:39], s46 offen offset:3072 sc1
    buffer_load_dwordx4 v[216:219], v0, s[36:39], s47 offen sc1
    s_add_u32 s45, s45, 16384
    s_add_u32 s46, s46, 147456
    s_add_u32 s47, s47, 147456
    s_waitcnt vmcnt(41)
    v_mfma_f32_16x16x32_bf16 v[4:7], v[236:239], v[220:223], v[4:7]
    v_mfma_f32_16x16x32_bf16 v[8:11], v[236:239], v[224:227], v[8:11]
    v_mfma_f32_16x16x32_bf16 v[40:43], v[236:239], v[228:231], v[40:43]
    v_mfma_f32_16x16x32_bf16 v[44:47], v[236:239], v[232:235], v[44:47]
    s_waitcnt vmcnt(40)
    v_mfma_f32_16x16x32_bf16 v[12:15], v[240:243], v[220:223], v[12:15]
    v_mfma_f32_16x16x32_bf16 v[16:19], v[240:243], v[224:227], v[16:19]
    v_mfma_f32_16x16x32_bf16 v[48:51], v[240:243], v[228:231], v[48:51]
    v_mfma_f32_16x16x32_bf16 v[52:55], v[240:243], v[232:235], v[52:55]
    s_waitcnt vmcnt(39)
    v_mfma_f32_16x16x32_bf16 v[20:23], v[244:247], v[220:223], v[20:23]
    v_mfma_f32_16x16x32_bf16 v[24:27], v[244:247], v[224:227], v[24:27]
    v_mfma_f32_16x16x32_bf16 v[56:59], v[244:247], v[228:231], v[56:59]
    v_mfma_f32_16x16x32_bf16 v[60:63], v[244:247], v[232:235], v[60:63]
    s_waitcnt vmcnt(38)
    v_mfma_f32_16x16x32_bf16 v[28:31], v[248:251], v[220:223], v[28:31]
    v_mfma_f32_16x16x32_bf16 v[32:35], v[248:251], v[224:227], v[32:35]
    v_mfma_f32_16x16x32_bf16 v[64:67], v[248:251], v[228:231], v[64:67]
    v_mfma_f32_16x16x32_bf16 v[68:71], v[248:251], v[232:235], v[68:71]
    s_waitcnt vmcnt(37)
    v_mfma_f32_16x16x32_bf16 v[36:39], v[252:255], v[220:223], v[36:39]
    v_mfma_f32_16x16x32_bf16 v[72:75], v[252:255], v[228:231], v[72:75]
    buffer_load_dwordx4 v[220:223], v1, s[36:39], s45 offen offset:0 sc1
    buffer_load_dwordx4 v[224:227], v2, s[36:39], s45 offen offset:0 sc1
    buffer_load_dwordx4 v[228:231], v1, s[36:39], s45 offen offset:2048 sc1
    buffer_load_dwordx4 v[232:235], v2, s[36:39], s45 offen offset:2048 sc1
    buffer_load_dwordx4 v[236:239], v0, s[36:39], s46 offen offset:0 sc1
    buffer_load_dwordx4 v[240:243], v0, s[36:39], s46 offen offset:1024 sc1
    buffer_load_dwordx4 v[244:247], v0, s[36:39], s46 offen offset:2048 sc1
    buffer_load_dwordx4 v[248:251], v0, s[36:39], s46 offen offset:3072 sc1
    buffer_load_dwordx4 v[252:255], v0, s[36:39], s47 offen sc1
    s_add_u32 s45, s45, 16384
    s_add_u32 s46, s46, 147456
    s_add_u32 s47, s47, 147456
    s_waitcnt vmcnt(41)
    v_mfma_f32_16x16x32_bf16 v[4:7], v[92:95], v[76:79], v[4:7]
    v_mfma_f32_16x16x32_bf16 v[8:11], v[92:95], v[80:83], v[8:11]
    v_mfma_f32_16x16x32_bf16 v[40:43], v[92:95], v[84:87], v[40:43]
    v_mfma_f32_16x16x32_bf16 v[44:47], v[92:95], v[88:91], v[44:47]
    s_waitcnt vmcnt(40)
    v_mfma_f32_16x16x32_bf16 v[12:15], v[96:99], v[76:79], v[12:15]
    v_mfma_f32_16x16x32_bf16 v[16:19], v[96:99], v[80:83], v[16:19]
    v_mfma_f32_16x16x32_bf16 v[48:51], v[96:99], v[84:87], v[48:51]
    v_mfma_f32_16x16x32_bf16 v[52:55], v[96:99], v[88:91], v[52:55]
    s_waitcnt vmcnt(39)
    v_mfma_f32_16x16x32_bf16 v[20:23], v[100:103], v[76:79], v[20:23]
    v_mfma_f32_16x16x32_bf16 v[24:27], v[100:103], v[80:83], v[24:27]
    v_mfma_f32_16x16x32_bf16 v[56:59], v[100:103], v[84:87], v[56:59]
    v_mfma_f32_16x16x32_bf16 v[60:63], v[100:103], v[88:91], v[60:63]
    s_waitcnt vmcnt(38)
    v_mfma_f32_16x16x32_bf16 v[28:31], v[104:107], v[76:79], v[28:31]
    v_mfma_f32_16x16x32_bf16 v[32:35], v[104:107], v[80:83], v[32:35]
    v_mfma_f32_16x16x32_bf16 v[64:67], v[104:107], v[84:87], v[64:67]
    v_mfma_f32_16x16x32_bf16 v[68:71], v[104:107], v[88:91], v[68:71]
    s_waitcnt vmcnt(37)
    v_mfma_f32_16x16x32_bf16 v[36:39], v[108:111], v[76:79], v[36:39]
    v_mfma_f32_16x16x32_bf16 v[72:75], v[108:111], v[84:87], v[72:75]
    buffer_load_dwordx4 v[76:79], v1, s[36:39], s45 offen offset:0 sc1
    buffer_load_dwordx4 v[80:83], v2, s[36:39], s45 offen offset:0 sc1
    buffer_load_dwordx4 v[84:87], v1, s[36:39], s45 offen offset:2048 sc1
    buffer_load_dwordx4 v[88:91], v2, s[36:39], s45 offen offset:2048 sc1
    buffer_load_dwordx4 v[92:95], v0, s[36:39], s46 offen offset:0 sc1
    buffer_load_dwordx4 v[96:99], v0, s[36:39], s46 offen offset:1024 sc1
    buffer_load_dwordx4 v[100:103], v0, s[36:39], s46 offen offset:2048 sc1
    buffer_load_dwordx4 v[104:107], v0, s[36:39], s46 offen offset:3072 sc1
    buffer_load_dwordx4 v[108:111], v0, s[36:39], s47 offen sc1
    s_add_u32 s35, s44, 2
    s_lshl_b32 s45, s35, 12
    s_add_u32 s45, s45, s59
    s_mul_i32 s47, s35, 36864
    s_add_u32 s47, s47, s60
    s_mul_i32 s35, s6, 5120
    s_add_u32 s46, s47, s35
    s_add_u32 s47, s47, 4096
    s_waitcnt vmcnt(41)
    v_mfma_f32_16x16x32_bf16 v[4:7], v[128:131], v[112:115], v[4:7]
    v_mfma_f32_16x16x32_bf16 v[8:11], v[128:131], v[116:119], v[8:11]
    v_mfma_f32_16x16x32_bf16 v[40:43], v[128:131], v[120:123], v[40:43]
    v_mfma_f32_16x16x32_bf16 v[44:47], v[128:131], v[124:127], v[44:47]
    s_waitcnt vmcnt(40)
    v_mfma_f32_16x16x32_bf16 v[12:15], v[132:135], v[112:115], v[12:15]
    v_mfma_f32_16x16x32_bf16 v[16:19], v[132:135], v[116:119], v[16:19]
    v_mfma_f32_16x16x32_bf16 v[48:51], v[132:135], v[120:123], v[48:51]
    v_mfma_f32_16x16x32_bf16 v[52:55], v[132:135], v[124:127], v[52:55]
    s_waitcnt vmcnt(39)
    v_mfma_f32_16x16x32_bf16 v[20:23], v[136:139], v[112:115], v[20:23]
    v_mfma_f32_16x16x32_bf16 v[24:27], v[136:139], v[116:119], v[24:27]
    v_mfma_f32_16x16x32_bf16 v[56:59], v[136:139], v[120:123], v[56:59]
    v_mfma_f32_16x16x32_bf16 v[60:63], v[136:139], v[124:127], v[60:63]
    s_waitcnt vmcnt(38)
    v_mfma_f32_16x16x32_bf16 v[28:31], v[140:143], v[112:115], v[28:31]
    v_mfma_f32_16x16x32_bf16 v[32:35], v[140:143], v[116:119], v[32:35]
    v_mfma_f32_16x16x32_bf16 v[64:67], v[140:143], v[120:123], v[64:67]
    v_mfma_f32_16x16x32_bf16 v[68:71], v[140:143], v[124:127], v[68:71]
    s_waitcnt vmcnt(37)
    v_mfma_f32_16x16x32_bf16 v[36:39], v[144:147], v[112:115], v[36:39]
    v_mfma_f32_16x16x32_bf16 v[72:75], v[144:147], v[120:123], v[72:75]
    s_waitcnt vmcnt(27)
    v_cmp_ne_u32 vcc, 1, v3
    s_cmp_eq_u64 vcc, 0
    s_cbranch_scc1 KB_HP_OK
    v_lshrrev_b32 v3, 2, v0
    buffer_load_dword v3, v3, s[36:39], s33 offen sc1
    s_mov_b32 s48, 0x40000
KB_HP:
    s_waitcnt vmcnt(0)
    v_cmp_ne_u32 vcc, 1, v3
    s_cmp_eq_u64 vcc, 0
    s_cbranch_scc1 KB_HP_OK
    s_sleep 6
    v_lshrrev_b32 v3, 2, v0
    buffer_load_dword v3, v3, s[36:39], s33 offen sc1
    s_sub_u32 s48, s48, 1
    s_cmp_lg_u32 s48, 0
    s_cbranch_scc1 KB_HP
    s_waitcnt vmcnt(0)
KB_HP_OK:
    buffer_load_dwordx4 v[112:115], v1, s[36:39], s45 offen offset:0 sc1
    buffer_load_dwordx4 v[116:119], v2, s[36:39], s45 offen offset:0 sc1
    buffer_load_dwordx4 v[120:123], v1, s[36:39], s45 offen offset:2048 sc1
    buffer_load_dwordx4 v[124:127], v2, s[36:39], s45 offen offset:2048 sc1
    buffer_load_dwordx4 v[128:131], v0, s[36:39], s46 offen offset:0 sc1
    buffer_load_dwordx4 v[132:135], v0, s[36:39], s46 offen offset:1024 sc1
    buffer_load_dwordx4 v[136:139], v0, s[36:39], s46 offen offset:2048 sc1
    buffer_load_dwordx4 v[140:143], v0, s[36:39], s46 offen offset:3072 sc1
    buffer_load_dwordx4 v[144:147], v0, s[36:39], s47 offen sc1
    s_add_u32 s45, s45, 32768
    s_add_u32 s46, s46, 294912
    s_add_u32 s47, s47, 294912
    v_mfma_f32_16x16x32_bf16 v[4:7], v[164:167], v[148:151], v[4:7]
    v_mfma_f32_16x16x32_bf16 v[8:11], v[164:167], v[152:155], v[8:11]
    v_mfma_f32_16x16x32_bf16 v[40:43], v[164:167], v[156:159], v[40:43]
    v_mfma_f32_16x16x32_bf16 v[44:47], v[164:167], v[160:163], v[44:47]
    v_mfma_f32_16x16x32_bf16 v[12:15], v[168:171], v[148:151], v[12:15]
    v_mfma_f32_16x16x32_bf16 v[16:19], v[168:171], v[152:155], v[16:19]
    v_mfma_f32_16x16x32_bf16 v[48:51], v[168:171], v[156:159], v[48:51]
    v_mfma_f32_16x16x32_bf16 v[52:55], v[168:171], v[160:163], v[52:55]
    v_mfma_f32_16x16x32_bf16 v[20:23], v[172:175], v[148:151], v[20:23]
    v_mfma_f32_16x16x32_bf16 v[24:27], v[172:175], v[152:155], v[24:27]
    v_mfma_f32_16x16x32_bf16 v[56:59], v[172:175], v[156:159], v[56:59]
    v_mfma_f32_16x16x32_bf16 v[60:63], v[172:175], v[160:163], v[60:63]
    v_mfma_f32_16x16x32_bf16 v[28:31], v[176:179], v[148:151], v[28:31]
    v_mfma_f32_16x16x32_bf16 v[32:35], v[176:179], v[152:155], v[32:35]
    v_mfma_f32_16x16x32_bf16 v[64:67], v[176:179], v[156:159], v[64:67]
    v_mfma_f32_16x16x32_bf16 v[68:71], v[176:179], v[160:163], v[68:71]
    v_mfma_f32_16x16x32_bf16 v[36:39], v[180:183], v[148:151], v[36:39]
    v_mfma_f32_16x16x32_bf16 v[72:75], v[180:183], v[156:159], v[72:75]
    buffer_load_dwordx4 v[148:151], v1, s[36:39], s45 offen offset:0 sc1
    buffer_load_dwordx4 v[152:155], v2, s[36:39], s45 offen offset:0 sc1
    buffer_load_dwordx4 v[156:159], v1, s[36:39], s45 offen offset:2048 sc1
    buffer_load_dwordx4 v[160:163], v2, s[36:39], s45 offen offset:2048 sc1
    buffer_load_dwordx4 v[164:167], v0, s[36:39], s46 offen offset:0 sc1
    buffer_load_dwordx4 v[168:171], v0, s[36:39], s46 offen offset:1024 sc1
    buffer_load_dwordx4 v[172:175], v0, s[36:39], s46 offen offset:2048 sc1
    buffer_load_dwordx4 v[176:179], v0, s[36:39], s46 offen offset:3072 sc1
    buffer_load_dwordx4 v[180:183], v0, s[36:39], s47 offen sc1
    s_add_u32 s45, s45, 32768
    s_add_u32 s46, s46, 294912
    s_add_u32 s47, s47, 294912
    s_waitcnt vmcnt(40)
    v_mfma_f32_16x16x32_bf16 v[4:7], v[200:203], v[184:187], v[4:7]
    v_mfma_f32_16x16x32_bf16 v[8:11], v[200:203], v[188:191], v[8:11]
    v_mfma_f32_16x16x32_bf16 v[40:43], v[200:203], v[192:195], v[40:43]
    v_mfma_f32_16x16x32_bf16 v[44:47], v[200:203], v[196:199], v[44:47]
    s_waitcnt vmcnt(39)
    v_mfma_f32_16x16x32_bf16 v[12:15], v[204:207], v[184:187], v[12:15]
    v_mfma_f32_16x16x32_bf16 v[16:19], v[204:207], v[188:191], v[16:19]
    v_mfma_f32_16x16x32_bf16 v[48:51], v[204:207], v[192:195], v[48:51]
    v_mfma_f32_16x16x32_bf16 v[52:55], v[204:207], v[196:199], v[52:55]
    s_waitcnt vmcnt(38)
    v_mfma_f32_16x16x32_bf16 v[20:23], v[208:211], v[184:187], v[20:23]
    v_mfma_f32_16x16x32_bf16 v[24:27], v[208:211], v[188:191], v[24:27]
    v_mfma_f32_16x16x32_bf16 v[56:59], v[208:211], v[192:195], v[56:59]
    v_mfma_f32_16x16x32_bf16 v[60:63], v[208:211], v[196:199], v[60:63]
    s_waitcnt vmcnt(37)
    v_mfma_f32_16x16x32_bf16 v[28:31], v[212:215], v[184:187], v[28:31]
    v_mfma_f32_16x16x32_bf16 v[32:35], v[212:215], v[188:191], v[32:35]
    v_mfma_f32_16x16x32_bf16 v[64:67], v[212:215], v[192:195], v[64:67]
    v_mfma_f32_16x16x32_bf16 v[68:71], v[212:215], v[196:199], v[68:71]
    s_waitcnt vmcnt(36)
    v_mfma_f32_16x16x32_bf16 v[36:39], v[216:219], v[184:187], v[36:39]
    v_mfma_f32_16x16x32_bf16 v[72:75], v[216:219], v[192:195], v[72:75]
    buffer_load_dwordx4 v[184:187], v1, s[36:39], s45 offen offset:0 sc1
    buffer_load_dwordx4 v[188:191], v2, s[36:39], s45 offen offset:0 sc1
    buffer_load_dwordx4 v[192:195], v1, s[36:39], s45 offen offset:2048 sc1
    buffer_load_dwordx4 v[196:199], v2, s[36:39], s45 offen offset:2048 sc1
    buffer_load_dwordx4 v[200:203], v0, s[36:39], s46 offen offset:0 sc1
    buffer_load_dwordx4 v[204:207], v0, s[36:39], s46 offen offset:1024 sc1
    buffer_load_dwordx4 v[208:211], v0, s[36:39], s46 offen offset:2048 sc1
    buffer_load_dwordx4 v[212:215], v0, s[36:39], s46 offen offset:3072 sc1
    buffer_load_dwordx4 v[216:219], v0, s[36:39], s47 offen sc1
    s_add_u32 s45, s45, 32768
    s_add_u32 s46, s46, 294912
    s_add_u32 s47, s47, 294912
    s_waitcnt vmcnt(40)
    v_mfma_f32_16x16x32_bf16 v[4:7], v[236:239], v[220:223], v[4:7]
    v_mfma_f32_16x16x32_bf16 v[8:11], v[236:239], v[224:227], v[8:11]
    v_mfma_f32_16x16x32_bf16 v[40:43], v[236:239], v[228:231], v[40:43]
    v_mfma_f32_16x16x32_bf16 v[44:47], v[236:239], v[232:235], v[44:47]
    s_waitcnt vmcnt(39)
    v_mfma_f32_16x16x32_bf16 v[12:15], v[240:243], v[220:223], v[12:15]
    v_mfma_f32_16x16x32_bf16 v[16:19], v[240:243], v[224:227], v[16:19]
    v_mfma_f32_16x16x32_bf16 v[48:51], v[240:243], v[228:231], v[48:51]
    v_mfma_f32_16x16x32_bf16 v[52:55], v[240:243], v[232:235], v[52:55]
    s_waitcnt vmcnt(38)
    v_mfma_f32_16x16x32_bf16 v[20:23], v[244:247], v[220:223], v[20:23]
    v_mfma_f32_16x16x32_bf16 v[24:27], v[244:247], v[224:227], v[24:27]
    v_mfma_f32_16x16x32_bf16 v[56:59], v[244:247], v[228:231], v[56:59]
    v_mfma_f32_16x16x32_bf16 v[60:63], v[244:247], v[232:235], v[60:63]
    s_waitcnt vmcnt(37)
    v_mfma_f32_16x16x32_bf16 v[28:31], v[248:251], v[220:223], v[28:31]
    v_mfma_f32_16x16x32_bf16 v[32:35], v[248:251], v[224:227], v[32:35]
    v_mfma_f32_16x16x32_bf16 v[64:67], v[248:251], v[228:231], v[64:67]
    v_mfma_f32_16x16x32_bf16 v[68:71], v[248:251], v[232:235], v[68:71]
    s_waitcnt vmcnt(36)
    v_mfma_f32_16x16x32_bf16 v[36:39], v[252:255], v[220:223], v[36:39]
    v_mfma_f32_16x16x32_bf16 v[72:75], v[252:255], v[228:231], v[72:75]
    buffer_load_dwordx4 v[220:223], v1, s[36:39], s45 offen offset:0 sc1
    buffer_load_dwordx4 v[224:227], v2, s[36:39], s45 offen offset:0 sc1
    buffer_load_dwordx4 v[228:231], v1, s[36:39], s45 offen offset:2048 sc1
    buffer_load_dwordx4 v[232:235], v2, s[36:39], s45 offen offset:2048 sc1
    buffer_load_dwordx4 v[236:239], v0, s[36:39], s46 offen offset:0 sc1
    buffer_load_dwordx4 v[240:243], v0, s[36:39], s46 offen offset:1024 sc1
    buffer_load_dwordx4 v[244:247], v0, s[36:39], s46 offen offset:2048 sc1
    buffer_load_dwordx4 v[248:251], v0, s[36:39], s46 offen offset:3072 sc1
    buffer_load_dwordx4 v[252:255], v0, s[36:39], s47 offen sc1
    s_add_u32 s45, s45, 32768
    s_add_u32 s46, s46, 294912
    s_add_u32 s47, s47, 294912
    s_waitcnt vmcnt(40)
    v_mfma_f32_16x16x32_bf16 v[4:7], v[92:95], v[76:79], v[4:7]
    v_mfma_f32_16x16x32_bf16 v[8:11], v[92:95], v[80:83], v[8:11]
    v_mfma_f32_16x16x32_bf16 v[40:43], v[92:95], v[84:87], v[40:43]
    v_mfma_f32_16x16x32_bf16 v[44:47], v[92:95], v[88:91], v[44:47]
    s_waitcnt vmcnt(39)
    v_mfma_f32_16x16x32_bf16 v[12:15], v[96:99], v[76:79], v[12:15]
    v_mfma_f32_16x16x32_bf16 v[16:19], v[96:99], v[80:83], v[16:19]
    v_mfma_f32_16x16x32_bf16 v[48:51], v[96:99], v[84:87], v[48:51]
    v_mfma_f32_16x16x32_bf16 v[52:55], v[96:99], v[88:91], v[52:55]
    s_waitcnt vmcnt(38)
    v_mfma_f32_16x16x32_bf16 v[20:23], v[100:103], v[76:79], v[20:23]
    v_mfma_f32_16x16x32_bf16 v[24:27], v[100:103], v[80:83], v[24:27]
    v_mfma_f32_16x16x32_bf16 v[56:59], v[100:103], v[84:87], v[56:59]
    v_mfma_f32_16x16x32_bf16 v[60:63], v[100:103], v[88:91], v[60:63]
    s_waitcnt vmcnt(37)
    v_mfma_f32_16x16x32_bf16 v[28:31], v[104:107], v[76:79], v[28:31]
    v_mfma_f32_16x16x32_bf16 v[32:35], v[104:107], v[80:83], v[32:35]
    v_mfma_f32_16x16x32_bf16 v[64:67], v[104:107], v[84:87], v[64:67]
    v_mfma_f32_16x16x32_bf16 v[68:71], v[104:107], v[88:91], v[68:71]
    s_waitcnt vmcnt(36)
    v_mfma_f32_16x16x32_bf16 v[36:39], v[108:111], v[76:79], v[36:39]
    v_mfma_f32_16x16x32_bf16 v[72:75], v[108:111], v[84:87], v[72:75]
    buffer_load_dwordx4 v[76:79], v1, s[36:39], s45 offen offset:0 sc1
    buffer_load_dwordx4 v[80:83], v2, s[36:39], s45 offen offset:0 sc1
    buffer_load_dwordx4 v[84:87], v1, s[36:39], s45 offen offset:2048 sc1
    buffer_load_dwordx4 v[88:91], v2, s[36:39], s45 offen offset:2048 sc1
    buffer_load_dwordx4 v[92:95], v0, s[36:39], s46 offen offset:0 sc1
    buffer_load_dwordx4 v[96:99], v0, s[36:39], s46 offen offset:1024 sc1
    buffer_load_dwordx4 v[100:103], v0, s[36:39], s46 offen offset:2048 sc1
    buffer_load_dwordx4 v[104:107], v0, s[36:39], s46 offen offset:3072 sc1
    buffer_load_dwordx4 v[108:111], v0, s[36:39], s47 offen sc1
    s_add_u32 s45, s45, 32768
    s_add_u32 s46, s46, 294912
    s_add_u32 s47, s47, 294912
    s_waitcnt vmcnt(40)
    v_mfma_f32_16x16x32_bf16 v[4:7], v[128:131], v[112:115], v[4:7]
    v_mfma_f32_16x16x32_bf16 v[8:11], v[128:131], v[116:119], v[8:11]
    v_mfma_f32_16x16x32_bf16 v[40:43], v[128:131], v[120:123], v[40:43]
    v_mfma_f32_16x16x32_bf16 v[44:47], v[128:131], v[124:127], v[44:47]
    s_waitcnt vmcnt(39)
    v_mfma_f32_16x16x32_bf16 v[12:15], v[132:135], v[112:115], v[12:15]
    v_mfma_f32_16x16x32_bf16 v[16:19], v[132:135], v[116:119], v[16:19]
    v_mfma_f32_16x16x32_bf16 v[48:51], v[132:135], v[120:123], v[48:51]
    v_mfma_f32_16x16x32_bf16 v[52:55], v[132:135], v[124:127], v[52:55]
    s_waitcnt vmcnt(38)
    v_mfma_f32_16x16x32_bf16 v[20:23], v[136:139], v[112:115], v[20:23]
    v_mfma_f32_16x16x32_bf16 v[24:27], v[136:139], v[116:119], v[24:27]
    v_mfma_f32_16x16x32_bf16 v[56:59], v[136:139], v[120:123], v[56:59]
    v_mfma_f32_16x16x32_bf16 v[60:63], v[136:139], v[124:127], v[60:63]
    s_waitcnt vmcnt(37)
    v_mfma_f32_16x16x32_bf16 v[28:31], v[140:143], v[112:115], v[28:31]
    v_mfma_f32_16x16x32_bf16 v[32:35], v[140:143], v[116:119], v[32:35]
    v_mfma_f32_16x16x32_bf16 v[64:67], v[140:143], v[120:123], v[64:67]
    v_mfma_f32_16x16x32_bf16 v[68:71], v[140:143], v[124:127], v[68:71]
    s_waitcnt vmcnt(36)
    v_mfma_f32_16x16x32_bf16 v[36:39], v[144:147], v[112:115], v[36:39]
    v_mfma_f32_16x16x32_bf16 v[72:75], v[144:147], v[120:123], v[72:75]
    buffer_load_dwordx4 v[112:115], v1, s[36:39], s45 offen offset:0 sc1
    buffer_load_dwordx4 v[116:119], v2, s[36:39], s45 offen offset:0 sc1
    buffer_load_dwordx4 v[120:123], v1, s[36:39], s45 offen offset:2048 sc1
    buffer_load_dwordx4 v[124:127], v2, s[36:39], s45 offen offset:2048 sc1
    buffer_load_dwordx4 v[128:131], v0, s[36:39], s46 offen offset:0 sc1
    buffer_load_dwordx4 v[132:135], v0, s[36:39], s46 offen offset:1024 sc1
    buffer_load_dwordx4 v[136:139], v0, s[36:39], s46 offen offset:2048 sc1
    buffer_load_dwordx4 v[140:143], v0, s[36:39], s46 offen offset:3072 sc1
    buffer_load_dwordx4 v[144:147], v0, s[36:39], s47 offen sc1
    s_add_u32 s45, s45, 32768
    s_add_u32 s46, s46, 294912
    s_add_u32 s47, s47, 294912
    s_waitcnt vmcnt(40)
    v_mfma_f32_16x16x32_bf16 v[4:7], v[164:167], v[148:151], v[4:7]
    v_mfma_f32_16x16x32_bf16 v[8:11], v[164:167], v[152:155], v[8:11]
    v_mfma_f32_16x16x32_bf16 v[40:43], v[164:167], v[156:159], v[40:43]
    v_mfma_f32_16x16x32_bf16 v[44:47], v[164:167], v[160:163], v[44:47]
    s_waitcnt vmcnt(39)
    v_mfma_f32_16x16x32_bf16 v[12:15], v[168:171], v[148:151], v[12:15]
    v_mfma_f32_16x16x32_bf16 v[16:19], v[168:171], v[152:155], v[16:19]
    v_mfma_f32_16x16x32_bf16 v[48:51], v[168:171], v[156:159], v[48:51]
    v_mfma_f32_16x16x32_bf16 v[52:55], v[168:171], v[160:163], v[52:55]
    s_waitcnt vmcnt(38)
    v_mfma_f32_16x16x32_bf16 v[20:23], v[172:175], v[148:151], v[20:23]
    v_mfma_f32_16x16x32_bf16 v[24:27], v[172:175], v[152:155], v[24:27]
    v_mfma_f32_16x16x32_bf16 v[56:59], v[172:175], v[156:159], v[56:59]
    v_mfma_f32_16x16x32_bf16 v[60:63], v[172:175], v[160:163], v[60:63]
    s_waitcnt vmcnt(37)
    v_mfma_f32_16x16x32_bf16 v[28:31], v[176:179], v[148:151], v[28:31]
    v_mfma_f32_16x16x32_bf16 v[32:35], v[176:179], v[152:155], v[32:35]
    v_mfma_f32_16x16x32_bf16 v[64:67], v[176:179], v[156:159], v[64:67]
    v_mfma_f32_16x16x32_bf16 v[68:71], v[176:179], v[160:163], v[68:71]
    s_waitcnt vmcnt(36)
    v_mfma_f32_16x16x32_bf16 v[36:39], v[180:183], v[148:151], v[36:39]
    v_mfma_f32_16x16x32_bf16 v[72:75], v[180:183], v[156:159], v[72:75]
    buffer_load_dwordx4 v[148:151], v1, s[36:39], s45 offen offset:0 sc1
    buffer_load_dwordx4 v[152:155], v2, s[36:39], s45 offen offset:0 sc1
    buffer_load_dwordx4 v[156:159], v1, s[36:39], s45 offen offset:2048 sc1
    buffer_load_dwordx4 v[160:163], v2, s[36:39], s45 offen offset:2048 sc1
    buffer_load_dwordx4 v[164:167], v0, s[36:39], s46 offen offset:0 sc1
    buffer_load_dwordx4 v[168:171], v0, s[36:39], s46 offen offset:1024 sc1
    buffer_load_dwordx4 v[172:175], v0, s[36:39], s46 offen offset:2048 sc1
    buffer_load_dwordx4 v[176:179], v0, s[36:39], s46 offen offset:3072 sc1
    buffer_load_dwordx4 v[180:183], v0, s[36:39], s47 offen sc1
    s_add_u32 s45, s45, 32768
    s_add_u32 s46, s46, 294912
    s_add_u32 s47, s47, 294912
    s_waitcnt vmcnt(40)
    v_mfma_f32_16x16x32_bf16 v[4:7], v[200:203], v[184:187], v[4:7]
    v_mfma_f32_16x16x32_bf16 v[8:11], v[200:203], v[188:191], v[8:11]
    v_mfma_f32_16x16x32_bf16 v[40:43], v[200:203], v[192:195], v[40:43]
    v_mfma_f32_16x16x32_bf16 v[44:47], v[200:203], v[196:199], v[44:47]
    s_waitcnt vmcnt(39)
    v_mfma_f32_16x16x32_bf16 v[12:15], v[204:207], v[184:187], v[12:15]
    v_mfma_f32_16x16x32_bf16 v[16:19], v[204:207], v[188:191], v[16:19]
    v_mfma_f32_16x16x32_bf16 v[48:51], v[204:207], v[192:195], v[48:51]
    v_mfma_f32_16x16x32_bf16 v[52:55], v[204:207], v[196:199], v[52:55]
    s_waitcnt vmcnt(38)
    v_mfma_f32_16x16x32_bf16 v[20:23], v[208:211], v[184:187], v[20:23]
    v_mfma_f32_16x16x32_bf16 v[24:27], v[208:211], v[188:191], v[24:27]
    v_mfma_f32_16x16x32_bf16 v[56:59], v[208:211], v[192:195], v[56:59]
    v_mfma_f32_16x16x32_bf16 v[60:63], v[208:211], v[196:199], v[60:63]
    s_waitcnt vmcnt(37)
    v_mfma_f32_16x16x32_bf16 v[28:31], v[212:215], v[184:187], v[28:31]
    v_mfma_f32_16x16x32_bf16 v[32:35], v[212:215], v[188:191], v[32:35]
    v_mfma_f32_16x16x32_bf16 v[64:67], v[212:215], v[192:195], v[64:67]
    v_mfma_f32_16x16x32_bf16 v[68:71], v[212:215], v[196:199], v[68:71]
    s_waitcnt vmcnt(36)
    v_mfma_f32_16x16x32_bf16 v[36:39], v[216:219], v[184:187], v[36:39]
    v_mfma_f32_16x16x32_bf16 v[72:75], v[216:219], v[192:195], v[72:75]
    buffer_load_dwordx4 v[184:187], v1, s[36:39], s45 offen offset:0 sc1
    buffer_load_dwordx4 v[188:191], v2, s[36:39], s45 offen offset:0 sc1
    buffer_load_dwordx4 v[192:195], v1, s[36:39], s45 offen offset:2048 sc1
    buffer_load_dwordx4 v[196:199], v2, s[36:39], s45 offen offset:2048 sc1
    buffer_load_dwordx4 v[200:203], v0, s[36:39], s46 offen offset:0 sc1
    buffer_load_dwordx4 v[204:207], v0, s[36:39], s46 offen offset:1024 sc1
    buffer_load_dwordx4 v[208:211], v0, s[36:39], s46 offen offset:2048 sc1
    buffer_load_dwordx4 v[212:215], v0, s[36:39], s46 offen offset:3072 sc1
    buffer_load_dwordx4 v[216:219], v0, s[36:39], s47 offen sc1
    s_add_u32 s45, s45, 32768
    s_add_u32 s46, s46, 294912
    s_add_u32 s47, s47, 294912
    s_waitcnt vmcnt(40)
    v_mfma_f32_16x16x32_bf16 v[4:7], v[236:239], v[220:223], v[4:7]
    v_mfma_f32_16x16x32_bf16 v[8:11], v[236:239], v[224:227], v[8:11]
    v_mfma_f32_16x16x32_bf16 v[40:43], v[236:239], v[228:231], v[40:43]
    v_mfma_f32_16x16x32_bf16 v[44:47], v[236:239], v[232:235], v[44:47]
    s_waitcnt vmcnt(39)
    v_mfma_f32_16x16x32_bf16 v[12:15], v[240:243], v[220:223], v[12:15]
    v_mfma_f32_16x16x32_bf16 v[16:19], v[240:243], v[224:227], v[16:19]
    v_mfma_f32_16x16x32_bf16 v[48:51], v[240:243], v[228:231], v[48:51]
    v_mfma_f32_16x16x32_bf16 v[52:55], v[240:243], v[232:235], v[52:55]
    s_waitcnt vmcnt(38)
    v_mfma_f32_16x16x32_bf16 v[20:23], v[244:247], v[220:223], v[20:23]
    v_mfma_f32_16x16x32_bf16 v[24:27], v[244:247], v[224:227], v[24:27]
    v_mfma_f32_16x16x32_bf16 v[56:59], v[244:247], v[228:231], v[56:59]
    v_mfma_f32_16x16x32_bf16 v[60:63], v[244:247], v[232:235], v[60:63]
    s_waitcnt vmcnt(37)
    v_mfma_f32_16x16x32_bf16 v[28:31], v[248:251], v[220:223], v[28:31]
    v_mfma_f32_16x16x32_bf16 v[32:35], v[248:251], v[224:227], v[32:35]
    v_mfma_f32_16x16x32_bf16 v[64:67], v[248:251], v[228:231], v[64:67]
    v_mfma_f32_16x16x32_bf16 v[68:71], v[248:251], v[232:235], v[68:71]
    s_waitcnt vmcnt(36)
    v_mfma_f32_16x16x32_bf16 v[36:39], v[252:255], v[220:223], v[36:39]
    v_mfma_f32_16x16x32_bf16 v[72:75], v[252:255], v[228:231], v[72:75]
    buffer_load_dwordx4 v[220:223], v1, s[36:39], s45 offen offset:0 sc1
    buffer_load_dwordx4 v[224:227], v2, s[36:39], s45 offen offset:0 sc1
    buffer_load_dwordx4 v[228:231], v1, s[36:39], s45 offen offset:2048 sc1
    buffer_load_dwordx4 v[232:235], v2, s[36:39], s45 offen offset:2048 sc1
    buffer_load_dwordx4 v[236:239], v0, s[36:39], s46 offen offset:0 sc1
    buffer_load_dwordx4 v[240:243], v0, s[36:39], s46 offen offset:1024 sc1
    buffer_load_dwordx4 v[244:247], v0, s[36:39], s46 offen offset:2048 sc1
    buffer_load_dwordx4 v[248:251], v0, s[36:39], s46 offen offset:3072 sc1
    buffer_load_dwordx4 v[252:255], v0, s[36:39], s47 offen sc1
    s_add_u32 s45, s45, 32768
    s_add_u32 s46, s46, 294912
    s_add_u32 s47, s47, 294912
    s_waitcnt vmcnt(40)
    v_mfma_f32_16x16x32_bf16 v[4:7], v[92:95], v[76:79], v[4:7]
    v_mfma_f32_16x16x32_bf16 v[8:11], v[92:95], v[80:83], v[8:11]
    v_mfma_f32_16x16x32_bf16 v[40:43], v[92:95], v[84:87], v[40:43]
    v_mfma_f32_16x16x32_bf16 v[44:47], v[92:95], v[88:91], v[44:47]
    s_waitcnt vmcnt(39)
    v_mfma_f32_16x16x32_bf16 v[12:15], v[96:99], v[76:79], v[12:15]
    v_mfma_f32_16x16x32_bf16 v[16:19], v[96:99], v[80:83], v[16:19]
    v_mfma_f32_16x16x32_bf16 v[48:51], v[96:99], v[84:87], v[48:51]
    v_mfma_f32_16x16x32_bf16 v[52:55], v[96:99], v[88:91], v[52:55]
    s_waitcnt vmcnt(38)
    v_mfma_f32_16x16x32_bf16 v[20:23], v[100:103], v[76:79], v[20:23]
    v_mfma_f32_16x16x32_bf16 v[24:27], v[100:103], v[80:83], v[24:27]
    v_mfma_f32_16x16x32_bf16 v[56:59], v[100:103], v[84:87], v[56:59]
    v_mfma_f32_16x16x32_bf16 v[60:63], v[100:103], v[88:91], v[60:63]
    s_waitcnt vmcnt(37)
    v_mfma_f32_16x16x32_bf16 v[28:31], v[104:107], v[76:79], v[28:31]
    v_mfma_f32_16x16x32_bf16 v[32:35], v[104:107], v[80:83], v[32:35]
    v_mfma_f32_16x16x32_bf16 v[64:67], v[104:107], v[84:87], v[64:67]
    v_mfma_f32_16x16x32_bf16 v[68:71], v[104:107], v[88:91], v[68:71]
    s_waitcnt vmcnt(36)
    v_mfma_f32_16x16x32_bf16 v[36:39], v[108:111], v[76:79], v[36:39]
    v_mfma_f32_16x16x32_bf16 v[72:75], v[108:111], v[84:87], v[72:75]
    buffer_load_dwordx4 v[76:79], v1, s[36:39], s45 offen offset:0 sc1
    buffer_load_dwordx4 v[80:83], v2, s[36:39], s45 offen offset:0 sc1
    buffer_load_dwordx4 v[84:87], v1, s[36:39], s45 offen offset:2048 sc1
    buffer_load_dwordx4 v[88:91], v2, s[36:39], s45 offen offset:2048 sc1
    buffer_load_dwordx4 v[92:95], v0, s[36:39], s46 offen offset:0 sc1
    buffer_load_dwordx4 v[96:99], v0, s[36:39], s46 offen offset:1024 sc1
    buffer_load_dwordx4 v[100:103], v0, s[36:39], s46 offen offset:2048 sc1
    buffer_load_dwordx4 v[104:107], v0, s[36:39], s46 offen offset:3072 sc1
    buffer_load_dwordx4 v[108:111], v0, s[36:39], s47 offen sc1
    s_add_u32 s45, s45, 32768
    s_add_u32 s46, s46, 294912
    s_add_u32 s47, s47, 294912
    s_waitcnt vmcnt(40)
    v_mfma_f32_16x16x32_bf16 v[4:7], v[128:131], v[112:115], v[4:7]
    v_mfma_f32_16x16x32_bf16 v[8:11], v[128:131], v[116:119], v[8:11]
    v_mfma_f32_16x16x32_bf16 v[40:43], v[128:131], v[120:123], v[40:43]
    v_mfma_f32_16x16x32_bf16 v[44:47], v[128:131], v[124:127], v[44:47]
    s_waitcnt vmcnt(39)
    v_mfma_f32_16x16x32_bf16 v[12:15], v[132:135], v[112:115], v[12:15]
    v_mfma_f32_16x16x32_bf16 v[16:19], v[132:135], v[116:119], v[16:19]
    v_mfma_f32_16x16x32_bf16 v[48:51], v[132:135], v[120:123], v[48:51]
    v_mfma_f32_16x16x32_bf16 v[52:55], v[132:135], v[124:127], v[52:55]
    s_waitcnt vmcnt(38)
    v_mfma_f32_16x16x32_bf16 v[20:23], v[136:139], v[112:115], v[20:23]
    v_mfma_f32_16x16x32_bf16 v[24:27], v[136:139], v[116:119], v[24:27]
    v_mfma_f32_16x16x32_bf16 v[56:59], v[136:139], v[120:123], v[56:59]
    v_mfma_f32_16x16x32_bf16 v[60:63], v[136:139], v[124:127], v[60:63]
    s_waitcnt vmcnt(37)
    v_mfma_f32_16x16x32_bf16 v[28:31], v[140:143], v[112:115], v[28:31]
    v_mfma_f32_16x16x32_bf16 v[32:35], v[140:143], v[116:119], v[32:35]
    v_mfma_f32_16x16x32_bf16 v[64:67], v[140:143], v[120:123], v[64:67]
    v_mfma_f32_16x16x32_bf16 v[68:71], v[140:143], v[124:127], v[68:71]
    s_waitcnt vmcnt(36)
    v_mfma_f32_16x16x32_bf16 v[36:39], v[144:147], v[112:115], v[36:39]
    v_mfma_f32_16x16x32_bf16 v[72:75], v[144:147], v[120:123], v[72:75]
    buffer_load_dwordx4 v[112:115], v1, s[36:39], s45 offen offset:0 sc1
    buffer_load_dwordx4 v[116:119], v2, s[36:39], s45 offen offset:0 sc1
    buffer_load_dwordx4 v[120:123], v1, s[36:39], s45 offen offset:2048 sc1
    buffer_load_dwordx4 v[124:127], v2, s[36:39], s45 offen offset:2048 sc1
    buffer_load_dwordx4 v[128:131], v0, s[36:39], s46 offen offset:0 sc1
    buffer_load_dwordx4 v[132:135], v0, s[36:39], s46 offen offset:1024 sc1
    buffer_load_dwordx4 v[136:139], v0, s[36:39], s46 offen offset:2048 sc1
    buffer_load_dwordx4 v[140:143], v0, s[36:39], s46 offen offset:3072 sc1
    buffer_load_dwordx4 v[144:147], v0, s[36:39], s47 offen sc1
    s_add_u32 s45, s45, 32768
    s_add_u32 s46, s46, 294912
    s_add_u32 s47, s47, 294912
    s_waitcnt vmcnt(40)
    v_mfma_f32_16x16x32_bf16 v[4:7], v[164:167], v[148:151], v[4:7]
    v_mfma_f32_16x16x32_bf16 v[8:11], v[164:167], v[152:155], v[8:11]
    v_mfma_f32_16x16x32_bf16 v[40:43], v[164:167], v[156:159], v[40:43]
    v_mfma_f32_16x16x32_bf16 v[44:47], v[164:167], v[160:163], v[44:47]
    s_waitcnt vmcnt(39)
    v_mfma_f32_16x16x32_bf16 v[12:15], v[168:171], v[148:151], v[12:15]
    v_mfma_f32_16x16x32_bf16 v[16:19], v[168:171], v[152:155], v[16:19]
    v_mfma_f32_16x16x32_bf16 v[48:51], v[168:171], v[156:159], v[48:51]
    v_mfma_f32_16x16x32_bf16 v[52:55], v[168:171], v[160:163], v[52:55]
    s_waitcnt vmcnt(38)
    v_mfma_f32_16x16x32_bf16 v[20:23], v[172:175], v[148:151], v[20:23]
    v_mfma_f32_16x16x32_bf16 v[24:27], v[172:175], v[152:155], v[24:27]
    v_mfma_f32_16x16x32_bf16 v[56:59], v[172:175], v[156:159], v[56:59]
    v_mfma_f32_16x16x32_bf16 v[60:63], v[172:175], v[160:163], v[60:63]
    s_waitcnt vmcnt(37)
    v_mfma_f32_16x16x32_bf16 v[28:31], v[176:179], v[148:151], v[28:31]
    v_mfma_f32_16x16x32_bf16 v[32:35], v[176:179], v[152:155], v[32:35]
    v_mfma_f32_16x16x32_bf16 v[64:67], v[176:179], v[156:159], v[64:67]
    v_mfma_f32_16x16x32_bf16 v[68:71], v[176:179], v[160:163], v[68:71]
    s_waitcnt vmcnt(36)
    v_mfma_f32_16x16x32_bf16 v[36:39], v[180:183], v[148:151], v[36:39]
    v_mfma_f32_16x16x32_bf16 v[72:75], v[180:183], v[156:159], v[72:75]
    buffer_load_dwordx4 v[148:151], v1, s[36:39], s45 offen offset:0 sc1
    buffer_load_dwordx4 v[152:155], v2, s[36:39], s45 offen offset:0 sc1
    buffer_load_dwordx4 v[156:159], v1, s[36:39], s45 offen offset:2048 sc1
    buffer_load_dwordx4 v[160:163], v2, s[36:39], s45 offen offset:2048 sc1
    buffer_load_dwordx4 v[164:167], v0, s[36:39], s46 offen offset:0 sc1
    buffer_load_dwordx4 v[168:171], v0, s[36:39], s46 offen offset:1024 sc1
    buffer_load_dwordx4 v[172:175], v0, s[36:39], s46 offen offset:2048 sc1
    buffer_load_dwordx4 v[176:179], v0, s[36:39], s46 offen offset:3072 sc1
    buffer_load_dwordx4 v[180:183], v0, s[36:39], s47 offen sc1
    s_add_u32 s45, s45, 32768
    s_add_u32 s46, s46, 294912
    s_add_u32 s47, s47, 294912
    s_waitcnt vmcnt(40)
    v_mfma_f32_16x16x32_bf16 v[4:7], v[200:203], v[184:187], v[4:7]
    v_mfma_f32_16x16x32_bf16 v[8:11], v[200:203], v[188:191], v[8:11]
    v_mfma_f32_16x16x32_bf16 v[40:43], v[200:203], v[192:195], v[40:43]
    v_mfma_f32_16x16x32_bf16 v[44:47], v[200:203], v[196:199], v[44:47]
    s_waitcnt vmcnt(39)
    v_mfma_f32_16x16x32_bf16 v[12:15], v[204:207], v[184:187], v[12:15]
    v_mfma_f32_16x16x32_bf16 v[16:19], v[204:207], v[188:191], v[16:19]
    v_mfma_f32_16x16x32_bf16 v[48:51], v[204:207], v[192:195], v[48:51]
    v_mfma_f32_16x16x32_bf16 v[52:55], v[204:207], v[196:199], v[52:55]
    s_waitcnt vmcnt(38)
    v_mfma_f32_16x16x32_bf16 v[20:23], v[208:211], v[184:187], v[20:23]
    v_mfma_f32_16x16x32_bf16 v[24:27], v[208:211], v[188:191], v[24:27]
    v_mfma_f32_16x16x32_bf16 v[56:59], v[208:211], v[192:195], v[56:59]
    v_mfma_f32_16x16x32_bf16 v[60:63], v[208:211], v[196:199], v[60:63]
    s_waitcnt vmcnt(37)
    v_mfma_f32_16x16x32_bf16 v[28:31], v[212:215], v[184:187], v[28:31]
    v_mfma_f32_16x16x32_bf16 v[32:35], v[212:215], v[188:191], v[32:35]
    v_mfma_f32_16x16x32_bf16 v[64:67], v[212:215], v[192:195], v[64:67]
    v_mfma_f32_16x16x32_bf16 v[68:71], v[212:215], v[196:199], v[68:71]
    s_waitcnt vmcnt(36)
    v_mfma_f32_16x16x32_bf16 v[36:39], v[216:219], v[184:187], v[36:39]
    v_mfma_f32_16x16x32_bf16 v[72:75], v[216:219], v[192:195], v[72:75]
    buffer_load_dwordx4 v[184:187], v1, s[36:39], s45 offen offset:0 sc1
    buffer_load_dwordx4 v[188:191], v2, s[36:39], s45 offen offset:0 sc1
    buffer_load_dwordx4 v[192:195], v1, s[36:39], s45 offen offset:2048 sc1
    buffer_load_dwordx4 v[196:199], v2, s[36:39], s45 offen offset:2048 sc1
    buffer_load_dwordx4 v[200:203], v0, s[36:39], s46 offen offset:0 sc1
    buffer_load_dwordx4 v[204:207], v0, s[36:39], s46 offen offset:1024 sc1
    buffer_load_dwordx4 v[208:211], v0, s[36:39], s46 offen offset:2048 sc1
    buffer_load_dwordx4 v[212:215], v0, s[36:39], s46 offen offset:3072 sc1
    buffer_load_dwordx4 v[216:219], v0, s[36:39], s47 offen sc1
    s_add_u32 s45, s45, 32768
    s_add_u32 s46, s46, 294912
    s_add_u32 s47, s47, 294912
    s_waitcnt vmcnt(40)
    v_mfma_f32_16x16x32_bf16 v[4:7], v[236:239], v[220:223], v[4:7]
    v_mfma_f32_16x16x32_bf16 v[8:11], v[236:239], v[224:227], v[8:11]
    v_mfma_f32_16x16x32_bf16 v[40:43], v[236:239], v[228:231], v[40:43]
    v_mfma_f32_16x16x32_bf16 v[44:47], v[236:239], v[232:235], v[44:47]
    s_waitcnt vmcnt(39)
    v_mfma_f32_16x16x32_bf16 v[12:15], v[240:243], v[220:223], v[12:15]
    v_mfma_f32_16x16x32_bf16 v[16:19], v[240:243], v[224:227], v[16:19]
    v_mfma_f32_16x16x32_bf16 v[48:51], v[240:243], v[228:231], v[48:51]
    v_mfma_f32_16x16x32_bf16 v[52:55], v[240:243], v[232:235], v[52:55]
    s_waitcnt vmcnt(38)
    v_mfma_f32_16x16x32_bf16 v[20:23], v[244:247], v[220:223], v[20:23]
    v_mfma_f32_16x16x32_bf16 v[24:27], v[244:247], v[224:227], v[24:27]
    v_mfma_f32_16x16x32_bf16 v[56:59], v[244:247], v[228:231], v[56:59]
    v_mfma_f32_16x16x32_bf16 v[60:63], v[244:247], v[232:235], v[60:63]
    s_waitcnt vmcnt(37)
    v_mfma_f32_16x16x32_bf16 v[28:31], v[248:251], v[220:223], v[28:31]
    v_mfma_f32_16x16x32_bf16 v[32:35], v[248:251], v[224:227], v[32:35]
    v_mfma_f32_16x16x32_bf16 v[64:67], v[248:251], v[228:231], v[64:67]
    v_mfma_f32_16x16x32_bf16 v[68:71], v[248:251], v[232:235], v[68:71]
    s_waitcnt vmcnt(36)
    v_mfma_f32_16x16x32_bf16 v[36:39], v[252:255], v[220:223], v[36:39]
    v_mfma_f32_16x16x32_bf16 v[72:75], v[252:255], v[228:231], v[72:75]
    buffer_load_dwordx4 v[220:223], v1, s[36:39], s45 offen offset:0 sc1
    buffer_load_dwordx4 v[224:227], v2, s[36:39], s45 offen offset:0 sc1
    buffer_load_dwordx4 v[228:231], v1, s[36:39], s45 offen offset:2048 sc1
    buffer_load_dwordx4 v[232:235], v2, s[36:39], s45 offen offset:2048 sc1
    buffer_load_dwordx4 v[236:239], v0, s[36:39], s46 offen offset:0 sc1
    buffer_load_dwordx4 v[240:243], v0, s[36:39], s46 offen offset:1024 sc1
    buffer_load_dwordx4 v[244:247], v0, s[36:39], s46 offen offset:2048 sc1
    buffer_load_dwordx4 v[248:251], v0, s[36:39], s46 offen offset:3072 sc1
    buffer_load_dwordx4 v[252:255], v0, s[36:39], s47 offen sc1
    s_add_u32 s45, s45, 32768
    s_add_u32 s46, s46, 294912
    s_add_u32 s47, s47, 294912
    s_waitcnt vmcnt(40)
    v_mfma_f32_16x16x32_bf16 v[4:7], v[92:95], v[76:79], v[4:7]
    v_mfma_f32_16x16x32_bf16 v[8:11], v[92:95], v[80:83], v[8:11]
    v_mfma_f32_16x16x32_bf16 v[40:43], v[92:95], v[84:87], v[40:43]
    v_mfma_f32_16x16x32_bf16 v[44:47], v[92:95], v[88:91], v[44:47]
    s_waitcnt vmcnt(39)
    v_mfma_f32_16x16x32_bf16 v[12:15], v[96:99], v[76:79], v[12:15]
    v_mfma_f32_16x16x32_bf16 v[16:19], v[96:99], v[80:83], v[16:19]
    v_mfma_f32_16x16x32_bf16 v[48:51], v[96:99], v[84:87], v[48:51]
    v_mfma_f32_16x16x32_bf16 v[52:55], v[96:99], v[88:91], v[52:55]
    s_waitcnt vmcnt(38)
    v_mfma_f32_16x16x32_bf16 v[20:23], v[100:103], v[76:79], v[20:23]
    v_mfma_f32_16x16x32_bf16 v[24:27], v[100:103], v[80:83], v[24:27]
    v_mfma_f32_16x16x32_bf16 v[56:59], v[100:103], v[84:87], v[56:59]
    v_mfma_f32_16x16x32_bf16 v[60:63], v[100:103], v[88:91], v[60:63]
    s_waitcnt vmcnt(37)
    v_mfma_f32_16x16x32_bf16 v[28:31], v[104:107], v[76:79], v[28:31]
    v_mfma_f32_16x16x32_bf16 v[32:35], v[104:107], v[80:83], v[32:35]
    v_mfma_f32_16x16x32_bf16 v[64:67], v[104:107], v[84:87], v[64:67]
    v_mfma_f32_16x16x32_bf16 v[68:71], v[104:107], v[88:91], v[68:71]
    s_waitcnt vmcnt(36)
    v_mfma_f32_16x16x32_bf16 v[36:39], v[108:111], v[76:79], v[36:39]
    v_mfma_f32_16x16x32_bf16 v[72:75], v[108:111], v[84:87], v[72:75]
    buffer_load_dwordx4 v[76:79], v1, s[36:39], s45 offen offset:0 sc1
    buffer_load_dwordx4 v[80:83], v2, s[36:39], s45 offen offset:0 sc1
    buffer_load_dwordx4 v[84:87], v1, s[36:39], s45 offen offset:2048 sc1
    buffer_load_dwordx4 v[88:91], v2, s[36:39], s45 offen offset:2048 sc1
    buffer_load_dwordx4 v[92:95], v0, s[36:39], s46 offen offset:0 sc1
    buffer_load_dwordx4 v[96:99], v0, s[36:39], s46 offen offset:1024 sc1
    buffer_load_dwordx4 v[100:103], v0, s[36:39], s46 offen offset:2048 sc1
    buffer_load_dwordx4 v[104:107], v0, s[36:39], s46 offen offset:3072 sc1
    buffer_load_dwordx4 v[108:111], v0, s[36:39], s47 offen sc1
    s_add_u32 s45, s45, 32768
    s_add_u32 s46, s46, 294912
    s_add_u32 s47, s47, 294912
    s_waitcnt vmcnt(40)
    v_mfma_f32_16x16x32_bf16 v[4:7], v[128:131], v[112:115], v[4:7]
    v_mfma_f32_16x16x32_bf16 v[8:11], v[128:131], v[116:119], v[8:11]
    v_mfma_f32_16x16x32_bf16 v[40:43], v[128:131], v[120:123], v[40:43]
    v_mfma_f32_16x16x32_bf16 v[44:47], v[128:131], v[124:127], v[44:47]
    s_waitcnt vmcnt(39)
    v_mfma_f32_16x16x32_bf16 v[12:15], v[132:135], v[112:115], v[12:15]
    v_mfma_f32_16x16x32_bf16 v[16:19], v[132:135], v[116:119], v[16:19]
    v_mfma_f32_16x16x32_bf16 v[48:51], v[132:135], v[120:123], v[48:51]
    v_mfma_f32_16x16x32_bf16 v[52:55], v[132:135], v[124:127], v[52:55]
    s_waitcnt vmcnt(38)
    v_mfma_f32_16x16x32_bf16 v[20:23], v[136:139], v[112:115], v[20:23]
    v_mfma_f32_16x16x32_bf16 v[24:27], v[136:139], v[116:119], v[24:27]
    v_mfma_f32_16x16x32_bf16 v[56:59], v[136:139], v[120:123], v[56:59]
    v_mfma_f32_16x16x32_bf16 v[60:63], v[136:139], v[124:127], v[60:63]
    s_waitcnt vmcnt(37)
    v_mfma_f32_16x16x32_bf16 v[28:31], v[140:143], v[112:115], v[28:31]
    v_mfma_f32_16x16x32_bf16 v[32:35], v[140:143], v[116:119], v[32:35]
    v_mfma_f32_16x16x32_bf16 v[64:67], v[140:143], v[120:123], v[64:67]
    v_mfma_f32_16x16x32_bf16 v[68:71], v[140:143], v[124:127], v[68:71]
    s_waitcnt vmcnt(36)
    v_mfma_f32_16x16x32_bf16 v[36:39], v[144:147], v[112:115], v[36:39]
    v_mfma_f32_16x16x32_bf16 v[72:75], v[144:147], v[120:123], v[72:75]
    buffer_load_dwordx4 v[112:115], v1, s[36:39], s45 offen offset:0 sc1
    buffer_load_dwordx4 v[116:119], v2, s[36:39], s45 offen offset:0 sc1
    buffer_load_dwordx4 v[120:123], v1, s[36:39], s45 offen offset:2048 sc1
    buffer_load_dwordx4 v[124:127], v2, s[36:39], s45 offen offset:2048 sc1
    buffer_load_dwordx4 v[128:131], v0, s[36:39], s46 offen offset:0 sc1
    buffer_load_dwordx4 v[132:135], v0, s[36:39], s46 offen offset:1024 sc1
    buffer_load_dwordx4 v[136:139], v0, s[36:39], s46 offen offset:2048 sc1
    buffer_load_dwordx4 v[140:143], v0, s[36:39], s46 offen offset:3072 sc1
    buffer_load_dwordx4 v[144:147], v0, s[36:39], s47 offen sc1
    s_add_u32 s35, s44, 144
    s_lshl_b32 s45, s35, 12
    s_add_u32 s45, s45, s59
    s_mul_i32 s47, s35, 36864
    s_add_u32 s47, s47, s60
    s_mul_i32 s35, s6, 5120
    s_add_u32 s46, s47, s35
    s_add_u32 s47, s47, 4096
    s_waitcnt vmcnt(40)
    v_mfma_f32_16x16x32_bf16 v[4:7], v[164:167], v[148:151], v[4:7]
    v_mfma_f32_16x16x32_bf16 v[8:11], v[164:167], v[152:155], v[8:11]
    v_mfma_f32_16x16x32_bf16 v[40:43], v[164:167], v[156:159], v[40:43]
    v_mfma_f32_16x16x32_bf16 v[44:47], v[164:167], v[160:163], v[44:47]
    s_waitcnt vmcnt(39)
    v_mfma_f32_16x16x32_bf16 v[12:15], v[168:171], v[148:151], v[12:15]
    v_mfma_f32_16x16x32_bf16 v[16:19], v[168:171], v[152:155], v[16:19]
    v_mfma_f32_16x16x32_bf16 v[48:51], v[168:171], v[156:159], v[48:51]
    v_mfma_f32_16x16x32_bf16 v[52:55], v[168:171], v[160:163], v[52:55]
    s_waitcnt vmcnt(38)
    v_mfma_f32_16x16x32_bf16 v[20:23], v[172:175], v[148:151], v[20:23]
    v_mfma_f32_16x16x32_bf16 v[24:27], v[172:175], v[152:155], v[24:27]
    v_mfma_f32_16x16x32_bf16 v[56:59], v[172:175], v[156:159], v[56:59]
    v_mfma_f32_16x16x32_bf16 v[60:63], v[172:175], v[160:163], v[60:63]
    s_waitcnt vmcnt(37)
    v_mfma_f32_16x16x32_bf16 v[28:31], v[176:179], v[148:151], v[28:31]
    v_mfma_f32_16x16x32_bf16 v[32:35], v[176:179], v[152:155], v[32:35]
    v_mfma_f32_16x16x32_bf16 v[64:67], v[176:179], v[156:159], v[64:67]
    v_mfma_f32_16x16x32_bf16 v[68:71], v[176:179], v[160:163], v[68:71]
    s_waitcnt vmcnt(36)
    v_mfma_f32_16x16x32_bf16 v[36:39], v[180:183], v[148:151], v[36:39]
    v_mfma_f32_16x16x32_bf16 v[72:75], v[180:183], v[156:159], v[72:75]
    buffer_load_dwordx4 v[148:151], v0, s[36:39], s46 offen offset:0 sc1
    buffer_load_dwordx4 v[152:155], v0, s[36:39], s46 offen offset:1024 sc1
    buffer_load_dwordx4 v[156:159], v0, s[36:39], s46 offen offset:2048 sc1
    buffer_load_dwordx4 v[160:163], v0, s[36:39], s46 offen offset:3072 sc1
    buffer_load_dwordx4 v[164:167], v0, s[36:39], s47 offen sc1
    s_add_u32 s46, s46, 147456
    s_add_u32 s47, s47, 147456
    buffer_load_dwordx4 v[168:171], v0, s[36:39], s46 offen offset:0 sc1
    buffer_load_dwordx4 v[172:175], v0, s[36:39], s46 offen offset:1024 sc1
    buffer_load_dwordx4 v[176:179], v0, s[36:39], s46 offen offset:2048 sc1
    buffer_load_dwordx4 v[180:183], v0, s[36:39], s46 offen offset:3072 sc1
    s_waitcnt vmcnt(40)
    v_mfma_f32_16x16x32_bf16 v[4:7], v[200:203], v[184:187], v[4:7]
    v_mfma_f32_16x16x32_bf16 v[8:11], v[200:203], v[188:191], v[8:11]
    v_mfma_f32_16x16x32_bf16 v[40:43], v[200:203], v[192:195], v[40:43]
    v_mfma_f32_16x16x32_bf16 v[44:47], v[200:203], v[196:199], v[44:47]
    s_waitcnt vmcnt(39)
    v_mfma_f32_16x16x32_bf16 v[12:15], v[204:207], v[184:187], v[12:15]
    v_mfma_f32_16x16x32_bf16 v[16:19], v[204:207], v[188:191], v[16:19]
    v_mfma_f32_16x16x32_bf16 v[48:51], v[204:207], v[192:195], v[48:51]
    v_mfma_f32_16x16x32_bf16 v[52:55], v[204:207], v[196:199], v[52:55]
    s_waitcnt vmcnt(38)
    v_mfma_f32_16x16x32_bf16 v[20:23], v[208:211], v[184:187], v[20:23]
    v_mfma_f32_16x16x32_bf16 v[24:27], v[208:211], v[188:191], v[24:27]
    v_mfma_f32_16x16x32_bf16 v[56:59], v[208:211], v[192:195], v[56:59]
    v_mfma_f32_16x16x32_bf16 v[60:63], v[208:211], v[196:199], v[60:63]
    s_waitcnt vmcnt(37)
    v_mfma_f32_16x16x32_bf16 v[28:31], v[212:215], v[184:187], v[28:31]
    v_mfma_f32_16x16x32_bf16 v[32:35], v[212:215], v[188:191], v[32:35]
    v_mfma_f32_16x16x32_bf16 v[64:67], v[212:215], v[192:195], v[64:67]
    v_mfma_f32_16x16x32_bf16 v[68:71], v[212:215], v[196:199], v[68:71]
    s_waitcnt vmcnt(36)
    v_mfma_f32_16x16x32_bf16 v[36:39], v[216:219], v[184:187], v[36:39]
    v_mfma_f32_16x16x32_bf16 v[72:75], v[216:219], v[192:195], v[72:75]
    buffer_load_dwordx4 v[184:187], v0, s[36:39], s47 offen sc1
    s_add_u32 s46, s46, 147456
    s_add_u32 s47, s47, 147456
    buffer_load_dwordx4 v[188:191], v0, s[36:39], s46 offen offset:0 sc1
    buffer_load_dwordx4 v[192:195], v0, s[36:39], s46 offen offset:1024 sc1
    buffer_load_dwordx4 v[196:199], v0, s[36:39], s46 offen offset:2048 sc1
    buffer_load_dwordx4 v[200:203], v0, s[36:39], s46 offen offset:3072 sc1
    buffer_load_dwordx4 v[204:207], v0, s[36:39], s47 offen sc1
    s_add_u32 s46, s46, 147456
    s_add_u32 s47, s47, 147456
    buffer_load_dwordx4 v[208:211], v0, s[36:39], s46 offen offset:0 sc1
    buffer_load_dwordx4 v[212:215], v0, s[36:39], s46 offen offset:1024 sc1
    buffer_load_dwordx4 v[216:219], v0, s[36:39], s46 offen offset:2048 sc1
    s_waitcnt vmcnt(40)
    v_mfma_f32_16x16x32_bf16 v[4:7], v[236:239], v[220:223], v[4:7]
    v_mfma_f32_16x16x32_bf16 v[8:11], v[236:239], v[224:227], v[8:11]
    v_mfma_f32_16x16x32_bf16 v[40:43], v[236:239], v[228:231], v[40:43]
    v_mfma_f32_16x16x32_bf16 v[44:47], v[236:239], v[232:235], v[44:47]
    s_waitcnt vmcnt(39)
    v_mfma_f32_16x16x32_bf16 v[12:15], v[240:243], v[220:223], v[12:15]
    v_mfma_f32_16x16x32_bf16 v[16:19], v[240:243], v[224:227], v[16:19]
    v_mfma_f32_16x16x32_bf16 v[48:51], v[240:243], v[228:231], v[48:51]
    v_mfma_f32_16x16x32_bf16 v[52:55], v[240:243], v[232:235], v[52:55]
    s_waitcnt vmcnt(38)
    v_mfma_f32_16x16x32_bf16 v[20:23], v[244:247], v[220:223], v[20:23]
    v_mfma_f32_16x16x32_bf16 v[24:27], v[244:247], v[224:227], v[24:27]
    v_mfma_f32_16x16x32_bf16 v[56:59], v[244:247], v[228:231], v[56:59]
    v_mfma_f32_16x16x32_bf16 v[60:63], v[244:247], v[232:235], v[60:63]
    s_waitcnt vmcnt(37)
    v_mfma_f32_16x16x32_bf16 v[28:31], v[248:251], v[220:223], v[28:31]
    v_mfma_f32_16x16x32_bf16 v[32:35], v[248:251], v[224:227], v[32:35]
    v_mfma_f32_16x16x32_bf16 v[64:67], v[248:251], v[228:231], v[64:67]
    v_mfma_f32_16x16x32_bf16 v[68:71], v[248:251], v[232:235], v[68:71]
    s_waitcnt vmcnt(36)
    v_mfma_f32_16x16x32_bf16 v[36:39], v[252:255], v[220:223], v[36:39]
    v_mfma_f32_16x16x32_bf16 v[72:75], v[252:255], v[228:231], v[72:75]
    buffer_load_dwordx4 v[220:223], v0, s[36:39], s46 offen offset:3072 sc1
    buffer_load_dwordx4 v[224:227], v0, s[36:39], s47 offen sc1
    s_add_u32 s46, s46, 147456
    s_add_u32 s47, s47, 147456
    s_cmp_gt_u32 s44, 1
    s_cselect_b32 s46, 0x7f000000, s46
    s_cselect_b32 s47, 0x7f000000, s47
    buffer_load_dwordx4 v[228:231], v0, s[36:39], s46 offen offset:0 sc1
    buffer_load_dwordx4 v[232:235], v0, s[36:39], s46 offen offset:1024 sc1
    buffer_load_dwordx4 v[236:239], v0, s[36:39], s46 offen offset:2048 sc1
    buffer_load_dwordx4 v[240:243], v0, s[36:39], s46 offen offset:3072 sc1
    buffer_load_dwordx4 v[244:247], v0, s[36:39], s47 offen sc1
    s_add_u32 s46, s46, 147456
    s_add_u32 s47, s47, 147456
    s_waitcnt vmcnt(38)
    v_mfma_f32_16x16x32_bf16 v[4:7], v[92:95], v[76:79], v[4:7]
    v_mfma_f32_16x16x32_bf16 v[8:11], v[92:95], v[80:83], v[8:11]
    v_mfma_f32_16x16x32_bf16 v[40:43], v[92:95], v[84:87], v[40:43]
    v_mfma_f32_16x16x32_bf16 v[44:47], v[92:95], v[88:91], v[44:47]
    s_waitcnt vmcnt(37)
    v_mfma_f32_16x16x32_bf16 v[12:15], v[96:99], v[76:79], v[12:15]
    v_mfma_f32_16x16x32_bf16 v[16:19], v[96:99], v[80:83], v[16:19]
    v_mfma_f32_16x16x32_bf16 v[48:51], v[96:99], v[84:87], v[48:51]
    v_mfma_f32_16x16x32_bf16 v[52:55], v[96:99], v[88:91], v[52:55]
    s_waitcnt vmcnt(36)
    v_mfma_f32_16x16x32_bf16 v[20:23], v[100:103], v[76:79], v[20:23]
    v_mfma_f32_16x16x32_bf16 v[24:27], v[100:103], v[80:83], v[24:27]
    v_mfma_f32_16x16x32_bf16 v[56:59], v[100:103], v[84:87], v[56:59]
    v_mfma_f32_16x16x32_bf16 v[60:63], v[100:103], v[88:91], v[60:63]
    s_waitcnt vmcnt(35)
    v_mfma_f32_16x16x32_bf16 v[28:31], v[104:107], v[76:79], v[28:31]
    v_mfma_f32_16x16x32_bf16 v[32:35], v[104:107], v[80:83], v[32:35]
    v_mfma_f32_16x16x32_bf16 v[64:67], v[104:107], v[84:87], v[64:67]
    v_mfma_f32_16x16x32_bf16 v[68:71], v[104:107], v[88:91], v[68:71]
    s_waitcnt vmcnt(34)
    v_mfma_f32_16x16x32_bf16 v[36:39], v[108:111], v[76:79], v[36:39]
    v_mfma_f32_16x16x32_bf16 v[72:75], v[108:111], v[84:87], v[72:75]
    s_waitcnt vmcnt(29)
    v_mfma_f32_16x16x32_bf16 v[4:7], v[128:131], v[112:115], v[4:7]
    v_mfma_f32_16x16x32_bf16 v[8:11], v[128:131], v[116:119], v[8:11]
    v_mfma_f32_16x16x32_bf16 v[40:43], v[128:131], v[120:123], v[40:43]
    v_mfma_f32_16x16x32_bf16 v[44:47], v[128:131], v[124:127], v[44:47]
    s_waitcnt vmcnt(28)
    v_mfma_f32_16x16x32_bf16 v[12:15], v[132:135], v[112:115], v[12:15]
    v_mfma_f32_16x16x32_bf16 v[16:19], v[132:135], v[116:119], v[16:19]
    v_mfma_f32_16x16x32_bf16 v[48:51], v[132:135], v[120:123], v[48:51]
    v_mfma_f32_16x16x32_bf16 v[52:55], v[132:135], v[124:127], v[52:55]
    s_waitcnt vmcnt(27)
    v_mfma_f32_16x16x32_bf16 v[20:23], v[136:139], v[112:115], v[20:23]
    v_mfma_f32_16x16x32_bf16 v[24:27], v[136:139], v[116:119], v[24:27]
    v_mfma_f32_16x16x32_bf16 v[56:59], v[136:139], v[120:123], v[56:59]
    v_mfma_f32_16x16x32_bf16 v[60:63], v[136:139], v[124:127], v[60:63]
    s_waitcnt vmcnt(26)
    v_mfma_f32_16x16x32_bf16 v[28:31], v[140:143], v[112:115], v[28:31]
    v_mfma_f32_16x16x32_bf16 v[32:35], v[140:143], v[116:119], v[32:35]
    v_mfma_f32_16x16x32_bf16 v[64:67], v[140:143], v[120:123], v[64:67]
    v_mfma_f32_16x16x32_bf16 v[68:71], v[140:143], v[124:127], v[68:71]
    s_waitcnt vmcnt(25)
    v_mfma_f32_16x16x32_bf16 v[36:39], v[144:147], v[112:115], v[36:39]
    v_mfma_f32_16x16x32_bf16 v[72:75], v[144:147], v[120:123], v[72:75]
    s_setprio 2
    s_mul_i32 s34, s44, 9216
    s_add_u32 s34, s34, 73728
    v_add_u32 v3, s34, v0
    s_mul_i32 s49, s4, 73728
    s_lshl_b32 s34, s44, 12
    s_add_u32 s49, s49, s34
    s_add_u32 s49, s49, 25165824
    s_add_u32 s50, s49, 16384
    s_add_u32 s51, s49, 32768
    s_add_u32 s52, s49, 49152
    s_add_u32 s53, s49, 65536
    s_cmp_gt_u32 s44, 1
    s_cselect_b32 s53, 0x7f000000, s53
    v_mov_b32 v248, 158496
    s_mov_b32 s34, 0x400000
KB_AP:
    ds_read_b128 v[252:255], v248
    s_waitcnt lgkmcnt(0)
    v_min_u32 v252, v252, v253
    v_min3_u32 v252, v252, v254, v255
    s_nop 0
    v_readfirstlane_b32 s35, v252
    s_cmp_lg_u32 s35, 0
    s_cbranch_scc1 KB_AP_OK
    s_sleep 8
    s_sub_u32 s34, s34, 1
    s_cmp_lg_u32 s34, 0
    s_cbranch_scc1 KB_AP
KB_AP_OK:
    ds_write_b128 v3, v[4:7] offset:0
    ds_write_b128 v3, v[8:11] offset:1024
    ds_write_b128 v3, v[12:15] offset:2048
    ds_write_b128 v3, v[16:19] offset:3072
    ds_write_b128 v3, v[20:23] offset:4096
    ds_write_b128 v3, v[24:27] offset:5120
    ds_write_b128 v3, v[28:31] offset:6144
    ds_write_b128 v3, v[32:35] offset:7168
    ds_write_b128 v3, v[36:39] offset:8192
    ds_write_b128 v3, v[40:43] offset:36864
    ds_write_b128 v3, v[44:47] offset:37888
    ds_write_b128 v3, v[48:51] offset:38912
    ds_write_b128 v3, v[52:55] offset:39936
    ds_write_b128 v3, v[56:59] offset:40960
    ds_write_b128 v3, v[60:63] offset:41984
    ds_write_b128 v3, v[64:67] offset:43008
    ds_write_b128 v3, v[68:71] offset:44032
    ds_write_b128 v3, v[72:75] offset:45056
    s_waitcnt lgkmcnt(0)
    s_lshl_b32 s35, s7, 2
    s_add_u32 s35, s35, 158480
    v_mov_b32 v248, s35
    v_mov_b32 v249, 1
    s_mov_b64 exec, 1
    ds_write_b32 v248, v249
    s_mov_b64 exec, -1
    s_waitcnt lgkmcnt(0)
    v_add_u32 v3, 0xfffee000, v3
    s_mov_b32 s48, 0x100000
    s_setprio 0
    v_mov_b32 v248, 158544
    s_mov_b32 s34, 0x400000
KB_AD0:
    ds_read_b128 v[252:255], v248
    s_waitcnt lgkmcnt(0)
    v_min_u32 v252, v252, v253
    v_min3_u32 v252, v252, v254, v255
    s_nop 0
    v_readfirstlane_b32 s35, v252
    s_cmp_lg_u32 s35, 0
    s_cbranch_scc1 KB_AD0_OK
    s_sleep 2
    s_sub_u32 s34, s34, 1
    s_cmp_lg_u32 s34, 0
    s_cbranch_scc1 KB_AD0
KB_AD0_OK:
    s_setprio 2
    buffer_load_dwordx4 v[4:7], v1, s[36:39], s49 offen offset:0 sc1
    buffer_load_dwordx4 v[8:11], v2, s[36:39], s49 offen offset:0 sc1
    buffer_load_dwordx4 v[12:15], v1, s[36:39], s50 offen offset:0 sc1
    buffer_load_dwordx4 v[16:19], v2, s[36:39], s50 offen offset:0 sc1
    buffer_load_dwordx4 v[20:23], v1, s[36:39], s51 offen offset:0 sc1
    buffer_load_dwordx4 v[24:27], v2, s[36:39], s51 offen offset:0 sc1
    buffer_load_dwordx4 v[28:31], v1, s[36:39], s52 offen offset:0 sc1
    buffer_load_dwordx4 v[32:35], v2, s[36:39], s52 offen offset:0 sc1
    buffer_load_dwordx4 v[36:39], v1, s[36:39], s53 offen offset:0 sc1
    buffer_load_dwordx4 v[40:43], v2, s[36:39], s53 offen offset:0 sc1
KB_OW00:
    s_waitcnt vmcnt(8)
    v_max_u32 v0, v4, v5
    v_max3_u32 v0, v6, v7, v0
    v_max3_u32 v0, v8, v9, v0
    v_max3_u32 v0, v10, v11, v0
    v_cmp_eq_u32 vcc, -1, v0
    s_cmp_eq_u64 vcc, 0
    s_cbranch_scc1 KB_OK00
    s_sub_u32 s48, s48, 1
    s_cmp_eq_u32 s48, 0
    s_cbranch_scc1 KB_OK00
    s_waitcnt vmcnt(0)
    s_sleep 4
    buffer_load_dwordx4 v[4:7], v1, s[36:39], s49 offen offset:0 sc1
    buffer_load_dwordx4 v[8:11], v2, s[36:39], s49 offen offset:0 sc1
    buffer_load_dwordx4 v[12:15], v1, s[36:39], s50 offen offset:0 sc1
    buffer_load_dwordx4 v[16:19], v2, s[36:39], s50 offen offset:0 sc1
    buffer_load_dwordx4 v[20:23], v1, s[36:39], s51 offen offset:0 sc1
    buffer_load_dwordx4 v[24:27], v2, s[36:39], s51 offen offset:0 sc1
    buffer_load_dwordx4 v[28:31], v1, s[36:39], s52 offen offset:0 sc1
    buffer_load_dwordx4 v[32:35], v2, s[36:39], s52 offen offset:0 sc1
    buffer_load_dwordx4 v[36:39], v1, s[36:39], s53 offen offset:0 sc1
    buffer_load_dwordx4 v[40:43], v2, s[36:39], s53 offen offset:0 sc1
    s_branch KB_OW00
KB_OK00:
    v_mfma_f32_16x16x32_bf16 v[76:79], v[148:151], v[4:7], 0
    v_mfma_f32_16x16x32_bf16 v[80:83], v[148:151], v[8:11], 0
    v_mfma_f32_16x16x32_bf16 v[84:87], v[152:155], v[4:7], 0
    v_mfma_f32_16x16x32_bf16 v[88:91], v[152:155], v[8:11], 0
    v_mfma_f32_16x16x32_bf16 v[92:95], v[156:159], v[4:7], 0
    v_mfma_f32_16x16x32_bf16 v[96:99], v[156:159], v[8:11], 0
    v_mfma_f32_16x16x32_bf16 v[100:103], v[160:163], v[4:7], 0
    v_mfma_f32_16x16x32_bf16 v[104:107], v[160:163], v[8:11], 0
    v_mfma_f32_16x16x32_bf16 v[108:111], v[164:167], v[4:7], 0
KB_OW01:
    s_waitcnt vmcnt(6)
    v_max_u32 v0, v12, v13
    v_max3_u32 v0, v14, v15, v0
    v_max3_u32 v0, v16, v17, v0
    v_max3_u32 v0, v18, v19, v0
    v_cmp_eq_u32 vcc, -1, v0
    s_cmp_eq_u64 vcc, 0
    s_cbranch_scc1 KB_OK01
    s_sub_u32 s48, s48, 1
    s_cmp_eq_u32 s48, 0
    s_cbranch_scc1 KB_OK01
    s_waitcnt vmcnt(0)
    s_sleep 4
    buffer_load_dwordx4 v[12:15], v1, s[36:39], s50 offen offset:0 sc1
    buffer_load_dwordx4 v[16:19], v2, s[36:39], s50 offen offset:0 sc1
    buffer_load_dwordx4 v[20:23], v1, s[36:39], s51 offen offset:0 sc1
    buffer_load_dwordx4 v[24:27], v2, s[36:39], s51 offen offset:0 sc1
    buffer_load_dwordx4 v[28:31], v1, s[36:39], s52 offen offset:0 sc1
    buffer_load_dwordx4 v[32:35], v2, s[36:39], s52 offen offset:0 sc1
    buffer_load_dwordx4 v[36:39], v1, s[36:39], s53 offen offset:0 sc1
    buffer_load_dwordx4 v[40:43], v2, s[36:39], s53 offen offset:0 sc1
    s_branch KB_OW01
KB_OK01:
    v_mfma_f32_16x16x32_bf16 v[76:79], v[168:171], v[12:15], v[76:79]
    v_mfma_f32_16x16x32_bf16 v[80:83], v[168:171], v[16:19], v[80:83]
    v_mfma_f32_16x16x32_bf16 v[84:87], v[172:175], v[12:15], v[84:87]
    v_mfma_f32_16x16x32_bf16 v[88:91], v[172:175], v[16:19], v[88:91]
    v_mfma_f32_16x16x32_bf16 v[92:95], v[176:179], v[12:15], v[92:95]
    v_mfma_f32_16x16x32_bf16 v[96:99], v[176:179], v[16:19], v[96:99]
    v_mfma_f32_16x16x32_bf16 v[100:103], v[180:183], v[12:15], v[100:103]
    v_mfma_f32_16x16x32_bf16 v[104:107], v[180:183], v[16:19], v[104:107]
    v_mfma_f32_16x16x32_bf16 v[108:111], v[184:187], v[12:15], v[108:111]
KB_OW02:
    s_waitcnt vmcnt(4)
    v_max_u32 v0, v20, v21
    v_max3_u32 v0, v22, v23, v0
    v_max3_u32 v0, v24, v25, v0
    v_max3_u32 v0, v26, v27, v0
    v_cmp_eq_u32 vcc, -1, v0
    s_cmp_eq_u64 vcc, 0
    s_cbranch_scc1 KB_OK02
    s_sub_u32 s48, s48, 1
    s_cmp_eq_u32 s48, 0
    s_cbranch_scc1 KB_OK02
    s_waitcnt vmcnt(0)
    s_sleep 4
    buffer_load_dwordx4 v[20:23], v1, s[36:39], s51 offen offset:0 sc1
    buffer_load_dwordx4 v[24:27], v2, s[36:39], s51 offen offset:0 sc1
    buffer_load_dwordx4 v[28:31], v1, s[36:39], s52 offen offset:0 sc1
    buffer_load_dwordx4 v[32:35], v2, s[36:39], s52 offen offset:0 sc1
    buffer_load_dwordx4 v[36:39], v1, s[36:39], s53 offen offset:0 sc1
    buffer_load_dwordx4 v[40:43], v2, s[36:39], s53 offen offset:0 sc1
    s_branch KB_OW02
KB_OK02:
    v_mfma_f32_16x16x32_bf16 v[76:79], v[188:191], v[20:23], v[76:79]
    v_mfma_f32_16x16x32_bf16 v[80:83], v[188:191], v[24:27], v[80:83]
    v_mfma_f32_16x16x32_bf16 v[84:87], v[192:195], v[20:23], v[84:87]
    v_mfma_f32_16x16x32_bf16 v[88:91], v[192:195], v[24:27], v[88:91]
    v_mfma_f32_16x16x32_bf16 v[92:95], v[196:199], v[20:23], v[92:95]
    v_mfma_f32_16x16x32_bf16 v[96:99], v[196:199], v[24:27], v[96:99]
    v_mfma_f32_16x16x32_bf16 v[100:103], v[200:203], v[20:23], v[100:103]
    v_mfma_f32_16x16x32_bf16 v[104:107], v[200:203], v[24:27], v[104:107]
    v_mfma_f32_16x16x32_bf16 v[108:111], v[204:207], v[20:23], v[108:111]
KB_OW03:
    s_waitcnt vmcnt(2)
    v_max_u32 v0, v28, v29
    v_max3_u32 v0, v30, v31, v0
    v_max3_u32 v0, v32, v33, v0
    v_max3_u32 v0, v34, v35, v0
    v_cmp_eq_u32 vcc, -1, v0
    s_cmp_eq_u64 vcc, 0
    s_cbranch_scc1 KB_OK03
    s_sub_u32 s48, s48, 1
    s_cmp_eq_u32 s48, 0
    s_cbranch_scc1 KB_OK03
    s_waitcnt vmcnt(0)
    s_sleep 4
    buffer_load_dwordx4 v[28:31], v1, s[36:39], s52 offen offset:0 sc1
    buffer_load_dwordx4 v[32:35], v2, s[36:39], s52 offen offset:0 sc1
    buffer_load_dwordx4 v[36:39], v1, s[36:39], s53 offen offset:0 sc1
    buffer_load_dwordx4 v[40:43], v2, s[36:39], s53 offen offset:0 sc1
    s_branch KB_OW03
KB_OK03:
    v_mfma_f32_16x16x32_bf16 v[76:79], v[208:211], v[28:31], v[76:79]
    v_mfma_f32_16x16x32_bf16 v[80:83], v[208:211], v[32:35], v[80:83]
    v_mfma_f32_16x16x32_bf16 v[84:87], v[212:215], v[28:31], v[84:87]
    v_mfma_f32_16x16x32_bf16 v[88:91], v[212:215], v[32:35], v[88:91]
    v_mfma_f32_16x16x32_bf16 v[92:95], v[216:219], v[28:31], v[92:95]
    v_mfma_f32_16x16x32_bf16 v[96:99], v[216:219], v[32:35], v[96:99]
    v_mfma_f32_16x16x32_bf16 v[100:103], v[220:223], v[28:31], v[100:103]
    v_mfma_f32_16x16x32_bf16 v[104:107], v[220:223], v[32:35], v[104:107]
    v_mfma_f32_16x16x32_bf16 v[108:111], v[224:227], v[28:31], v[108:111]
KB_OW04:
    s_waitcnt vmcnt(0)
    v_max_u32 v0, v36, v37
    v_max3_u32 v0, v38, v39, v0
    v_max3_u32 v0, v40, v41, v0
    v_max3_u32 v0, v42, v43, v0
    v_cmp_eq_u32 vcc, -1, v0
    s_cmp_eq_u64 vcc, 0
    s_cbranch_scc1 KB_OK04
    s_sub_u32 s48, s48, 1
    s_cmp_eq_u32 s48, 0
    s_cbranch_scc1 KB_OK04
    s_waitcnt vmcnt(0)
    s_sleep 4
    buffer_load_dwordx4 v[36:39], v1, s[36:39], s53 offen offset:0 sc1
    buffer_load_dwordx4 v[40:43], v2, s[36:39], s53 offen offset:0 sc1
    s_branch KB_OW04
KB_OK04:
    v_mfma_f32_16x16x32_bf16 v[76:79], v[228:231], v[36:39], v[76:79]
    v_mfma_f32_16x16x32_bf16 v[80:83], v[228:231], v[40:43], v[80:83]
    v_mfma_f32_16x16x32_bf16 v[84:87], v[232:235], v[36:39], v[84:87]
    v_mfma_f32_16x16x32_bf16 v[88:91], v[232:235], v[40:43], v[88:91]
    v_mfma_f32_16x16x32_bf16 v[92:95], v[236:239], v[36:39], v[92:95]
    v_mfma_f32_16x16x32_bf16 v[96:99], v[236:239], v[40:43], v[96:99]
    v_mfma_f32_16x16x32_bf16 v[100:103], v[240:243], v[36:39], v[100:103]
    v_mfma_f32_16x16x32_bf16 v[104:107], v[240:243], v[40:43], v[104:107]
    v_mfma_f32_16x16x32_bf16 v[108:111], v[244:247], v[36:39], v[108:111]
    ds_write_b128 v3, v[76:79] offset:0
    ds_write_b128 v3, v[80:83] offset:1024
    ds_write_b128 v3, v[84:87] offset:2048
    ds_write_b128 v3, v[88:91] offset:3072
    ds_write_b128 v3, v[92:95] offset:4096
    ds_write_b128 v3, v[96:99] offset:5120
    ds_write_b128 v3, v[100:103] offset:6144
    ds_write_b128 v3, v[104:107] offset:7168
    ds_write_b128 v3, v[108:111] offset:8192
    s_waitcnt lgkmcnt(0)
    s_lshl_b32 s35, s7, 2
    s_add_u32 s35, s35, 158560
    v_mov_b32 v248, s35
    v_mov_b32 v249, 1
    s_mov_b64 exec, 1
    ds_write_b32 v248, v249
    s_mov_b64 exec, -1
    s_setprio 0
    v_mov_b32 v248, 158512
    s_mov_b32 s34, 0x400000
KB_AD1:
    ds_read_b128 v[252:255], v248
    s_waitcnt lgkmcnt(0)
    v_min_u32 v252, v252, v253
    v_min3_u32 v252, v252, v254, v255
    s_nop 0
    v_readfirstlane_b32 s35, v252
    s_cmp_lg_u32 s35, 0
    s_cbranch_scc1 KB_AD1_OK
    s_sleep 2
    s_sub_u32 s34, s34, 1
    s_cmp_lg_u32 s34, 0
    s_cbranch_scc1 KB_AD1
KB_AD1_OK:
    s_setprio 2
    buffer_load_dwordx4 v[4:7], v1, s[36:39], s49 offen offset:2048 sc1
    buffer_load_dwordx4 v[8:11], v2, s[36:39], s49 offen offset:2048 sc1
    buffer_load_dwordx4 v[12:15], v1, s[36:39], s50 offen offset:2048 sc1
    buffer_load_dwordx4 v[16:19], v2, s[36:39], s50 offen offset:2048 sc1
    buffer_load_dwordx4 v[20:23], v1, s[36:39], s51 offen offset:2048 sc1
    buffer_load_dwordx4 v[24:27], v2, s[36:39], s51 offen offset:2048 sc1
    buffer_load_dwordx4 v[28:31], v1, s[36:39], s52 offen offset:2048 sc1
    buffer_load_dwordx4 v[32:35], v2, s[36:39], s52 offen offset:2048 sc1
    buffer_load_dwordx4 v[36:39], v1, s[36:39], s53 offen offset:2048 sc1
    buffer_load_dwordx4 v[40:43], v2, s[36:39], s53 offen offset:2048 sc1
KB_OW10:
    s_waitcnt vmcnt(8)
    v_max_u32 v0, v4, v5
    v_max3_u32 v0, v6, v7, v0
    v_max3_u32 v0, v8, v9, v0
    v_max3_u32 v0, v10, v11, v0
    v_cmp_eq_u32 vcc, -1, v0
    s_cmp_eq_u64 vcc, 0
    s_cbranch_scc1 KB_OK10
    s_sub_u32 s48, s48, 1
    s_cmp_eq_u32 s48, 0
    s_cbranch_scc1 KB_OK10
    s_waitcnt vmcnt(0)
    s_sleep 4
    buffer_load_dwordx4 v[4:7], v1, s[36:39], s49 offen offset:2048 sc1
    buffer_load_dwordx4 v[8:11], v2, s[36:39], s49 offen offset:2048 sc1
    buffer_load_dwordx4 v[12:15], v1, s[36:39], s50 offen offset:2048 sc1
    buffer_load_dwordx4 v[16:19], v2, s[36:39], s50 offen offset:2048 sc1
    buffer_load_dwordx4 v[20:23], v1, s[36:39], s51 offen offset:2048 sc1
    buffer_load_dwordx4 v[24:27], v2, s[36:39], s51 offen offset:2048 sc1
    buffer_load_dwordx4 v[28:31], v1, s[36:39], s52 offen offset:2048 sc1
    buffer_load_dwordx4 v[32:35], v2, s[36:39], s52 offen offset:2048 sc1
    buffer_load_dwordx4 v[36:39], v1, s[36:39], s53 offen offset:2048 sc1
    buffer_load_dwordx4 v[40:43], v2, s[36:39], s53 offen offset:2048 sc1
    s_branch KB_OW10
KB_OK10:
    v_mfma_f32_16x16x32_bf16 v[112:115], v[148:151], v[4:7], 0
    v_mfma_f32_16x16x32_bf16 v[116:119], v[148:151], v[8:11], 0
    v_mfma_f32_16x16x32_bf16 v[120:123], v[152:155], v[4:7], 0
    v_mfma_f32_16x16x32_bf16 v[124:127], v[152:155], v[8:11], 0
    v_mfma_f32_16x16x32_bf16 v[128:131], v[156:159], v[4:7], 0
    v_mfma_f32_16x16x32_bf16 v[132:135], v[156:159], v[8:11], 0
    v_mfma_f32_16x16x32_bf16 v[136:139], v[160:163], v[4:7], 0
    v_mfma_f32_16x16x32_bf16 v[140:143], v[160:163], v[8:11], 0
    v_mfma_f32_16x16x32_bf16 v[144:147], v[164:167], v[4:7], 0
KB_OW11:
    s_waitcnt vmcnt(6)
    v_max_u32 v0, v12, v13
    v_max3_u32 v0, v14, v15, v0
    v_max3_u32 v0, v16, v17, v0
    v_max3_u32 v0, v18, v19, v0
    v_cmp_eq_u32 vcc, -1, v0
    s_cmp_eq_u64 vcc, 0
    s_cbranch_scc1 KB_OK11
    s_sub_u32 s48, s48, 1
    s_cmp_eq_u32 s48, 0
    s_cbranch_scc1 KB_OK11
    s_waitcnt vmcnt(0)
    s_sleep 4
    buffer_load_dwordx4 v[12:15], v1, s[36:39], s50 offen offset:2048 sc1
    buffer_load_dwordx4 v[16:19], v2, s[36:39], s50 offen offset:2048 sc1
    buffer_load_dwordx4 v[20:23], v1, s[36:39], s51 offen offset:2048 sc1
    buffer_load_dwordx4 v[24:27], v2, s[36:39], s51 offen offset:2048 sc1
    buffer_load_dwordx4 v[28:31], v1, s[36:39], s52 offen offset:2048 sc1
    buffer_load_dwordx4 v[32:35], v2, s[36:39], s52 offen offset:2048 sc1
    buffer_load_dwordx4 v[36:39], v1, s[36:39], s53 offen offset:2048 sc1
    buffer_load_dwordx4 v[40:43], v2, s[36:39], s53 offen offset:2048 sc1
    s_branch KB_OW11
KB_OK11:
    v_mfma_f32_16x16x32_bf16 v[112:115], v[168:171], v[12:15], v[112:115]
    v_mfma_f32_16x16x32_bf16 v[116:119], v[168:171], v[16:19], v[116:119]
    v_mfma_f32_16x16x32_bf16 v[120:123], v[172:175], v[12:15], v[120:123]
    v_mfma_f32_16x16x32_bf16 v[124:127], v[172:175], v[16:19], v[124:127]
    v_mfma_f32_16x16x32_bf16 v[128:131], v[176:179], v[12:15], v[128:131]
    v_mfma_f32_16x16x32_bf16 v[132:135], v[176:179], v[16:19], v[132:135]
    v_mfma_f32_16x16x32_bf16 v[136:139], v[180:183], v[12:15], v[136:139]
    v_mfma_f32_16x16x32_bf16 v[140:143], v[180:183], v[16:19], v[140:143]
    v_mfma_f32_16x16x32_bf16 v[144:147], v[184:187], v[12:15], v[144:147]
KB_OW12:
    s_waitcnt vmcnt(4)
    v_max_u32 v0, v20, v21
    v_max3_u32 v0, v22, v23, v0
    v_max3_u32 v0, v24, v25, v0
    v_max3_u32 v0, v26, v27, v0
    v_cmp_eq_u32 vcc, -1, v0
    s_cmp_eq_u64 vcc, 0
    s_cbranch_scc1 KB_OK12
    s_sub_u32 s48, s48, 1
    s_cmp_eq_u32 s48, 0
    s_cbranch_scc1 KB_OK12
    s_waitcnt vmcnt(0)
    s_sleep 4
    buffer_load_dwordx4 v[20:23], v1, s[36:39], s51 offen offset:2048 sc1
    buffer_load_dwordx4 v[24:27], v2, s[36:39], s51 offen offset:2048 sc1
    buffer_load_dwordx4 v[28:31], v1, s[36:39], s52 offen offset:2048 sc1
    buffer_load_dwordx4 v[32:35], v2, s[36:39], s52 offen offset:2048 sc1
    buffer_load_dwordx4 v[36:39], v1, s[36:39], s53 offen offset:2048 sc1
    buffer_load_dwordx4 v[40:43], v2, s[36:39], s53 offen offset:2048 sc1
    s_branch KB_OW12
KB_OK12:
    v_mfma_f32_16x16x32_bf16 v[112:115], v[188:191], v[20:23], v[112:115]
    v_mfma_f32_16x16x32_bf16 v[116:119], v[188:191], v[24:27], v[116:119]
    v_mfma_f32_16x16x32_bf16 v[120:123], v[192:195], v[20:23], v[120:123]
    v_mfma_f32_16x16x32_bf16 v[124:127], v[192:195], v[24:27], v[124:127]
    v_mfma_f32_16x16x32_bf16 v[128:131], v[196:199], v[20:23], v[128:131]
    v_mfma_f32_16x16x32_bf16 v[132:135], v[196:199], v[24:27], v[132:135]
    v_mfma_f32_16x16x32_bf16 v[136:139], v[200:203], v[20:23], v[136:139]
    v_mfma_f32_16x16x32_bf16 v[140:143], v[200:203], v[24:27], v[140:143]
    v_mfma_f32_16x16x32_bf16 v[144:147], v[204:207], v[20:23], v[144:147]
KB_OW13:
    s_waitcnt vmcnt(2)
    v_max_u32 v0, v28, v29
    v_max3_u32 v0, v30, v31, v0
    v_max3_u32 v0, v32, v33, v0
    v_max3_u32 v0, v34, v35, v0
    v_cmp_eq_u32 vcc, -1, v0
    s_cmp_eq_u64 vcc, 0
    s_cbranch_scc1 KB_OK13
    s_sub_u32 s48, s48, 1
    s_cmp_eq_u32 s48, 0
    s_cbranch_scc1 KB_OK13
    s_waitcnt vmcnt(0)
    s_sleep 4
    buffer_load_dwordx4 v[28:31], v1, s[36:39], s52 offen offset:2048 sc1
    buffer_load_dwordx4 v[32:35], v2, s[36:39], s52 offen offset:2048 sc1
    buffer_load_dwordx4 v[36:39], v1, s[36:39], s53 offen offset:2048 sc1
    buffer_load_dwordx4 v[40:43], v2, s[36:39], s53 offen offset:2048 sc1
    s_branch KB_OW13
KB_OK13:
    v_mfma_f32_16x16x32_bf16 v[112:115], v[208:211], v[28:31], v[112:115]
    v_mfma_f32_16x16x32_bf16 v[116:119], v[208:211], v[32:35], v[116:119]
    v_mfma_f32_16x16x32_bf16 v[120:123], v[212:215], v[28:31], v[120:123]
    v_mfma_f32_16x16x32_bf16 v[124:127], v[212:215], v[32:35], v[124:127]
    v_mfma_f32_16x16x32_bf16 v[128:131], v[216:219], v[28:31], v[128:131]
    v_mfma_f32_16x16x32_bf16 v[132:135], v[216:219], v[32:35], v[132:135]
    v_mfma_f32_16x16x32_bf16 v[136:139], v[220:223], v[28:31], v[136:139]
    v_mfma_f32_16x16x32_bf16 v[140:143], v[220:223], v[32:35], v[140:143]
    v_mfma_f32_16x16x32_bf16 v[144:147], v[224:227], v[28:31], v[144:147]
KB_OW14:
    s_waitcnt vmcnt(0)
    v_max_u32 v0, v36, v37
    v_max3_u32 v0, v38, v39, v0
    v_max3_u32 v0, v40, v41, v0
    v_max3_u32 v0, v42, v43, v0
    v_cmp_eq_u32 vcc, -1, v0
    s_cmp_eq_u64 vcc, 0
    s_cbranch_scc1 KB_OK14
    s_sub_u32 s48, s48, 1
    s_cmp_eq_u32 s48, 0
    s_cbranch_scc1 KB_OK14
    s_waitcnt vmcnt(0)
    s_sleep 4
    buffer_load_dwordx4 v[36:39], v1, s[36:39], s53 offen offset:2048 sc1
    buffer_load_dwordx4 v[40:43], v2, s[36:39], s53 offen offset:2048 sc1
    s_branch KB_OW14
KB_OK14:
    v_mfma_f32_16x16x32_bf16 v[112:115], v[228:231], v[36:39], v[112:115]
    v_mfma_f32_16x16x32_bf16 v[116:119], v[228:231], v[40:43], v[116:119]
    v_mfma_f32_16x16x32_bf16 v[120:123], v[232:235], v[36:39], v[120:123]
    v_mfma_f32_16x16x32_bf16 v[124:127], v[232:235], v[40:43], v[124:127]
    v_mfma_f32_16x16x32_bf16 v[128:131], v[236:239], v[36:39], v[128:131]
    v_mfma_f32_16x16x32_bf16 v[132:135], v[236:239], v[40:43], v[132:135]
    v_mfma_f32_16x16x32_bf16 v[136:139], v[240:243], v[36:39], v[136:139]
    v_mfma_f32_16x16x32_bf16 v[140:143], v[240:243], v[40:43], v[140:143]
    v_mfma_f32_16x16x32_bf16 v[144:147], v[244:247], v[36:39], v[144:147]
    ds_write_b128 v3, v[112:115] offset:36864
    ds_write_b128 v3, v[116:119] offset:37888
    ds_write_b128 v3, v[120:123] offset:38912
    ds_write_b128 v3, v[124:127] offset:39936
    ds_write_b128 v3, v[128:131] offset:40960
    ds_write_b128 v3, v[132:135] offset:41984
    ds_write_b128 v3, v[136:139] offset:43008
    ds_write_b128 v3, v[140:143] offset:44032
    ds_write_b128 v3, v[144:147] offset:45056
    s_waitcnt lgkmcnt(0)
    s_barrier
    s_endpgm
.section .rodata,"a"
.p2align 6
.amdhsa_kernel recurrent_scan__grouped_kv_mqa__glu_gated_swiglu__prompt_kernel
  .amdhsa_next_free_vgpr 256
  .amdhsa_next_free_sgpr 68
  .amdhsa_accum_offset 256
  .amdhsa_group_segment_fixed_size 0
  .amdhsa_kernarg_size 96
  .amdhsa_user_sgpr_count 2
  .amdhsa_user_sgpr_kernarg_segment_ptr 1
  .amdhsa_system_sgpr_workgroup_id_x 1
.end_amdhsa_kernel
```
